```python
import torch

def _softmax(x, axis=-1):
    return torch.softmax(x, dim=axis)
def _gelu(x):
    return torch.nn.functional.gelu(x, approximate="tanh")
def _silu(x):
    return torch.nn.functional.silu(x)
def _sigmoid(x):
    return torch.sigmoid(x)
def _layernorm(x, axis=-1, eps=1e-5):
    m = x.mean(dim=axis, keepdim=True)
    v = x.var(dim=axis, keepdim=True, unbiased=False)
    return (x - m) / torch.sqrt(v + eps)
def _scatter_add(tgt, idx, src, axis=0):
    return tgt.clone().index_add_(axis, idx, src)
def _segment_sum(src, seg, n):
    out = torch.zeros((n,) + src.shape[1:], dtype=src.dtype)
    return out.index_add_(0, seg, src)
def _pad(x, pw):
    flat = tuple(v for pair in reversed(pw) for v in pair)
    return torch.nn.functional.pad(x, flat)

kernel_name = 'gated_mix__mha_block__spectral_fnet__prompt'

def setup_inputs():

    _w = (lambda a: (lambda t: t.to(torch.bfloat16) if t.is_floating_point() else t)(torch.as_tensor(a)))
    def _A_setup():
        B, S, D, H = 1, 2048, 1024, 32
        return {
            "x": _w((lambda *s: torch.randn(*s, dtype=torch.bfloat16) * 0.05)(B, S, D)),
            "wqkv": _w((lambda *s: torch.randn(*s, dtype=torch.bfloat16) * 1.6)(D, 3 * D)),
            "wo": _w((lambda *s: torch.randn(*s, dtype=torch.bfloat16) * 0.2)(D, D)),
        }
    _A_in = _A_setup()

    def _B_setup():
        B, S, D = 1, 2048, 1024
        ns = torch.arange(S)[:, None] * torch.arange(S)[None, :]
        nd = torch.arange(D)[:, None] * torch.arange(D)[None, :]
        Ws_re = torch.cos(-2.0 * torch.pi * ns / S).to(float)
        Ws_im = torch.sin(-2.0 * torch.pi * ns / S).to(float)
        Wd_re = torch.cos(-2.0 * torch.pi * nd / D).to(float)
        Wd_im = torch.sin(-2.0 * torch.pi * nd / D).to(float)
        return {
            "x": _w((lambda *s: torch.randn(*s, dtype=torch.bfloat16) * 0.05)(B, S, D)),
            "dft_seq_re": _w(Ws_re),
            "dft_seq_im": _w(Ws_im),
            "dft_hid_re": _w(Wd_re),
            "dft_hid_im": _w(Wd_im),
        }
    _B_in = _B_setup()

    return {
        "A_x": _A_in["x"],
        "A_wqkv": _A_in["wqkv"],
        "A_wo": _A_in["wo"],
        "B_x": _B_in["x"],
        "B_dft_seq_re": _B_in["dft_seq_re"],
        "B_dft_seq_im": _B_in["dft_seq_im"],
        "B_dft_hid_re": _B_in["dft_hid_re"],
        "B_dft_hid_im": _B_in["dft_hid_im"],
        "gate_w": _w((lambda *s: torch.randn(*s, dtype=torch.bfloat16) * 0.05)(1024) * 16.0),
    }

def reference(A_x, A_wqkv, A_wo, B_x, B_dft_seq_re, B_dft_seq_im, B_dft_hid_re, B_dft_hid_im, gate_w):
    def _A_ref(x, wqkv, wo):
        B, S, D = x.shape
        H = 32
        Dh = D // H
        qkv = (lambda x, *d: x.permute(*d))((x @ wqkv).reshape(B, S, 3, H, Dh), 2, 0, 3, 1, 4)
        q, k, v = qkv[0], qkv[1], qkv[2]
        scores = torch.einsum("bhqd,bhkd->bhqk", q, k) * (Dh ** -0.5)
        p = _softmax(scores, axis=-1)
        o = torch.einsum("bhqk,bhkd->bhqd", p, v)
        return (lambda x, *d: x.permute(*d))(o, 0, 2, 1, 3).reshape(B, S, D) @ wo

    def _B_ref(x, dft_seq_re, dft_seq_im, dft_hid_re, dft_hid_im):
        a = torch.einsum("bsd,ed->bse", x, dft_hid_re)
        b = torch.einsum("bsd,ed->bse", x, dft_hid_im)
        y = torch.einsum("ts,bse->bte", dft_seq_re, a) - torch.einsum("ts,bse->bte", dft_seq_im, b)
        return y

    x = A_x
    g = _sigmoid((x * gate_w).sum(-1, keepdims=True))
    a = _A_ref(x, A_wqkv, A_wo)
    b = _B_ref(x, B_dft_seq_re, B_dft_seq_im, B_dft_hid_re, B_dft_hid_im)
    return g * a + (1 - g) * b
```

```asm
; @launch grid=(256,1,1) block=(256,1,1) lds=163840
.amdgcn_target "amdgcn-amd-amdhsa--gfx950"
.text
.p2align 12
.globl gated_mix__mha_block__spectral_fnet__prompt_kernel
.p2align 8
.type gated_mix__mha_block__spectral_fnet__prompt_kernel,@function
gated_mix__mha_block__spectral_fnet__prompt_kernel:
    s_load_dwordx4 s[4:7], s[0:1], 0
    s_load_dwordx8 s[56:63], s[0:1], 64
    s_load_dwordx2 s[54:55], s[0:1], 16
    s_cmp_ge_u32 s2, 256
    s_cbranch_scc1 L_end
    s_getpc_b64 s[76:77]
L_pc:
    s_lshr_b32 s49, s2, 3
    v_lshrrev_b32 v253, 6, v0
    v_bfe_u32 v248, v0, 4, 4
    v_lshlrev_b32 v248, 5, v248
    v_add_lshl_u32 v248, v248, s49, 7
    v_min_u32 v248, L_codeend-L_pc-4, v248
    v_mov_b32 v249, s77
    v_add_co_u32 v248, vcc, s76, v248
    v_readfirstlane_b32 s36, v253
    v_and_b32 v1, 63, v0
    v_addc_co_u32 v249, vcc, 0, v249, vcc
    global_load_dword v244, v[248:249], off
    v_lshlrev_b32 v3, 4, v1
    s_lshr_b32 s47, s2, 5
    s_lshl_b32 s47, s47, 19
    s_and_b32 s48, s2, 31
    s_lshl_b32 s48, s48, 11
    s_add_u32 s47, s47, s48
    s_lshl_b32 s48, s36, 17
    s_add_u32 s47, s47, s48
    s_add_u32 s48, s47, 63488
    s_mul_i32 s51, s36, 6144
    s_add_u32 s51, s51, 114688
    s_mov_b32 m0, s51
    s_mov_b32 s10, 4194304
    s_mov_b32 s11, 0x00020000
    s_waitcnt lgkmcnt(0)
    s_mov_b64 s[8:9], s[4:5]
    buffer_load_dwordx4 v3, s[8:11], s47 offen lds
    buffer_load_dwordx4 v3, s[8:11], s47 offen offset:1024 lds
    buffer_load_dwordx4 v3, s[8:11], s48 offen offset:2048 lds
    buffer_load_dwordx4 v3, s[8:11], s48 offen offset:3072 lds
    s_add_u32 m0, m0, 4096
    s_mov_b64 s[28:29], s[56:57]
    s_mov_b32 s30, 2048
    s_mov_b32 s31, 0x00020000
    buffer_load_dwordx4 v3, s[28:31], 0 offen lds
    buffer_load_dwordx4 v3, s[28:31], 0 offen offset:1024 lds
    s_mov_b64 s[12:13], s[6:7]
    s_mov_b32 s14, 6291456
    s_mov_b32 s15, 0x00020000
    s_lshl_b32 s49, s49, 2
    s_add_u32 s49, s49, s36
    s_mul_i32 s95, s49, 6144
    s_and_b32 s49, s2, 7
    s_lshl_b32 s49, s49, 8
    s_add_u32 s95, s95, s49
    v_lshrrev_b32 v248, 3, v1
    v_mul_u32_u24 v248, 786432, v248
    v_bfe_u32 v249, v1, 1, 2
    v_min_u32 v249, 2, v249
    v_lshl_add_u32 v248, v249, 11, v248
    v_and_b32 v249, 1, v1
    v_lshl_add_u32 v247, v249, 7, v248
    s_and_b32 s37, s2, 7
    s_lshl_b32 s37, s37, 1
    s_bfe_u32 s50, s2, 0x10003
    s_add_u32 s37, s37, s50
    s_lshr_b32 s38, s2, 4
    s_lshr_b32 s39, s36, 1
    s_and_b32 s40, s36, 1
    s_lshl_b32 s64, s37, 1
    s_add_u32 s64, s64, s40
    s_lshl_b32 s53, s2, 11
    s_add_u32 s53, s53, 20971520
    s_lshl_b32 s50, s36, 2
    s_add_u32 s99, s53, s50
    s_lshl_b32 s50, s36, 9
    s_add_u32 s53, s53, s50
    v_lshrrev_b32 v248, 3, v1
    v_lshrrev_b32 v249, 4, v1
    v_and_b32 v250, 7, v1
    v_xor_b32 v251, v249, v250
    v_lshlrev_b32 v251, 4, v251
    v_lshl_add_u32 v4, v248, 11, v251
    v_xor_b32 v5, 64, v4
    v_add_u32 v5, 15360, v5
    v_add_u32 v6, 30720, v4
    v_add_u32 v7, 30720, v5
    v_mul_u32_u24 v248, 6144, v248
    v_and_b32 v249, 1, v249
    v_lshlrev_b32 v249, 1, v249
    v_xor_b32 v249, v249, v250
    v_lshl_add_u32 v8, v249, 4, v248
    v_xor_b32 v9, 64, v8
    v_add_u32 v9, 48128, v9
    s_lshl_b32 s41, s38, 18
    s_lshl_b32 s49, s36, 16
    s_add_u32 s41, s41, s49
    s_mul_i32 s42, s36, 98304
    s_lshl_b32 s49, s37, 7
    s_add_u32 s42, s42, s49
    s_add_u32 s42, s42, 2048
    s_lshl_b32 s44, s36, 12
    s_lshl_b32 s45, s36, 11
    s_mov_b32 s10, 63616
    s_mov_b32 s30, 92288
    s_add_u32 s8, s8, s41
    s_addc_u32 s9, s9, 0
    s_add_u32 s28, s12, s42
    s_addc_u32 s29, s13, 0
    s_mov_b32 s16, s62
    s_mov_b32 s17, s63
    s_mov_b32 s18, 25165824
    s_mov_b32 s19, 0x00020000
    s_mov_b32 s20, s54
    s_mov_b32 s21, s55
    s_mov_b32 s22, 2097152
    s_mov_b32 s23, 0x00020000
    s_mov_b32 s24, s58
    s_mov_b32 s25, s59
    s_mov_b32 s26, 4194304
    s_mov_b32 s27, 0x00020000
    s_mov_b32 s32, s60
    s_mov_b32 s33, s61
    s_mov_b32 s34, 256
    s_mov_b32 s35, 0x00020000
    s_mov_b32 s98, 20971520
    v_mov_b32 v19, 1
    v_min_u32 v2, 1, v1
    v_lshlrev_b32 v2, 31, v2
    s_add_u32 m0, s45, 139264
    s_nop 0
    buffer_load_dwordx4 v8, s[28:31], 0 offen offset:0 lds
    s_lshl_b32 s47, s38, 4
    s_add_u32 s47, s47, s37
    s_and_b32 s65, s47, 31
    s_lshr_b32 s48, s47, 5
    s_lshl_b32 s48, s48, 6
    s_add_u32 s65, s65, s48
    s_lshl_b32 s48, s39, 5
    s_add_u32 s65, s65, s48
    s_lshr_b32 s96, s47, 1
    s_lshl_b32 s96, s96, 15
    s_and_b32 s47, s47, 1
    s_lshl_b32 s47, s47, 6
    s_add_u32 s96, s96, s47
    s_lshl_b32 s47, s36, 13
    s_add_u32 s96, s96, s47
    s_add_u32 s96, s96, 12582912
    s_lshl_b32 s75, s65, 12
    s_lshl_b32 s47, s40, 11
    s_add_u32 s75, s75, s47
    s_add_u32 s75, s75, 16777216
    s_lshl_b32 s66, s64, 18
    s_lshl_b32 s47, s39, 13
    s_add_u32 s66, s66, s47
    s_lshl_b32 s68, s38, 14
    s_add_u32 s67, s66, s68
    s_add_u32 s84, s67, 4096
    s_mov_b32 s85, 0x3e8293ee
    s_lshl_b32 s47, s38, 2
    s_lshl_b32 s48, s39, 1
    s_add_u32 s47, s47, s48
    buffer_load_dwordx4 v9, s[28:31], 0 offen offset:1024 lds
    s_add_u32 s28, s28, 2048
    s_addc_u32 s29, s29, 0
    s_lshl_b32 s87, s47, 16
    s_lshl_b32 s48, s64, 11
    s_add_u32 s87, s87, s48
    s_add_u32 s87, s87, 8388608
    s_lshr_b32 s97, s47, 3
    s_lshl_b32 s97, s97, 16
    s_and_b32 s47, s47, 7
    s_lshl_b32 s47, s47, 8
    s_add_u32 s97, s97, s47
    s_add_u32 s97, s97, 20971520
    s_and_b32 s82, s53, 0x7fff
    s_add_u32 s82, s82, 20971520
    s_lshl_b32 s83, s37, 15
    s_mul_i32 s47, s39, 520
    s_add_u32 s83, s83, s47
    s_mul_i32 s47, s39, 512
    s_add_u32 s55, s99, s47
    s_add_u32 s83, s83, 20971520
    s_lshl_b32 s80, s37, 2
    s_add_u32 s80, s80, s36
    s_lshr_b32 s86, s80, 3
    s_lshl_b32 s86, s86, 16
    s_and_b32 s47, s80, 6
    s_lshl_b32 s47, s47, 8
    s_add_u32 s86, s86, s47
    s_lshl_b32 s47, s40, 2
    s_add_u32 s86, s86, s47
    s_add_u32 s86, s86, 20971520
    s_lshl_b32 s101, s80, 16
    s_add_u32 s101, s101, 8388608
    s_lshr_b32 s81, s38, 3
    s_add_u32 m0, s45, 65536
    s_nop 0
    buffer_load_dwordx4 v8, s[28:31], 0 offen offset:0 lds
    s_mul_i32 s47, s81, 63
    s_xor_b32 s47, s47, s80
    s_add_u32 s48, s47, s81
    s_and_b32 s48, s48, 63
    s_and_b32 s88, s47, 1
    s_lshl_b32 s88, s88, 11
    s_lshr_b32 s47, s47, 1
    s_lshl_b32 s47, s47, 6
    s_add_u32 s88, s88, s47
    s_add_u32 s88, s88, 16777216
    s_and_b32 s92, s48, 1
    s_lshl_b32 s92, s92, 11
    s_lshr_b32 s48, s48, 1
    s_lshl_b32 s48, s48, 6
    s_add_u32 s92, s92, s48
    s_add_u32 s92, s92, 16777216
    s_lshl_b32 s47, s81, 17
    s_sub_u32 s47, 64512, s47
    s_add_u32 s89, s88, s47
    s_add_u32 s90, s89, s47
    s_add_u32 s91, s90, s47
    v_lshrrev_b32 v248, 3, v1
    v_lshrrev_b32 v249, 4, v1
    v_lshlrev_b32 v249, 1, v249
    v_and_b32 v250, 7, v1
    v_xor_b32 v249, v249, v250
    v_lshlrev_b32 v249, 4, v249
    v_lshl_add_u32 v237, v248, 11, v249
    v_lshrrev_b32 v248, 5, v1
    v_lshlrev_b32 v248, 11, v248
    v_bfe_u32 v249, v1, 2, 3
    buffer_load_dwordx4 v9, s[28:31], 0 offen offset:1024 lds
    s_sub_u32 s28, s28, 4096
    s_subb_u32 s29, s29, 0
    v_lshl_add_u32 v248, v249, 7, v248
    v_bfe_u32 v249, v1, 3, 2
    v_lshl_add_u32 v248, v249, 5, v248
    v_and_b32 v249, 3, v1
    v_lshl_add_u32 v240, v249, 3, v248
    s_lshl_b32 s100, s38, 7
    s_lshl_b32 s69, s36, 14
    s_add_u32 s69, s69, s100
    s_lshl_b32 s70, s36, 10
    s_mov_b32 s73, 0x80008000
    v_and_b32 v248, 31, v1
    v_cvt_f32_u32 v249, v248
    v_lshrrev_b32 v250, 5, v1
    v_cvt_f32_u32 v250, v250
    v_mul_f32 v250, 4.0, v250
    v_mul_f32 v101, 0x3d000000, v249
    v_mul_f32 v100, v250, v101
    v_bfe_i32 v102, v248, 0, 1
    v_and_b32 v102, s73, v102
    v_fmamk_f32 v104, v101, 0x00000000, v100
    v_fmamk_f32 v105, v101, 0x3f800000, v100
    v_cos_f32 v106, v104
    v_sin_f32 v108, v104
    v_cos_f32 v107, v105
    v_sin_f32 v109, v105
    v_cvt_pk_bf16_f32 v104, v106, v107
    v_cvt_pk_bf16_f32 v105, v108, v109
    v_xor_b32 v106, v102, v104
    v_xor_b32 v107, v102, v105
    v_accvgpr_write_b32 a48, v104
    s_add_u32 m0, s45, 73728
    s_nop 0
    buffer_load_dwordx4 v8, s[28:31], 0 offen offset:0 lds
    v_accvgpr_write_b32 a56, v105
    v_accvgpr_write_b32 a52, v106
    v_accvgpr_write_b32 a60, v107
    v_fmamk_f32 v110, v101, 0x40000000, v100
    v_fmamk_f32 v111, v101, 0x40400000, v100
    v_cos_f32 v112, v110
    v_sin_f32 v114, v110
    v_cos_f32 v113, v111
    v_sin_f32 v115, v111
    v_cvt_pk_bf16_f32 v110, v112, v113
    v_cvt_pk_bf16_f32 v111, v114, v115
    v_xor_b32 v112, v102, v110
    v_xor_b32 v113, v102, v111
    v_accvgpr_write_b32 a49, v110
    v_accvgpr_write_b32 a57, v111
    v_accvgpr_write_b32 a53, v112
    v_accvgpr_write_b32 a61, v113
    v_fmamk_f32 v116, v101, 0x41000000, v100
    v_fmamk_f32 v117, v101, 0x41100000, v100
    v_cos_f32 v118, v116
    v_sin_f32 v120, v116
    v_cos_f32 v119, v117
    v_sin_f32 v121, v117
    v_cvt_pk_bf16_f32 v116, v118, v119
    v_cvt_pk_bf16_f32 v117, v120, v121
    v_xor_b32 v118, v102, v116
    v_xor_b32 v119, v102, v117
    v_accvgpr_write_b32 a50, v116
    v_accvgpr_write_b32 a58, v117
    v_accvgpr_write_b32 a54, v118
    v_accvgpr_write_b32 a62, v119
    buffer_load_dwordx4 v9, s[28:31], 0 offen offset:1024 lds
    s_add_u32 s28, s28, 395264
    s_addc_u32 s29, s29, 0
    v_fmamk_f32 v122, v101, 0x41200000, v100
    v_fmamk_f32 v123, v101, 0x41300000, v100
    v_cos_f32 v124, v122
    v_sin_f32 v126, v122
    v_cos_f32 v125, v123
    v_sin_f32 v127, v123
    v_cvt_pk_bf16_f32 v122, v124, v125
    v_cvt_pk_bf16_f32 v123, v126, v127
    v_xor_b32 v124, v102, v122
    v_xor_b32 v125, v102, v123
    v_accvgpr_write_b32 a51, v122
    v_accvgpr_write_b32 a59, v123
    v_accvgpr_write_b32 a55, v124
    v_accvgpr_write_b32 a63, v125
    v_mul_f32 v101, 0x3d000000, v101
    v_mul_f32 v100, 0x3d000000, v100
    v_fmamk_f32 v52, v101, 0x00000000, v100
    v_cos_f32 v36, v52
    v_sin_f32 v52, v52
    v_fmamk_f32 v53, v101, 0x3f800000, v100
    v_cos_f32 v37, v53
    v_sin_f32 v53, v53
    v_fmamk_f32 v54, v101, 0x40000000, v100
    v_cos_f32 v38, v54
    v_sin_f32 v54, v54
    v_fmamk_f32 v55, v101, 0x40400000, v100
    v_cos_f32 v39, v55
    v_sin_f32 v55, v55
    v_fmamk_f32 v56, v101, 0x41000000, v100
    v_cos_f32 v40, v56
    v_sin_f32 v56, v56
    s_add_u32 m0, s44, 0
    s_nop 0
    buffer_load_dwordx4 v4, s[8:11], 0 offen offset:0 lds
    v_fmamk_f32 v57, v101, 0x41100000, v100
    v_cos_f32 v41, v57
    v_sin_f32 v57, v57
    v_fmamk_f32 v58, v101, 0x41200000, v100
    v_cos_f32 v42, v58
    v_sin_f32 v58, v58
    v_fmamk_f32 v59, v101, 0x41300000, v100
    v_cos_f32 v43, v59
    v_sin_f32 v59, v59
    v_fmamk_f32 v60, v101, 0x41800000, v100
    v_cos_f32 v44, v60
    v_sin_f32 v60, v60
    v_fmamk_f32 v61, v101, 0x41880000, v100
    v_cos_f32 v45, v61
    v_sin_f32 v61, v61
    v_fmamk_f32 v62, v101, 0x41900000, v100
    v_cos_f32 v46, v62
    v_sin_f32 v62, v62
    v_fmamk_f32 v63, v101, 0x41980000, v100
    v_cos_f32 v47, v63
    v_sin_f32 v63, v63
    v_fmamk_f32 v64, v101, 0x41c00000, v100
    v_cos_f32 v48, v64
    v_sin_f32 v64, v64
    v_fmamk_f32 v65, v101, 0x41c80000, v100
    v_cos_f32 v49, v65
    v_sin_f32 v65, v65
    v_fmamk_f32 v66, v101, 0x41d00000, v100
    v_cos_f32 v50, v66
    v_sin_f32 v66, v66
    buffer_load_dwordx4 v5, s[8:11], 0 offen offset:1024 lds
    v_fmamk_f32 v67, v101, 0x41d80000, v100
    v_cos_f32 v51, v67
    v_sin_f32 v67, v67
    v_lshrrev_b32 v251, 1, v248
    v_cvt_f32_u32 v101, v251
    v_mul_f32 v101, 0x3d000000, v101
    v_mul_f32 v100, v250, v101
    v_and_b32 v252, 1, v248
    v_cvt_f32_u32 v252, v252
    v_fmamk_f32 v100, v252, 0x3e800000, v100
    v_bfe_i32 v102, v251, 0, 1
    v_and_b32 v102, s73, v102
    v_fmamk_f32 v104, v101, 0x00000000, v100
    v_fmamk_f32 v105, v101, 0x3f800000, v100
    v_cos_f32 v106, v104
    v_sin_f32 v108, v104
    v_cos_f32 v107, v105
    v_sin_f32 v109, v105
    v_cvt_pk_bf16_f32 v20, v106, v107
    v_cvt_pk_bf16_f32 v28, v108, v109
    v_xor_b32 v24, v102, v20
    v_xor_b32 v32, v102, v28
    v_fmamk_f32 v110, v101, 0x40000000, v100
    v_fmamk_f32 v111, v101, 0x40400000, v100
    v_cos_f32 v112, v110
    v_sin_f32 v114, v110
    v_cos_f32 v113, v111
    v_sin_f32 v115, v111
    v_cvt_pk_bf16_f32 v21, v112, v113
    v_cvt_pk_bf16_f32 v29, v114, v115
    v_xor_b32 v25, v102, v21
    buffer_load_dwordx4 v6, s[8:11], 0 offen offset:2048 lds
    v_xor_b32 v33, v102, v29
    v_fmamk_f32 v116, v101, 0x41000000, v100
    v_fmamk_f32 v117, v101, 0x41100000, v100
    v_cos_f32 v118, v116
    v_sin_f32 v120, v116
    v_cos_f32 v119, v117
    v_sin_f32 v121, v117
    v_cvt_pk_bf16_f32 v22, v118, v119
    v_cvt_pk_bf16_f32 v30, v120, v121
    v_xor_b32 v26, v102, v22
    v_xor_b32 v34, v102, v30
    v_fmamk_f32 v122, v101, 0x41200000, v100
    v_fmamk_f32 v123, v101, 0x41300000, v100
    v_cos_f32 v124, v122
    v_sin_f32 v126, v122
    v_cos_f32 v125, v123
    v_sin_f32 v127, v123
    v_cvt_pk_bf16_f32 v23, v124, v125
    v_cvt_pk_bf16_f32 v31, v126, v127
    v_xor_b32 v27, v102, v23
    v_xor_b32 v35, v102, v31
    v_and_b32 v248, 15, v1
    v_lshrrev_b32 v249, 1, v248
    v_lshrrev_b32 v250, 4, v1
    v_xor_b32 v249, v249, v250
    v_lshlrev_b32 v249, 4, v249
    v_lshl_add_u32 v11, v248, 7, v249
    s_lshl_b32 s47, s39, 13
    v_add_u32 v11, s47, v11
    v_xor_b32 v12, 64, v11
    v_lshlrev_b32 v248, 10, v250
    buffer_load_dwordx4 v7, s[8:11], 0 offen offset:3072 lds
    s_add_u32 s8, s8, 128
    s_addc_u32 s9, s9, 0
    v_bfe_u32 v249, v1, 2, 2
    v_lshl_add_u32 v248, v249, 7, v248
    v_bfe_u32 v249, v1, 3, 2
    s_lshl_b32 s47, s40, 1
    v_xor_b32 v249, s47, v249
    v_lshl_add_u32 v248, v249, 5, v248
    v_and_b32 v249, 3, v1
    v_lshl_add_u32 v248, v249, 3, v248
    v_add_u32 v13, 131072, v248
    v_xor_b32 v14, 32, v13
    v_add_u32 v15, 65536, v248
    v_xor_b32 v16, 32, v15
    v_lshrrev_b32 v253, 5, v1
    v_lshlrev_b32 v253, 8, v253
    v_bfe_u32 v249, v1, 2, 2
    v_lshl_add_u32 v253, v249, 6, v253
    v_bfe_u32 v249, v1, 4, 1
    v_lshl_add_u32 v253, v249, 5, v253
    v_and_b32 v249, 3, v1
    v_lshl_add_u32 v253, v249, 3, v253
    v_add_u32 v253, s51, v253
    s_add_u32 s47, s44, 49152
    v_add_u32 v254, s47, v3
    s_lshl_b32 s47, s36, 10
    s_add_u32 s47, s47, 49152
    v_lshlrev_b32 v233, 2, v1
    v_add_u32 v252, s47, v233
    s_lshl_b32 s52, s36, 20
    s_lshl_b32 s47, s2, 7
    s_add_u32 s52, s52, s47
    s_add_u32 s52, s52, 12582912
    s_mov_b32 exec_lo, 4294967295
    s_mov_b32 exec_hi, 4294967295
    buffer_load_dword v246, v247, s[12:15], s95 offen
    s_mov_b64 exec, -1
    s_mov_b32 s3, 1
    s_cmp_lg_u32 s36, 0
    s_cbranch_scc1 L_walkn_2
    s_call_b64 s[78:79], L_pad_2
    s_branch L_walk_1
L_walkn_2:
    s_cmp_lg_u32 s36, 1
    s_cbranch_scc1 L_walkn_3
    s_call_b64 s[78:79], L_pad_3
    s_branch L_walk_1
L_walkn_3:
    s_cmp_lg_u32 s36, 2
    s_cbranch_scc1 L_walkn_4
    s_call_b64 s[78:79], L_pad_4
    s_branch L_walk_1
L_walkn_4:
    s_call_b64 s[78:79], L_pad_5
L_walk_1:
    s_mov_b32 s3, 0
    s_mov_b32 s3, 1
    s_cmp_lg_u32 s36, 0
    s_cbranch_scc1 L_walkn_7
    s_call_b64 s[78:79], L_pad_6
    s_branch L_walk_6
L_walkret:
    s_setpc_b64 s[78:79]
L_walkn_7:
    s_cmp_lg_u32 s36, 1
    s_cbranch_scc1 L_walkn_8
    s_call_b64 s[78:79], L_pad_7
    s_branch L_walk_6
L_walkn_8:
    s_cmp_lg_u32 s36, 2
    s_cbranch_scc1 L_walkn_9
    s_call_b64 s[78:79], L_pad_8
    s_branch L_walk_6
L_walkn_9:
    s_call_b64 s[78:79], L_pad_9
L_walk_6:
    s_mov_b32 s3, 0
    s_waitcnt vmcnt(11)
    ds_read_b64_tr_b16 v[68:69], v253 offset:0
    ds_read_b64_tr_b16 v[70:71], v253 offset:512
    ds_read_b64_tr_b16 v[72:73], v253 offset:1024
    ds_read_b64_tr_b16 v[74:75], v253 offset:1536
    ds_read_b64_tr_b16 v[76:77], v253 offset:2048
    ds_read_b64_tr_b16 v[78:79], v253 offset:2560
    ds_read_b64_tr_b16 v[80:81], v253 offset:3072
    ds_read_b64_tr_b16 v[82:83], v253 offset:3584
    ds_read_b64_tr_b16 v[84:85], v253 offset:4096
    ds_read_b64_tr_b16 v[86:87], v253 offset:4608
    ds_read_b64_tr_b16 v[88:89], v253 offset:5120
    ds_read_b64_tr_b16 v[90:91], v253 offset:5632
    s_waitcnt lgkmcnt(10)
    v_mfma_f32_32x32x16_bf16 v[100:115], v[68:71], a[48:51], 0
    s_waitcnt lgkmcnt(8)
    v_mfma_f32_32x32x16_bf16 v[100:115], v[72:75], a[52:55], v[100:115]
    v_mfma_f32_32x32x16_bf16 v[116:131], v[68:71], a[56:59], 0
    v_mfma_f32_32x32x16_bf16 v[116:131], v[72:75], a[60:63], v[116:131]
    s_waitcnt lgkmcnt(6)
    v_mfma_f32_32x32x16_bf16 v[132:147], v[76:79], a[48:51], 0
    s_nop 7
    v_sub_f32 v248, v100, v101
    v_add_f32 v248, v248, v102
    v_sub_f32 v248, v248, v103
    v_add_f32 v248, v248, v104
    v_sub_f32 v248, v248, v105
    v_add_f32 v248, v248, v106
    s_waitcnt lgkmcnt(4)
    v_mfma_f32_32x32x16_bf16 v[132:147], v[80:83], a[52:55], v[132:147]
    v_sub_f32 v248, v248, v107
    v_add_f32 v248, v248, v108
    v_sub_f32 v248, v248, v109
    v_add_f32 v248, v248, v110
    v_sub_f32 v248, v248, v111
    v_add_f32 v248, v248, v112
    v_mfma_f32_32x32x16_bf16 v[148:163], v[76:79], a[56:59], 0
    v_sub_f32 v248, v248, v113
    v_add_f32 v248, v248, v114
    v_sub_f32 v248, v248, v115
    v_mfma_f32_32x32x16_bf16 v[148:163], v[80:83], a[60:63], v[148:163]
    s_waitcnt lgkmcnt(3)
    v_dot2_f32_bf16 v17, v68, v84, 0
    v_dot2_f32_bf16 v18, v76, v84, 0
    v_dot2_f32_bf16 v17, v69, v85, v17
    v_dot2_f32_bf16 v18, v77, v85, v18
    s_waitcnt lgkmcnt(2)
    v_dot2_f32_bf16 v17, v70, v86, v17
    v_dot2_f32_bf16 v18, v78, v86, v18
    v_dot2_f32_bf16 v17, v71, v87, v17
    v_dot2_f32_bf16 v18, v79, v87, v18
    s_waitcnt lgkmcnt(1)
    v_dot2_f32_bf16 v17, v72, v88, v17
    v_dot2_f32_bf16 v18, v80, v88, v18
    v_dot2_f32_bf16 v17, v73, v89, v17
    v_dot2_f32_bf16 v18, v81, v89, v18
    s_waitcnt lgkmcnt(0)
    v_dot2_f32_bf16 v17, v74, v90, v17
    v_dot2_f32_bf16 v18, v82, v90, v18
    v_dot2_f32_bf16 v17, v75, v91, v17
    v_dot2_f32_bf16 v18, v83, v91, v18
    v_pk_mul_f32 v[94:95], v[100:101], v[52:53]
    v_pk_mul_f32 v[92:93], v[116:117], v[52:53]
    v_pk_fma_f32 v[94:95], v[116:117], v[36:37], v[94:95] neg_lo:[1,0,1] neg_hi:[1,0,1]
    v_pk_fma_f32 v[92:93], v[100:101], v[36:37], v[92:93] neg_lo:[0,0,1] neg_hi:[0,0,1]
    v_cvt_pk_bf16_f32 v76, v94, v95
    v_cvt_pk_bf16_f32 v68, v92, v93
    v_pk_mul_f32 v[98:99], v[102:103], v[54:55]
    v_pk_mul_f32 v[96:97], v[118:119], v[54:55]
    v_pk_fma_f32 v[98:99], v[118:119], v[38:39], v[98:99] neg_lo:[1,0,1] neg_hi:[1,0,1]
    v_pk_fma_f32 v[96:97], v[102:103], v[38:39], v[96:97] neg_lo:[0,0,1] neg_hi:[0,0,1]
    v_cvt_pk_bf16_f32 v77, v98, v99
    v_cvt_pk_bf16_f32 v69, v96, v97
    s_add_u32 m0, s45, 147456
    s_nop 0
    buffer_load_dwordx4 v8, s[28:31], 0 offen offset:0 lds
    v_pk_mul_f32 v[94:95], v[104:105], v[56:57]
    v_pk_mul_f32 v[92:93], v[120:121], v[56:57]
    v_pk_fma_f32 v[94:95], v[120:121], v[40:41], v[94:95] neg_lo:[1,0,1] neg_hi:[1,0,1]
    v_pk_fma_f32 v[92:93], v[104:105], v[40:41], v[92:93] neg_lo:[0,0,1] neg_hi:[0,0,1]
    v_cvt_pk_bf16_f32 v78, v94, v95
    v_cvt_pk_bf16_f32 v70, v92, v93
    buffer_load_dwordx4 v9, s[28:31], 0 offen offset:1024 lds
    s_add_u32 s28, s28, 2048
    s_addc_u32 s29, s29, 0
    v_pk_mul_f32 v[98:99], v[106:107], v[58:59]
    v_pk_mul_f32 v[96:97], v[122:123], v[58:59]
    v_pk_fma_f32 v[98:99], v[122:123], v[42:43], v[98:99] neg_lo:[1,0,1] neg_hi:[1,0,1]
    v_pk_fma_f32 v[96:97], v[106:107], v[42:43], v[96:97] neg_lo:[0,0,1] neg_hi:[0,0,1]
    v_cvt_pk_bf16_f32 v79, v98, v99
    v_cvt_pk_bf16_f32 v71, v96, v97
    s_add_u32 m0, s45, 81920
    s_nop 0
    buffer_load_dwordx4 v8, s[28:31], 0 offen offset:0 lds
    v_pk_mul_f32 v[94:95], v[108:109], v[60:61]
    v_pk_mul_f32 v[92:93], v[124:125], v[60:61]
    v_pk_fma_f32 v[94:95], v[124:125], v[44:45], v[94:95] neg_lo:[1,0,1] neg_hi:[1,0,1]
    v_pk_fma_f32 v[92:93], v[108:109], v[44:45], v[92:93] neg_lo:[0,0,1] neg_hi:[0,0,1]
    v_cvt_pk_bf16_f32 v80, v94, v95
    v_cvt_pk_bf16_f32 v72, v92, v93
    buffer_load_dwordx4 v9, s[28:31], 0 offen offset:1024 lds
    s_sub_u32 s28, s28, 4096
    s_subb_u32 s29, s29, 0
    v_pk_mul_f32 v[98:99], v[110:111], v[62:63]
    v_pk_mul_f32 v[96:97], v[126:127], v[62:63]
    v_pk_fma_f32 v[98:99], v[126:127], v[46:47], v[98:99] neg_lo:[1,0,1] neg_hi:[1,0,1]
    v_pk_fma_f32 v[96:97], v[110:111], v[46:47], v[96:97] neg_lo:[0,0,1] neg_hi:[0,0,1]
    v_cvt_pk_bf16_f32 v81, v98, v99
    v_cvt_pk_bf16_f32 v73, v96, v97
    s_add_u32 m0, s45, 90112
    s_nop 0
    buffer_load_dwordx4 v8, s[28:31], 0 offen offset:0 lds
    v_pk_mul_f32 v[94:95], v[112:113], v[64:65]
    v_pk_mul_f32 v[92:93], v[128:129], v[64:65]
    v_pk_fma_f32 v[94:95], v[128:129], v[48:49], v[94:95] neg_lo:[1,0,1] neg_hi:[1,0,1]
    v_pk_fma_f32 v[92:93], v[112:113], v[48:49], v[92:93] neg_lo:[0,0,1] neg_hi:[0,0,1]
    v_cvt_pk_bf16_f32 v82, v94, v95
    v_cvt_pk_bf16_f32 v74, v92, v93
    buffer_load_dwordx4 v9, s[28:31], 0 offen offset:1024 lds
    s_add_u32 s28, s28, 395264
    s_addc_u32 s29, s29, 0
    v_pk_mul_f32 v[98:99], v[114:115], v[66:67]
    v_pk_mul_f32 v[96:97], v[130:131], v[66:67]
    v_pk_fma_f32 v[98:99], v[130:131], v[50:51], v[98:99] neg_lo:[1,0,1] neg_hi:[1,0,1]
    v_pk_fma_f32 v[96:97], v[114:115], v[50:51], v[96:97] neg_lo:[0,0,1] neg_hi:[0,0,1]
    v_cvt_pk_bf16_f32 v83, v98, v99
    v_cvt_pk_bf16_f32 v75, v96, v97
    s_add_u32 m0, s44, 16384
    s_nop 0
    buffer_load_dwordx4 v4, s[8:11], 0 offen offset:0 lds
    v_mfma_f32_32x32x16_bf16 v[164:179], v[20:23], v[68:71], 0
    v_permlane32_swap_b32 v17, v18
    v_add_f32 v17, v17, v18
    v_sub_f32 v249, v132, v133
    v_add_f32 v249, v249, v134
    v_add_f32_dpp v17, v17, v17 quad_perm:[1,0,3,2] row_mask:0xf bank_mask:0xf
    v_sub_f32 v249, v249, v135
    v_mfma_f32_32x32x16_bf16 v[164:179], v[28:31], v[76:79], v[164:179]
    v_add_f32 v249, v249, v136
    v_add_f32_dpp v17, v17, v17 quad_perm:[2,3,0,1] row_mask:0xf bank_mask:0xf
    v_sub_f32 v249, v249, v137
    v_add_f32 v249, v249, v138
    v_add_f32_dpp v17, v17, v17 row_half_mirror row_mask:0xf bank_mask:0xf
    v_sub_f32 v249, v249, v139
    v_mfma_f32_32x32x16_bf16 v[164:179], v[24:27], v[72:75], v[164:179]
    v_add_f32 v249, v249, v140
    v_add_f32_dpp v17, v17, v17 row_mirror row_mask:0xf bank_mask:0xf
    v_mov_b32 v18, v17
    v_sub_f32 v249, v249, v141
    v_add_f32 v249, v249, v142
    v_permlane16_swap_b32 v17, v18
    v_mfma_f32_32x32x16_bf16 v[164:179], v[32:35], v[80:83], v[164:179]
    v_add_f32 v17, v17, v18
    v_sub_f32 v249, v249, v143
    v_add_f32 v249, v249, v144
    v_sub_f32 v249, v249, v145
    v_add_f32 v249, v249, v146
    v_sub_f32 v249, v249, v147
    v_pk_mul_f32 v[94:95], v[132:133], v[52:53]
    v_pk_mul_f32 v[92:93], v[148:149], v[52:53]
    v_pk_fma_f32 v[94:95], v[148:149], v[36:37], v[94:95] neg_lo:[1,0,1] neg_hi:[1,0,1]
    v_pk_fma_f32 v[92:93], v[132:133], v[36:37], v[92:93] neg_lo:[0,0,1] neg_hi:[0,0,1]
    v_cvt_pk_bf16_f32 v108, v94, v95
    v_cvt_pk_bf16_f32 v100, v92, v93
    v_pk_mul_f32 v[98:99], v[134:135], v[54:55]
    v_pk_mul_f32 v[96:97], v[150:151], v[54:55]
    v_pk_fma_f32 v[98:99], v[150:151], v[38:39], v[98:99] neg_lo:[1,0,1] neg_hi:[1,0,1]
    v_pk_fma_f32 v[96:97], v[134:135], v[38:39], v[96:97] neg_lo:[0,0,1] neg_hi:[0,0,1]
    v_cvt_pk_bf16_f32 v109, v98, v99
    v_cvt_pk_bf16_f32 v101, v96, v97
    buffer_load_dwordx4 v5, s[8:11], 0 offen offset:1024 lds
    v_pk_mul_f32 v[94:95], v[136:137], v[56:57]
    v_pk_mul_f32 v[92:93], v[152:153], v[56:57]
    v_pk_fma_f32 v[94:95], v[152:153], v[40:41], v[94:95] neg_lo:[1,0,1] neg_hi:[1,0,1]
    v_pk_fma_f32 v[92:93], v[136:137], v[40:41], v[92:93] neg_lo:[0,0,1] neg_hi:[0,0,1]
    v_cvt_pk_bf16_f32 v110, v94, v95
    v_cvt_pk_bf16_f32 v102, v92, v93
    buffer_load_dwordx4 v6, s[8:11], 0 offen offset:2048 lds
    v_pk_mul_f32 v[98:99], v[138:139], v[58:59]
    v_pk_mul_f32 v[96:97], v[154:155], v[58:59]
    v_pk_fma_f32 v[98:99], v[154:155], v[42:43], v[98:99] neg_lo:[1,0,1] neg_hi:[1,0,1]
    v_pk_fma_f32 v[96:97], v[138:139], v[42:43], v[96:97] neg_lo:[0,0,1] neg_hi:[0,0,1]
    v_cvt_pk_bf16_f32 v111, v98, v99
    v_cvt_pk_bf16_f32 v103, v96, v97
    buffer_load_dwordx4 v7, s[8:11], 0 offen offset:3072 lds
    s_add_u32 s8, s8, 128
    s_addc_u32 s9, s9, 0
    v_pk_mul_f32 v[94:95], v[140:141], v[60:61]
    v_pk_mul_f32 v[92:93], v[156:157], v[60:61]
    v_pk_fma_f32 v[94:95], v[156:157], v[44:45], v[94:95] neg_lo:[1,0,1] neg_hi:[1,0,1]
    v_pk_fma_f32 v[92:93], v[140:141], v[44:45], v[92:93] neg_lo:[0,0,1] neg_hi:[0,0,1]
    v_cvt_pk_bf16_f32 v112, v94, v95
    v_cvt_pk_bf16_f32 v104, v92, v93
    s_add_u32 m0, s44, 32768
    s_nop 0
    buffer_load_dwordx4 v4, s[8:11], 0 offen offset:0 lds
    v_pk_mul_f32 v[98:99], v[142:143], v[62:63]
    v_pk_mul_f32 v[96:97], v[158:159], v[62:63]
    v_pk_fma_f32 v[98:99], v[158:159], v[46:47], v[98:99] neg_lo:[1,0,1] neg_hi:[1,0,1]
    v_pk_fma_f32 v[96:97], v[142:143], v[46:47], v[96:97] neg_lo:[0,0,1] neg_hi:[0,0,1]
    v_cvt_pk_bf16_f32 v113, v98, v99
    v_cvt_pk_bf16_f32 v105, v96, v97
    buffer_load_dwordx4 v5, s[8:11], 0 offen offset:1024 lds
    v_pk_mul_f32 v[94:95], v[144:145], v[64:65]
    v_pk_mul_f32 v[92:93], v[160:161], v[64:65]
    v_pk_fma_f32 v[94:95], v[160:161], v[48:49], v[94:95] neg_lo:[1,0,1] neg_hi:[1,0,1]
    v_pk_fma_f32 v[92:93], v[144:145], v[48:49], v[92:93] neg_lo:[0,0,1] neg_hi:[0,0,1]
    v_cvt_pk_bf16_f32 v114, v94, v95
    v_cvt_pk_bf16_f32 v106, v92, v93
    buffer_load_dwordx4 v6, s[8:11], 0 offen offset:2048 lds
    v_pk_mul_f32 v[98:99], v[146:147], v[66:67]
    v_pk_mul_f32 v[96:97], v[162:163], v[66:67]
    v_pk_fma_f32 v[98:99], v[162:163], v[50:51], v[98:99] neg_lo:[1,0,1] neg_hi:[1,0,1]
    v_pk_fma_f32 v[96:97], v[146:147], v[50:51], v[96:97] neg_lo:[0,0,1] neg_hi:[0,0,1]
    v_cvt_pk_bf16_f32 v115, v98, v99
    v_cvt_pk_bf16_f32 v107, v96, v97
    buffer_load_dwordx4 v7, s[8:11], 0 offen offset:3072 lds
    s_add_u32 s8, s8, 128
    s_addc_u32 s9, s9, 0
    v_mfma_f32_32x32x16_bf16 v[180:195], v[20:23], v[100:103], 0
    v_cvt_pk_bf16_f32 v17, v17, v17
    v_and_b32 v17, 0xffff0000, v17
    v_mul_f32 v17, 0xbfb8aa3b, v17
    v_exp_f32 v17, v17
    v_permlane32_swap_b32 v248, v249
    v_mfma_f32_32x32x16_bf16 v[180:195], v[28:31], v[108:111], v[180:195]
    v_add_f32 v17, 1.0, v17
    v_rcp_f32 v17, v17
    v_add_f32 v248, v248, v249
    v_cvt_pk_bf16_f32 v17, v17, v17
    v_mov_b64 v[238:239], 0
    v_mfma_f32_32x32x16_bf16 v[180:195], v[24:27], v[104:107], v[180:195]
    v_readlane_b32 s47, v248, 0
    v_readlane_b32 s48, v248, 32
    v_and_b32 v17, 0xffff0000, v17
    s_nop 0
    v_readlane_b32 s49, v17, 0
    v_readlane_b32 s50, v17, 32
    v_lshlrev_b32 v17, 3, v1
    s_bfe_u32 s46, s2, 0x20002
    v_mfma_f32_32x32x16_bf16 v[180:195], v[32:35], v[112:115], v[180:195]
    v_and_b32 v250, 7, v1
    v_xor_b32 v250, s46, v250
    v_lshlrev_b32 v250, 4, v250
    v_lshrrev_b32 v251, 3, v1
    v_lshl_add_u32 v18, v251, 15, v250
    v_writelane_b32 v238, s49, 0
    v_writelane_b32 v239, s50, 0
    v_writelane_b32 v165, s47, 0
    s_nop 3
    v_writelane_b32 v181, s48, 0
    buffer_store_dwordx2 v[238:239], v17, s[16:19], s53 offen sc1
    v_cvt_pk_bf16_f32 v68, v164, v180
    v_cvt_pk_bf16_f32 v69, v165, v181
    v_cvt_pk_bf16_f32 v70, v166, v182
    v_cvt_pk_bf16_f32 v71, v167, v183
    ds_write_b128 v254, v[68:71] offset:0
    v_cvt_pk_bf16_f32 v72, v168, v184
    v_cvt_pk_bf16_f32 v73, v169, v185
    v_cvt_pk_bf16_f32 v74, v170, v186
    v_cvt_pk_bf16_f32 v75, v171, v187
    ds_write_b128 v254, v[72:75] offset:1024
    v_cvt_pk_bf16_f32 v76, v172, v188
    v_cvt_pk_bf16_f32 v77, v173, v189
    v_cvt_pk_bf16_f32 v78, v174, v190
    v_cvt_pk_bf16_f32 v79, v175, v191
    ds_write_b128 v254, v[76:79] offset:2048
    v_cvt_pk_bf16_f32 v80, v176, v192
    v_cvt_pk_bf16_f32 v81, v177, v193
    v_cvt_pk_bf16_f32 v82, v178, v194
    v_cvt_pk_bf16_f32 v83, v179, v195
    ds_write_b128 v254, v[80:83] offset:3072
    s_waitcnt lgkmcnt(0)
    s_barrier
    ds_read2st64_b32 a[208:209], v252 offset0:0 offset1:16
    ds_read2st64_b32 a[210:211], v252 offset0:32 offset1:48
    ds_read2st64_b32 a[212:213], v252 offset0:1 offset1:17
    ds_read2st64_b32 a[214:215], v252 offset0:33 offset1:49
    ds_read2st64_b32 a[216:217], v252 offset0:2 offset1:18
    ds_read2st64_b32 a[218:219], v252 offset0:34 offset1:50
    ds_read2st64_b32 a[220:221], v252 offset0:3 offset1:19
    ds_read2st64_b32 a[222:223], v252 offset0:35 offset1:51
    s_waitcnt lgkmcnt(6)
    buffer_store_dwordx4 a[208:211], v18, s[16:19], s52 offen sc1
    s_add_u32 s52, s52, 262144
    s_waitcnt lgkmcnt(4)
    buffer_store_dwordx4 a[212:215], v18, s[16:19], s52 offen sc1
    s_add_u32 s52, s52, 262144
    s_waitcnt lgkmcnt(2)
    buffer_store_dwordx4 a[216:219], v18, s[16:19], s52 offen sc1
    s_add_u32 s52, s52, 262144
    s_waitcnt lgkmcnt(0)
    buffer_store_dwordx4 a[220:223], v18, s[16:19], s52 offen sc1
    s_waitcnt vmcnt(20) lgkmcnt(0)
    s_barrier
    ds_read_b128 a[96:99], v11 offset:0
    ds_read_b64_tr_b16 a[128:129], v13 offset:8192
    ds_read_b64_tr_b16 a[130:131], v13 offset:8704
    ds_read_b128 a[100:103], v12 offset:0
    ds_read_b64_tr_b16 a[132:133], v13 offset:12288
    ds_read_b64_tr_b16 a[134:135], v13 offset:12800
    ds_read_b128 a[108:111], v12 offset:2048
    ds_read_b128 a[104:107], v11 offset:2048
    ds_read_b128 a[112:115], v11 offset:4096
    ds_read_b128 a[116:119], v12 offset:4096
    ds_read_b128 a[124:127], v12 offset:6144
    ds_read_b128 a[120:123], v11 offset:6144
    ds_read_b64_tr_b16 a[136:137], v14 offset:8192
    ds_read_b64_tr_b16 a[138:139], v14 offset:8704
    ds_read_b64_tr_b16 a[140:141], v14 offset:12288
    ds_read_b64_tr_b16 a[142:143], v14 offset:12800
    s_waitcnt lgkmcnt(9)
    v_mfma_f32_16x16x32_bf16 v[108:111], a[128:131], a[96:99], 0
    ds_read_b64_tr_b16 a[144:145], v15 offset:0
    s_add_u32 m0, s45, 155648
    v_mfma_f32_16x16x32_bf16 v[108:111], a[132:135], a[100:103], v[108:111]
    buffer_load_dwordx4 v8, s[28:31], 0 offen offset:0 lds
    s_and_b32 s46, s2, 63
    v_mfma_f32_16x16x32_bf16 v[132:135], a[132:135], a[108:111], 0
    ds_read_b64_tr_b16 a[146:147], v15 offset:512
    s_waitcnt lgkmcnt(4)
    v_mfma_f32_16x16x32_bf16 v[132:135], a[128:131], a[104:107], v[132:135]
    ds_read_b64_tr_b16 a[148:149], v15 offset:4096
    s_lshl_b32 s46, s46, 2
    v_mfma_f32_16x16x32_bf16 v[156:159], a[128:131], a[112:115], 0
    ds_read_b64_tr_b16 a[150:151], v15 offset:4608
    s_lshr_b32 s93, s2, 6
    v_mfma_f32_16x16x32_bf16 v[156:159], a[132:135], a[116:119], v[156:159]
    ds_read_b64_tr_b16 a[152:153], v16 offset:0
    s_lshl_b32 s94, s36, 4
    v_mfma_f32_16x16x32_bf16 v[180:183], a[132:135], a[124:127], 0
    buffer_load_dwordx4 v9, s[28:31], 0 offen offset:1024 lds
    s_add_u32 s28, s28, 2048
    v_mfma_f32_16x16x32_bf16 v[180:183], a[128:131], a[120:123], v[180:183]
    ds_read_b64_tr_b16 a[154:155], v16 offset:512
    s_addc_u32 s29, s29, 0
    v_mfma_f32_16x16x32_bf16 v[184:187], a[136:139], a[120:123], 0
    ds_read_b64_tr_b16 a[156:157], v16 offset:4096
    s_waitcnt lgkmcnt(3)
    v_mfma_f32_16x16x32_bf16 v[184:187], a[140:143], a[124:127], v[184:187]
    ds_read_b64_tr_b16 a[158:159], v16 offset:4608
    s_add_u32 m0, s45, 98304
    v_mfma_f32_16x16x32_bf16 v[160:163], a[140:143], a[116:119], 0
    buffer_load_dwordx4 v8, s[28:31], 0 offen offset:0 lds
    s_add_u32 s93, s93, s94
    v_mfma_f32_16x16x32_bf16 v[160:163], a[136:139], a[112:115], v[160:163]
    ds_read_b64_tr_b16 a[160:161], v15 offset:8192
    v_lshrrev_b32 v254, 2, v1
    v_mfma_f32_16x16x32_bf16 v[136:139], a[136:139], a[104:107], 0
    ds_read_b64_tr_b16 a[162:163], v15 offset:8704
    v_lshlrev_b32 v254, 7, v254
    v_mfma_f32_16x16x32_bf16 v[136:139], a[140:143], a[108:111], v[136:139]
    ds_read_b64_tr_b16 a[164:165], v15 offset:12288
    v_and_b32 v253, 3, v1
    v_mfma_f32_16x16x32_bf16 v[112:115], a[140:143], a[100:103], 0
    ds_read_b64_tr_b16 a[166:167], v15 offset:12800
    v_lshl_add_u32 v254, v253, 4, v254
    v_mfma_f32_16x16x32_bf16 v[112:115], a[136:139], a[96:99], v[112:115]
    buffer_load_dwordx4 v9, s[28:31], 0 offen offset:1024 lds
    s_sub_u32 s28, s28, 4096
    v_mfma_f32_16x16x32_bf16 v[116:119], a[96:99], a[144:147], 0
    ds_read_b64_tr_b16 a[168:169], v16 offset:8192
    s_subb_u32 s29, s29, 0
    v_mfma_f32_16x16x32_bf16 v[116:119], a[100:103], a[148:151], v[116:119]
    ds_read_b64_tr_b16 a[170:171], v16 offset:8704
    s_lshl_b32 s50, s40, 5
    v_mfma_f32_16x16x32_bf16 v[140:143], a[108:111], a[148:151], 0
    ds_read_b64_tr_b16 a[172:173], v16 offset:12288
    s_add_u32 m0, s45, 106496
    v_mfma_f32_16x16x32_bf16 v[140:143], a[104:107], a[144:147], v[140:143]
    buffer_load_dwordx4 v8, s[28:31], 0 offen offset:0 lds
    v_and_b32 v23, 31, v1
    v_mfma_f32_16x16x32_bf16 v[164:167], a[112:115], a[144:147], 0
    ds_read_b64_tr_b16 a[174:175], v16 offset:12800
    v_mfma_f32_16x16x32_bf16 v[164:167], a[116:119], a[148:151], v[164:167]
    v_mfma_f32_16x16x32_bf16 v[188:191], a[124:127], a[148:151], 0
    v_mfma_f32_16x16x32_bf16 v[188:191], a[120:123], a[144:147], v[188:191]
    buffer_load_dwordx4 v9, s[28:31], 0 offen offset:1024 lds
    s_add_u32 s28, s28, 395264
    s_waitcnt lgkmcnt(1)
    v_mfma_f32_16x16x32_bf16 v[192:195], a[120:123], a[152:155], 0
    s_waitcnt vmcnt(15) lgkmcnt(0)
    s_barrier
    ds_read_b128 a[64:67], v11 offset:16384
    s_addc_u32 s29, s29, 0
    v_mfma_f32_16x16x32_bf16 v[192:195], a[124:127], a[156:159], v[192:195]
    ds_read_b64_tr_b16 a[128:129], v13 offset:16384
    v_mfma_f32_16x16x32_bf16 v[168:171], a[116:119], a[156:159], 0
    ds_read_b64_tr_b16 a[130:131], v13 offset:16896
    v_mfma_f32_16x16x32_bf16 v[168:171], a[112:115], a[152:155], v[168:171]
    ds_read_b128 a[68:71], v12 offset:16384
    s_add_u32 m0, s44, 49152
    v_mfma_f32_16x16x32_bf16 v[144:147], a[104:107], a[152:155], 0
    buffer_load_dwordx4 v4, s[8:11], 0 offen offset:0 lds
    v_mfma_f32_16x16x32_bf16 v[144:147], a[108:111], a[156:159], v[144:147]
    ds_read_b64_tr_b16 a[132:133], v13 offset:20480
    v_mfma_f32_16x16x32_bf16 v[120:123], a[100:103], a[156:159], 0
    ds_read_b64_tr_b16 a[134:135], v13 offset:20992
    v_mfma_f32_16x16x32_bf16 v[120:123], a[96:99], a[152:155], v[120:123]
    ds_read_b128 a[76:79], v12 offset:18432
    v_mfma_f32_16x16x32_bf16 v[100:103], a[160:163], a[96:99], 0
    buffer_load_dwordx4 v5, s[8:11], 0 offen offset:1024 lds
    v_mfma_f32_16x16x32_bf16 v[100:103], a[164:167], a[100:103], v[100:103]
    ds_read_b128 a[72:75], v11 offset:18432
    v_add_u32 v23, s50, v23
    v_mfma_f32_16x16x32_bf16 v[124:127], a[164:167], a[108:111], 0
    ds_read_b128 a[80:83], v11 offset:20480
    v_cvt_f32_u32 v23, v23
    v_mfma_f32_16x16x32_bf16 v[124:127], a[160:163], a[104:107], v[124:127]
    ds_read_b128 a[84:87], v12 offset:20480
    v_mul_f32 v21, 0x3a000000, v23
    v_mfma_f32_16x16x32_bf16 v[148:151], a[160:163], a[112:115], 0
    ds_read_b128 a[92:95], v12 offset:22528
    v_lshrrev_b32 v23, 5, v1
    v_mfma_f32_16x16x32_bf16 v[148:151], a[164:167], a[116:119], v[148:151]
    buffer_load_dwordx4 v6, s[8:11], 0 offen offset:2048 lds
    v_cvt_f32_u32 v23, v23
    v_mfma_f32_16x16x32_bf16 v[172:175], a[164:167], a[124:127], 0
    ds_read_b128 a[88:91], v11 offset:22528
    v_mul_f32 v23, 4.0, v23
    v_mfma_f32_16x16x32_bf16 v[172:175], a[160:163], a[120:123], v[172:175]
    ds_read_b64_tr_b16 a[136:137], v14 offset:16384
    v_mul_f32 v20, v23, v21
    v_mfma_f32_16x16x32_bf16 v[176:179], a[168:171], a[120:123], 0
    ds_read_b64_tr_b16 a[138:139], v14 offset:16896
    v_fmamk_f32 v212, v21, 0x00000000, v20
    v_mfma_f32_16x16x32_bf16 v[176:179], a[172:175], a[124:127], v[176:179]
    buffer_load_dwordx4 v7, s[8:11], 0 offen offset:3072 lds
    s_add_u32 s8, s8, 128
    v_mfma_f32_16x16x32_bf16 v[152:155], a[172:175], a[116:119], 0
    ds_read_b64_tr_b16 a[140:141], v14 offset:20480
    s_addc_u32 s9, s9, 0
    v_mfma_f32_16x16x32_bf16 v[152:155], a[168:171], a[112:115], v[152:155]
    ds_read_b64_tr_b16 a[142:143], v14 offset:20992
    v_cos_f32 v196, v212
    v_mfma_f32_16x16x32_bf16 v[128:131], a[168:171], a[104:107], 0
    s_add_u32 m0, s45, 131072
    v_sin_f32 v212, v212
    v_mfma_f32_16x16x32_bf16 v[128:131], a[172:175], a[108:111], v[128:131]
    buffer_load_dwordx4 v8, s[28:31], 0 offen offset:0 lds
    v_fmamk_f32 v213, v21, 0x3f800000, v20
    v_mfma_f32_16x16x32_bf16 v[104:107], a[172:175], a[100:103], 0
    v_cos_f32 v197, v213
    v_mfma_f32_16x16x32_bf16 v[104:107], a[168:171], a[96:99], v[104:107]
    v_sin_f32 v213, v213
    s_waitcnt lgkmcnt(1)
    v_mfma_f32_16x16x32_bf16 v[108:111], a[128:131], a[64:67], v[108:111]
    ds_read_b64_tr_b16 a[144:145], v15 offset:16384
    v_fmamk_f32 v214, v21, 0x40000000, v20
    v_mfma_f32_16x16x32_bf16 v[108:111], a[132:135], a[68:71], v[108:111]
    ds_read_b64_tr_b16 a[146:147], v15 offset:16896
    v_cos_f32 v198, v214
    v_mfma_f32_16x16x32_bf16 v[132:135], a[132:135], a[76:79], v[132:135]
    buffer_load_dwordx4 v9, s[28:31], 0 offen offset:1024 lds
    s_add_u32 s28, s28, 2048
    v_mfma_f32_16x16x32_bf16 v[132:135], a[128:131], a[72:75], v[132:135]
    ds_read_b64_tr_b16 a[148:149], v15 offset:20480
    s_addc_u32 s29, s29, 0
    v_mfma_f32_16x16x32_bf16 v[156:159], a[128:131], a[80:83], v[156:159]
    ds_read_b64_tr_b16 a[150:151], v15 offset:20992
    v_sin_f32 v214, v214
    v_mfma_f32_16x16x32_bf16 v[156:159], a[132:135], a[84:87], v[156:159]
    ds_read_b64_tr_b16 a[152:153], v16 offset:16384
    s_add_u32 m0, s45, 114688
    v_mfma_f32_16x16x32_bf16 v[180:183], a[132:135], a[92:95], v[180:183]
    buffer_load_dwordx4 v8, s[28:31], 0 offen offset:0 lds
    v_fmamk_f32 v215, v21, 0x40400000, v20
    v_mfma_f32_16x16x32_bf16 v[180:183], a[128:131], a[88:91], v[180:183]
    ds_read_b64_tr_b16 a[154:155], v16 offset:16896
    v_cos_f32 v199, v215
    v_mfma_f32_16x16x32_bf16 v[184:187], a[136:139], a[88:91], v[184:187]
    ds_read_b64_tr_b16 a[156:157], v16 offset:20480
    s_waitcnt lgkmcnt(3)
    v_mfma_f32_16x16x32_bf16 v[184:187], a[140:143], a[92:95], v[184:187]
    ds_read_b64_tr_b16 a[158:159], v16 offset:20992
    v_sin_f32 v215, v215
    v_mfma_f32_16x16x32_bf16 v[160:163], a[140:143], a[84:87], v[160:163]
    ds_read_b64_tr_b16 a[160:161], v15 offset:24576
    v_fmamk_f32 v216, v21, 0x41000000, v20
    v_mfma_f32_16x16x32_bf16 v[160:163], a[136:139], a[80:83], v[160:163]
    buffer_load_dwordx4 v9, s[28:31], 0 offen offset:1024 lds
    s_sub_u32 s28, s28, 4096
    v_mfma_f32_16x16x32_bf16 v[136:139], a[136:139], a[72:75], v[136:139]
    ds_read_b64_tr_b16 a[162:163], v15 offset:25088
    s_subb_u32 s29, s29, 0
    v_mfma_f32_16x16x32_bf16 v[136:139], a[140:143], a[76:79], v[136:139]
    ds_read_b64_tr_b16 a[164:165], v15 offset:28672
    v_cos_f32 v200, v216
    v_mfma_f32_16x16x32_bf16 v[112:115], a[140:143], a[68:71], v[112:115]
    ds_read_b64_tr_b16 a[166:167], v15 offset:29184
    v_sin_f32 v216, v216
    v_mfma_f32_16x16x32_bf16 v[112:115], a[136:139], a[64:67], v[112:115]
    ds_read_b64_tr_b16 a[168:169], v16 offset:24576
    v_fmamk_f32 v217, v21, 0x41100000, v20
    v_mfma_f32_16x16x32_bf16 v[116:119], a[64:67], a[144:147], v[116:119]
    ds_read_b64_tr_b16 a[170:171], v16 offset:25088
    v_cos_f32 v201, v217
    v_mfma_f32_16x16x32_bf16 v[116:119], a[68:71], a[148:151], v[116:119]
    ds_read_b64_tr_b16 a[172:173], v16 offset:28672
    s_add_u32 m0, s45, 122880
    v_mfma_f32_16x16x32_bf16 v[140:143], a[76:79], a[148:151], v[140:143]
    buffer_load_dwordx4 v8, s[28:31], 0 offen offset:0 lds
    v_sin_f32 v217, v217
    v_mfma_f32_16x16x32_bf16 v[140:143], a[72:75], a[144:147], v[140:143]
    ds_read_b64_tr_b16 a[174:175], v16 offset:29184
    v_fmamk_f32 v218, v21, 0x41200000, v20
    v_mfma_f32_16x16x32_bf16 v[164:167], a[80:83], a[144:147], v[164:167]
    v_mfma_f32_16x16x32_bf16 v[164:167], a[84:87], a[148:151], v[164:167]
    v_mfma_f32_16x16x32_bf16 v[188:191], a[92:95], a[148:151], v[188:191]
    buffer_load_dwordx4 v9, s[28:31], 0 offen offset:1024 lds
    s_add_u32 s28, s28, 395264
    v_mfma_f32_16x16x32_bf16 v[188:191], a[88:91], a[144:147], v[188:191]
    s_addc_u32 s29, s29, 0
    s_waitcnt lgkmcnt(1)
    v_mfma_f32_16x16x32_bf16 v[192:195], a[88:91], a[152:155], v[192:195]
    s_waitcnt vmcnt(10) lgkmcnt(0)
    s_barrier
    ds_read_b128 a[96:99], v11 offset:32768
    v_mfma_f32_16x16x32_bf16 v[192:195], a[92:95], a[156:159], v[192:195]
    ds_read_b64_tr_b16 a[128:129], v13 offset:24576
    v_mfma_f32_16x16x32_bf16 v[168:171], a[84:87], a[156:159], v[168:171]
    ds_read_b64_tr_b16 a[130:131], v13 offset:25088
    s_add_u32 m0, s44, 0
    v_mfma_f32_16x16x32_bf16 v[168:171], a[80:83], a[152:155], v[168:171]
    buffer_load_dwordx4 v4, s[8:11], 0 offen offset:0 lds
    v_mfma_f32_16x16x32_bf16 v[144:147], a[72:75], a[152:155], v[144:147]
    ds_read_b128 a[100:103], v12 offset:32768
    v_mfma_f32_16x16x32_bf16 v[144:147], a[76:79], a[156:159], v[144:147]
    ds_read_b64_tr_b16 a[132:133], v13 offset:28672
    v_mfma_f32_16x16x32_bf16 v[120:123], a[68:71], a[156:159], v[120:123]
    ds_read_b64_tr_b16 a[134:135], v13 offset:29184
    v_mfma_f32_16x16x32_bf16 v[120:123], a[64:67], a[152:155], v[120:123]
    buffer_load_dwordx4 v5, s[8:11], 0 offen offset:1024 lds
    v_mfma_f32_16x16x32_bf16 v[100:103], a[160:163], a[64:67], v[100:103]
    ds_read_b128 a[108:111], v12 offset:34816
    v_mfma_f32_16x16x32_bf16 v[100:103], a[164:167], a[68:71], v[100:103]
    ds_read_b128 a[104:107], v11 offset:34816
    v_cos_f32 v202, v218
    v_mfma_f32_16x16x32_bf16 v[124:127], a[164:167], a[76:79], v[124:127]
    ds_read_b128 a[112:115], v11 offset:36864
    v_sin_f32 v218, v218
    v_mfma_f32_16x16x32_bf16 v[124:127], a[160:163], a[72:75], v[124:127]
    buffer_load_dwordx4 v6, s[8:11], 0 offen offset:2048 lds
    v_fmamk_f32 v219, v21, 0x41300000, v20
    v_mfma_f32_16x16x32_bf16 v[148:151], a[160:163], a[80:83], v[148:151]
    ds_read_b128 a[116:119], v12 offset:36864
    v_cos_f32 v203, v219
    v_mfma_f32_16x16x32_bf16 v[148:151], a[164:167], a[84:87], v[148:151]
    ds_read_b128 a[124:127], v12 offset:38912
    v_sin_f32 v219, v219
    v_mfma_f32_16x16x32_bf16 v[172:175], a[164:167], a[92:95], v[172:175]
    ds_read_b128 a[120:123], v11 offset:38912
    v_fmamk_f32 v220, v21, 0x41800000, v20
    v_mfma_f32_16x16x32_bf16 v[172:175], a[160:163], a[88:91], v[172:175]
    ds_read_b64_tr_b16 a[136:137], v14 offset:24576
    v_cos_f32 v204, v220
    v_mfma_f32_16x16x32_bf16 v[176:179], a[168:171], a[88:91], v[176:179]
    buffer_load_dwordx4 v7, s[8:11], 0 offen offset:3072 lds
    s_add_u32 s8, s8, 128
    v_mfma_f32_16x16x32_bf16 v[176:179], a[172:175], a[92:95], v[176:179]
    ds_read_b64_tr_b16 a[138:139], v14 offset:25088
    s_addc_u32 s9, s9, 0
    v_mfma_f32_16x16x32_bf16 v[152:155], a[172:175], a[84:87], v[152:155]
    ds_read_b64_tr_b16 a[140:141], v14 offset:28672
    v_sin_f32 v220, v220
    v_mfma_f32_16x16x32_bf16 v[152:155], a[168:171], a[80:83], v[152:155]
    ds_read_b64_tr_b16 a[142:143], v14 offset:29184
    s_add_u32 m0, s45, 139264
    v_mfma_f32_16x16x32_bf16 v[128:131], a[168:171], a[72:75], v[128:131]
    buffer_load_dwordx4 v8, s[28:31], 0 offen offset:0 lds
    v_fmamk_f32 v221, v21, 0x41880000, v20
    v_mfma_f32_16x16x32_bf16 v[128:131], a[172:175], a[76:79], v[128:131]
    v_cos_f32 v205, v221
    v_mfma_f32_16x16x32_bf16 v[104:107], a[172:175], a[68:71], v[104:107]
    v_sin_f32 v221, v221
    v_mfma_f32_16x16x32_bf16 v[104:107], a[168:171], a[64:67], v[104:107]
    v_fmamk_f32 v222, v21, 0x41900000, v20
    s_waitcnt lgkmcnt(2)
    v_mfma_f32_16x16x32_bf16 v[108:111], a[128:131], a[96:99], v[108:111]
    ds_read_b64_tr_b16 a[144:145], v15 offset:32768
    v_cos_f32 v206, v222
    v_mfma_f32_16x16x32_bf16 v[108:111], a[132:135], a[100:103], v[108:111]
    buffer_load_dwordx4 v9, s[28:31], 0 offen offset:1024 lds
    s_add_u32 s28, s28, 2048
    v_mfma_f32_16x16x32_bf16 v[132:135], a[132:135], a[108:111], v[132:135]
    ds_read_b64_tr_b16 a[146:147], v15 offset:33280
    s_addc_u32 s29, s29, 0
    v_mfma_f32_16x16x32_bf16 v[132:135], a[128:131], a[104:107], v[132:135]
    ds_read_b64_tr_b16 a[148:149], v15 offset:36864
    v_sin_f32 v222, v222
    v_mfma_f32_16x16x32_bf16 v[156:159], a[128:131], a[112:115], v[156:159]
    ds_read_b64_tr_b16 a[150:151], v15 offset:37376
    s_add_u32 m0, s45, 65536
    v_mfma_f32_16x16x32_bf16 v[156:159], a[132:135], a[116:119], v[156:159]
    buffer_load_dwordx4 v8, s[28:31], 0 offen offset:0 lds
    v_fmamk_f32 v223, v21, 0x41980000, v20
    v_mfma_f32_16x16x32_bf16 v[180:183], a[132:135], a[124:127], v[180:183]
    ds_read_b64_tr_b16 a[152:153], v16 offset:32768
    v_cos_f32 v207, v223
    v_mfma_f32_16x16x32_bf16 v[180:183], a[128:131], a[120:123], v[180:183]
    ds_read_b64_tr_b16 a[154:155], v16 offset:33280
    v_sin_f32 v223, v223
    v_mfma_f32_16x16x32_bf16 v[184:187], a[136:139], a[120:123], v[184:187]
    ds_read_b64_tr_b16 a[156:157], v16 offset:36864
    s_waitcnt lgkmcnt(3)
    v_mfma_f32_16x16x32_bf16 v[184:187], a[140:143], a[124:127], v[184:187]
    buffer_load_dwordx4 v9, s[28:31], 0 offen offset:1024 lds
    s_sub_u32 s28, s28, 4096
    v_mfma_f32_16x16x32_bf16 v[160:163], a[140:143], a[116:119], v[160:163]
    ds_read_b64_tr_b16 a[158:159], v16 offset:37376
    s_subb_u32 s29, s29, 0
    v_mfma_f32_16x16x32_bf16 v[160:163], a[136:139], a[112:115], v[160:163]
    ds_read_b64_tr_b16 a[160:161], v15 offset:40960
    v_fmamk_f32 v224, v21, 0x41c00000, v20
    v_mfma_f32_16x16x32_bf16 v[136:139], a[136:139], a[104:107], v[136:139]
    ds_read_b64_tr_b16 a[162:163], v15 offset:41472
    v_cos_f32 v208, v224
    v_mfma_f32_16x16x32_bf16 v[136:139], a[140:143], a[108:111], v[136:139]
    ds_read_b64_tr_b16 a[164:165], v15 offset:45056
    v_sin_f32 v224, v224
    v_mfma_f32_16x16x32_bf16 v[112:115], a[140:143], a[100:103], v[112:115]
    ds_read_b64_tr_b16 a[166:167], v15 offset:45568
    v_fmamk_f32 v225, v21, 0x41c80000, v20
    v_mfma_f32_16x16x32_bf16 v[112:115], a[136:139], a[96:99], v[112:115]
    ds_read_b64_tr_b16 a[168:169], v16 offset:40960
    v_cos_f32 v209, v225
    v_mfma_f32_16x16x32_bf16 v[116:119], a[96:99], a[144:147], v[116:119]
    ds_read_b64_tr_b16 a[170:171], v16 offset:41472
    s_add_u32 m0, s45, 73728
    v_mfma_f32_16x16x32_bf16 v[116:119], a[100:103], a[148:151], v[116:119]
    buffer_load_dwordx4 v8, s[28:31], 0 offen offset:0 lds
    v_sin_f32 v225, v225
    v_mfma_f32_16x16x32_bf16 v[140:143], a[108:111], a[148:151], v[140:143]
    ds_read_b64_tr_b16 a[172:173], v16 offset:45056
    v_fmamk_f32 v226, v21, 0x41d00000, v20
    v_mfma_f32_16x16x32_bf16 v[140:143], a[104:107], a[144:147], v[140:143]
    ds_read_b64_tr_b16 a[174:175], v16 offset:45568
    v_cos_f32 v210, v226
    v_mfma_f32_16x16x32_bf16 v[164:167], a[112:115], a[144:147], v[164:167]
    v_mfma_f32_16x16x32_bf16 v[164:167], a[116:119], a[148:151], v[164:167]
    buffer_load_dwordx4 v9, s[28:31], 0 offen offset:1024 lds
    s_add_u32 s28, s28, 395264
    v_mfma_f32_16x16x32_bf16 v[188:191], a[124:127], a[148:151], v[188:191]
    s_addc_u32 s29, s29, 0
    v_mfma_f32_16x16x32_bf16 v[188:191], a[120:123], a[144:147], v[188:191]
    s_waitcnt lgkmcnt(1)
    v_mfma_f32_16x16x32_bf16 v[192:195], a[120:123], a[152:155], v[192:195]
    s_waitcnt vmcnt(10) lgkmcnt(0)
    s_barrier
    ds_read_b128 a[64:67], v11 offset:49152
    v_mfma_f32_16x16x32_bf16 v[192:195], a[124:127], a[156:159], v[192:195]
    ds_read_b64_tr_b16 a[128:129], v13 offset:0
    s_add_u32 m0, s44, 16384
    v_mfma_f32_16x16x32_bf16 v[168:171], a[116:119], a[156:159], v[168:171]
    buffer_load_dwordx4 v4, s[8:11], 0 offen offset:0 lds
    v_mfma_f32_16x16x32_bf16 v[168:171], a[112:115], a[152:155], v[168:171]
    ds_read_b64_tr_b16 a[130:131], v13 offset:512
    v_mfma_f32_16x16x32_bf16 v[144:147], a[104:107], a[152:155], v[144:147]
    ds_read_b128 a[68:71], v12 offset:49152
    v_mfma_f32_16x16x32_bf16 v[144:147], a[108:111], a[156:159], v[144:147]
    ds_read_b64_tr_b16 a[132:133], v13 offset:4096
    v_mfma_f32_16x16x32_bf16 v[120:123], a[100:103], a[156:159], v[120:123]
    buffer_load_dwordx4 v5, s[8:11], 0 offen offset:1024 lds
    v_mfma_f32_16x16x32_bf16 v[120:123], a[96:99], a[152:155], v[120:123]
    ds_read_b64_tr_b16 a[134:135], v13 offset:4608
    v_mfma_f32_16x16x32_bf16 v[100:103], a[160:163], a[96:99], v[100:103]
L_pad_2:
    s_cmp_eq_u32 s3, 1
    s_cbranch_scc1 L_walkret
    ds_read_b128 a[76:79], v12 offset:51200
    v_mfma_f32_16x16x32_bf16 v[100:103], a[164:167], a[100:103], v[100:103]
    ds_read_b128 a[72:75], v11 offset:51200
    v_sin_f32 v226, v226
    v_mfma_f32_16x16x32_bf16 v[124:127], a[164:167], a[108:111], v[124:127]
    buffer_load_dwordx4 v6, s[8:11], 0 offen offset:2048 lds
    v_fmamk_f32 v227, v21, 0x41d80000, v20
    v_mfma_f32_16x16x32_bf16 v[124:127], a[160:163], a[104:107], v[124:127]
    ds_read_b128 a[80:83], v11 offset:53248
    v_cos_f32 v211, v227
    v_mfma_f32_16x16x32_bf16 v[148:151], a[160:163], a[112:115], v[148:151]
    ds_read_b128 a[84:87], v12 offset:53248
    v_sin_f32 v227, v227
    v_mfma_f32_16x16x32_bf16 v[148:151], a[164:167], a[116:119], v[148:151]
    ds_read_b128 a[92:95], v12 offset:55296
    v_mul_f32 v21, 0x42000000, v21
    v_mfma_f32_16x16x32_bf16 v[172:175], a[164:167], a[124:127], v[172:175]
    ds_read_b128 a[88:91], v11 offset:55296
    v_mul_f32 v20, 0x42800000, v20
    v_mfma_f32_16x16x32_bf16 v[172:175], a[160:163], a[120:123], v[172:175]
    buffer_load_dwordx4 v7, s[8:11], 0 offen offset:3072 lds
    s_add_u32 s8, s8, 128
    v_mfma_f32_16x16x32_bf16 v[176:179], a[168:171], a[120:123], v[176:179]
    ds_read_b64_tr_b16 a[136:137], v14 offset:0
    s_addc_u32 s9, s9, 0
    v_mfma_f32_16x16x32_bf16 v[176:179], a[172:175], a[124:127], v[176:179]
    ds_read_b64_tr_b16 a[138:139], v14 offset:512
    v_bfe_i32 v22, v1, 0, 1
    v_mfma_f32_16x16x32_bf16 v[152:155], a[172:175], a[116:119], v[152:155]
    ds_read_b64_tr_b16 a[140:141], v14 offset:4096
    s_add_u32 m0, s45, 147456
    v_mfma_f32_16x16x32_bf16 v[152:155], a[168:171], a[112:115], v[152:155]
    buffer_load_dwordx4 v8, s[28:31], 0 offen offset:0 lds
    v_and_b32 v22, s73, v22
    v_mfma_f32_16x16x32_bf16 v[128:131], a[168:171], a[104:107], v[128:131]
    ds_read_b64_tr_b16 a[142:143], v14 offset:4608
    v_fmamk_f32 v24, v21, 0x00000000, v20
    v_mfma_f32_16x16x32_bf16 v[128:131], a[172:175], a[108:111], v[128:131]
    v_fmamk_f32 v25, v21, 0x3f800000, v20
    v_mfma_f32_16x16x32_bf16 v[104:107], a[172:175], a[100:103], v[104:107]
    v_cos_f32 v26, v24
    v_mfma_f32_16x16x32_bf16 v[104:107], a[168:171], a[96:99], v[104:107]
    v_sin_f32 v28, v24
    s_waitcnt lgkmcnt(2)
    v_mfma_f32_16x16x32_bf16 v[108:111], a[128:131], a[64:67], v[108:111]
    ds_read_b64_tr_b16 a[144:145], v15 offset:49152
    v_mfma_f32_16x16x32_bf16 v[108:111], a[132:135], a[68:71], v[108:111]
    buffer_load_dwordx4 v9, s[28:31], 0 offen offset:1024 lds
    s_add_u32 s28, s28, 2048
    v_mfma_f32_16x16x32_bf16 v[132:135], a[132:135], a[76:79], v[132:135]
    ds_read_b64_tr_b16 a[146:147], v15 offset:49664
    s_addc_u32 s29, s29, 0
    v_mfma_f32_16x16x32_bf16 v[132:135], a[128:131], a[72:75], v[132:135]
    ds_read_b64_tr_b16 a[148:149], v15 offset:53248
    v_mfma_f32_16x16x32_bf16 v[156:159], a[128:131], a[80:83], v[156:159]
    ds_read_b64_tr_b16 a[150:151], v15 offset:53760
    s_add_u32 m0, s45, 81920
    v_mfma_f32_16x16x32_bf16 v[156:159], a[132:135], a[84:87], v[156:159]
    buffer_load_dwordx4 v8, s[28:31], 0 offen offset:0 lds
    v_mfma_f32_16x16x32_bf16 v[180:183], a[132:135], a[92:95], v[180:183]
    ds_read_b64_tr_b16 a[152:153], v16 offset:49152
    v_mfma_f32_16x16x32_bf16 v[180:183], a[128:131], a[88:91], v[180:183]
    ds_read_b64_tr_b16 a[154:155], v16 offset:49664
    v_mfma_f32_16x16x32_bf16 v[184:187], a[136:139], a[88:91], v[184:187]
    ds_read_b64_tr_b16 a[156:157], v16 offset:53248
    s_waitcnt lgkmcnt(3)
    v_mfma_f32_16x16x32_bf16 v[184:187], a[140:143], a[92:95], v[184:187]
    buffer_load_dwordx4 v9, s[28:31], 0 offen offset:1024 lds
    s_sub_u32 s28, s28, 4096
    v_mfma_f32_16x16x32_bf16 v[160:163], a[140:143], a[84:87], v[160:163]
    ds_read_b64_tr_b16 a[158:159], v16 offset:53760
    s_subb_u32 s29, s29, 0
    v_mfma_f32_16x16x32_bf16 v[160:163], a[136:139], a[80:83], v[160:163]
    ds_read_b64_tr_b16 a[160:161], v15 offset:57344
    v_mfma_f32_16x16x32_bf16 v[136:139], a[136:139], a[72:75], v[136:139]
    ds_read_b64_tr_b16 a[162:163], v15 offset:57856
    v_mfma_f32_16x16x32_bf16 v[136:139], a[140:143], a[76:79], v[136:139]
    ds_read_b64_tr_b16 a[164:165], v15 offset:61440
    v_mfma_f32_16x16x32_bf16 v[112:115], a[140:143], a[68:71], v[112:115]
    ds_read_b64_tr_b16 a[166:167], v15 offset:61952
    v_mfma_f32_16x16x32_bf16 v[112:115], a[136:139], a[64:67], v[112:115]
    ds_read_b64_tr_b16 a[168:169], v16 offset:57344
    s_add_u32 m0, s45, 90112
    v_mfma_f32_16x16x32_bf16 v[116:119], a[64:67], a[144:147], v[116:119]
    buffer_load_dwordx4 v8, s[28:31], 0 offen offset:0 lds
    v_mfma_f32_16x16x32_bf16 v[116:119], a[68:71], a[148:151], v[116:119]
    ds_read_b64_tr_b16 a[170:171], v16 offset:57856
    v_mfma_f32_16x16x32_bf16 v[140:143], a[76:79], a[148:151], v[140:143]
    ds_read_b64_tr_b16 a[172:173], v16 offset:61440
    v_mfma_f32_16x16x32_bf16 v[140:143], a[72:75], a[144:147], v[140:143]
    ds_read_b64_tr_b16 a[174:175], v16 offset:61952
    v_mfma_f32_16x16x32_bf16 v[164:167], a[80:83], a[144:147], v[164:167]
    buffer_load_dwordx4 v9, s[28:31], 0 offen offset:1024 lds
    s_add_u32 s28, s28, 395264
    v_mfma_f32_16x16x32_bf16 v[164:167], a[84:87], a[148:151], v[164:167]
    s_addc_u32 s29, s29, 0
    v_mfma_f32_16x16x32_bf16 v[188:191], a[92:95], a[148:151], v[188:191]
    v_mfma_f32_16x16x32_bf16 v[188:191], a[88:91], a[144:147], v[188:191]
    s_waitcnt lgkmcnt(1)
    v_mfma_f32_16x16x32_bf16 v[192:195], a[88:91], a[152:155], v[192:195]
    s_waitcnt vmcnt(10) lgkmcnt(0)
    s_barrier
    ds_read_b128 a[96:99], v11 offset:0
    v_mfma_f32_16x16x32_bf16 v[192:195], a[92:95], a[156:159], v[192:195]
    ds_read_b64_tr_b16 a[128:129], v13 offset:8192
    s_add_u32 m0, s44, 32768
    v_mfma_f32_16x16x32_bf16 v[168:171], a[84:87], a[156:159], v[168:171]
    buffer_load_dwordx4 v4, s[8:11], 0 offen offset:0 lds
    v_mfma_f32_16x16x32_bf16 v[168:171], a[80:83], a[152:155], v[168:171]
    ds_read_b64_tr_b16 a[130:131], v13 offset:8704
    v_mfma_f32_16x16x32_bf16 v[144:147], a[72:75], a[152:155], v[144:147]
    ds_read_b128 a[100:103], v12 offset:0
    v_mfma_f32_16x16x32_bf16 v[144:147], a[76:79], a[156:159], v[144:147]
    ds_read_b64_tr_b16 a[132:133], v13 offset:12288
    v_mfma_f32_16x16x32_bf16 v[120:123], a[68:71], a[156:159], v[120:123]
    buffer_load_dwordx4 v5, s[8:11], 0 offen offset:1024 lds
    v_mfma_f32_16x16x32_bf16 v[120:123], a[64:67], a[152:155], v[120:123]
    ds_read_b64_tr_b16 a[134:135], v13 offset:12800
    v_mfma_f32_16x16x32_bf16 v[100:103], a[160:163], a[64:67], v[100:103]
    ds_read_b128 a[108:111], v12 offset:2048
    v_mfma_f32_16x16x32_bf16 v[100:103], a[164:167], a[68:71], v[100:103]
    ds_read_b128 a[104:107], v11 offset:2048
    v_mfma_f32_16x16x32_bf16 v[124:127], a[164:167], a[76:79], v[124:127]
    buffer_load_dwordx4 v6, s[8:11], 0 offen offset:2048 lds
    v_mfma_f32_16x16x32_bf16 v[124:127], a[160:163], a[72:75], v[124:127]
    ds_read_b128 a[112:115], v11 offset:4096
    v_mfma_f32_16x16x32_bf16 v[148:151], a[160:163], a[80:83], v[148:151]
    ds_read_b128 a[116:119], v12 offset:4096
    v_mfma_f32_16x16x32_bf16 v[148:151], a[164:167], a[84:87], v[148:151]
    ds_read_b128 a[124:127], v12 offset:6144
    v_mfma_f32_16x16x32_bf16 v[172:175], a[164:167], a[92:95], v[172:175]
    ds_read_b128 a[120:123], v11 offset:6144
    v_mfma_f32_16x16x32_bf16 v[172:175], a[160:163], a[88:91], v[172:175]
    buffer_load_dwordx4 v7, s[8:11], 0 offen offset:3072 lds
    s_add_u32 s8, s8, 128
    v_mfma_f32_16x16x32_bf16 v[176:179], a[168:171], a[88:91], v[176:179]
    ds_read_b64_tr_b16 a[136:137], v14 offset:8192
    s_addc_u32 s9, s9, 0
    v_mfma_f32_16x16x32_bf16 v[176:179], a[172:175], a[92:95], v[176:179]
    ds_read_b64_tr_b16 a[138:139], v14 offset:8704
    v_mfma_f32_16x16x32_bf16 v[152:155], a[172:175], a[84:87], v[152:155]
    ds_read_b64_tr_b16 a[140:141], v14 offset:12288
    s_add_u32 m0, s45, 155648
    v_mfma_f32_16x16x32_bf16 v[152:155], a[168:171], a[80:83], v[152:155]
    buffer_load_dwordx4 v8, s[28:31], 0 offen offset:0 lds
    v_mfma_f32_16x16x32_bf16 v[128:131], a[168:171], a[72:75], v[128:131]
    ds_read_b64_tr_b16 a[142:143], v14 offset:12800
    v_mfma_f32_16x16x32_bf16 v[128:131], a[172:175], a[76:79], v[128:131]
    s_cmp_lg_u32 s93, 0
    s_cselect_b32 s94, 0x80000000, 0
    v_or_b32 v40, s94, v2
    v_mfma_f32_16x16x32_bf16 v[104:107], a[172:175], a[68:71], v[104:107]
    v_cos_f32 v27, v25
    v_mfma_f32_16x16x32_bf16 v[104:107], a[168:171], a[64:67], v[104:107]
    buffer_atomic_add v19, v40, s[32:35], s46 offen
    s_waitcnt lgkmcnt(1)
    v_mfma_f32_16x16x32_bf16 v[108:111], a[128:131], a[96:99], v[108:111]
    ds_read_b64_tr_b16 a[144:145], v15 offset:0
    v_mfma_f32_16x16x32_bf16 v[108:111], a[132:135], a[100:103], v[108:111]
    buffer_load_dwordx4 v9, s[28:31], 0 offen offset:1024 lds
    s_add_u32 s28, s28, 2048
    v_mfma_f32_16x16x32_bf16 v[132:135], a[132:135], a[108:111], v[132:135]
    ds_read_b64_tr_b16 a[146:147], v15 offset:512
    s_addc_u32 s29, s29, 0
    v_mfma_f32_16x16x32_bf16 v[132:135], a[128:131], a[104:107], v[132:135]
    ds_read_b64_tr_b16 a[148:149], v15 offset:4096
    v_mfma_f32_16x16x32_bf16 v[156:159], a[128:131], a[112:115], v[156:159]
    ds_read_b64_tr_b16 a[150:151], v15 offset:4608
    s_add_u32 m0, s45, 98304
    v_mfma_f32_16x16x32_bf16 v[156:159], a[132:135], a[116:119], v[156:159]
    buffer_load_dwordx4 v8, s[28:31], 0 offen offset:0 lds
    v_mfma_f32_16x16x32_bf16 v[180:183], a[132:135], a[124:127], v[180:183]
    ds_read_b64_tr_b16 a[152:153], v16 offset:0
    v_mfma_f32_16x16x32_bf16 v[180:183], a[128:131], a[120:123], v[180:183]
    ds_read_b64_tr_b16 a[154:155], v16 offset:512
    v_mfma_f32_16x16x32_bf16 v[184:187], a[136:139], a[120:123], v[184:187]
    ds_read_b64_tr_b16 a[156:157], v16 offset:4096
    s_waitcnt lgkmcnt(3)
    v_mfma_f32_16x16x32_bf16 v[184:187], a[140:143], a[124:127], v[184:187]
    buffer_load_dwordx4 v9, s[28:31], 0 offen offset:1024 lds
    s_sub_u32 s28, s28, 4096
    v_mfma_f32_16x16x32_bf16 v[160:163], a[140:143], a[116:119], v[160:163]
    ds_read_b64_tr_b16 a[158:159], v16 offset:4608
    s_subb_u32 s29, s29, 0
    v_mfma_f32_16x16x32_bf16 v[160:163], a[136:139], a[112:115], v[160:163]
    ds_read_b64_tr_b16 a[160:161], v15 offset:8192
    v_mfma_f32_16x16x32_bf16 v[136:139], a[136:139], a[104:107], v[136:139]
    ds_read_b64_tr_b16 a[162:163], v15 offset:8704
    v_mfma_f32_16x16x32_bf16 v[136:139], a[140:143], a[108:111], v[136:139]
    ds_read_b64_tr_b16 a[164:165], v15 offset:12288
    v_mfma_f32_16x16x32_bf16 v[112:115], a[140:143], a[100:103], v[112:115]
    ds_read_b64_tr_b16 a[166:167], v15 offset:12800
    v_mfma_f32_16x16x32_bf16 v[112:115], a[136:139], a[96:99], v[112:115]
    ds_read_b64_tr_b16 a[168:169], v16 offset:8192
    s_add_u32 m0, s45, 106496
    v_mfma_f32_16x16x32_bf16 v[116:119], a[96:99], a[144:147], v[116:119]
    buffer_load_dwordx4 v8, s[28:31], 0 offen offset:0 lds
    v_mfma_f32_16x16x32_bf16 v[116:119], a[100:103], a[148:151], v[116:119]
    ds_read_b64_tr_b16 a[170:171], v16 offset:8704
    v_mfma_f32_16x16x32_bf16 v[140:143], a[108:111], a[148:151], v[140:143]
    ds_read_b64_tr_b16 a[172:173], v16 offset:12288
    v_mfma_f32_16x16x32_bf16 v[140:143], a[104:107], a[144:147], v[140:143]
    ds_read_b64_tr_b16 a[174:175], v16 offset:12800
    v_mfma_f32_16x16x32_bf16 v[164:167], a[112:115], a[144:147], v[164:167]
    buffer_load_dwordx4 v9, s[28:31], 0 offen offset:1024 lds
    s_add_u32 s28, s28, 395264
    v_mfma_f32_16x16x32_bf16 v[164:167], a[116:119], a[148:151], v[164:167]
    s_addc_u32 s29, s29, 0
    v_mfma_f32_16x16x32_bf16 v[188:191], a[124:127], a[148:151], v[188:191]
    v_mfma_f32_16x16x32_bf16 v[188:191], a[120:123], a[144:147], v[188:191]
    s_waitcnt lgkmcnt(1)
    v_mfma_f32_16x16x32_bf16 v[192:195], a[120:123], a[152:155], v[192:195]
    s_waitcnt vmcnt(11) lgkmcnt(0)
    s_barrier
    ds_read_b128 a[64:67], v11 offset:16384
    v_mfma_f32_16x16x32_bf16 v[192:195], a[124:127], a[156:159], v[192:195]
    ds_read_b64_tr_b16 a[128:129], v13 offset:16384
    s_add_u32 m0, s44, 49152
    v_mfma_f32_16x16x32_bf16 v[168:171], a[116:119], a[156:159], v[168:171]
    buffer_load_dwordx4 v4, s[8:11], 0 offen offset:0 lds
    v_mfma_f32_16x16x32_bf16 v[168:171], a[112:115], a[152:155], v[168:171]
    ds_read_b64_tr_b16 a[130:131], v13 offset:16896
    v_mfma_f32_16x16x32_bf16 v[144:147], a[104:107], a[152:155], v[144:147]
    ds_read_b128 a[68:71], v12 offset:16384
    v_mfma_f32_16x16x32_bf16 v[144:147], a[108:111], a[156:159], v[144:147]
    ds_read_b64_tr_b16 a[132:133], v13 offset:20480
    v_mfma_f32_16x16x32_bf16 v[120:123], a[100:103], a[156:159], v[120:123]
    buffer_load_dwordx4 v5, s[8:11], 0 offen offset:1024 lds
    v_mfma_f32_16x16x32_bf16 v[120:123], a[96:99], a[152:155], v[120:123]
    ds_read_b64_tr_b16 a[134:135], v13 offset:20992
    v_mfma_f32_16x16x32_bf16 v[100:103], a[160:163], a[96:99], v[100:103]
    ds_read_b128 a[76:79], v12 offset:18432
    v_mfma_f32_16x16x32_bf16 v[100:103], a[164:167], a[100:103], v[100:103]
    ds_read_b128 a[72:75], v11 offset:18432
    v_mfma_f32_16x16x32_bf16 v[124:127], a[164:167], a[108:111], v[124:127]
    buffer_load_dwordx4 v6, s[8:11], 0 offen offset:2048 lds
    v_mfma_f32_16x16x32_bf16 v[124:127], a[160:163], a[104:107], v[124:127]
    ds_read_b128 a[80:83], v11 offset:20480
    v_mfma_f32_16x16x32_bf16 v[148:151], a[160:163], a[112:115], v[148:151]
    ds_read_b128 a[84:87], v12 offset:20480
    v_mfma_f32_16x16x32_bf16 v[148:151], a[164:167], a[116:119], v[148:151]
    ds_read_b128 a[92:95], v12 offset:22528
    v_mfma_f32_16x16x32_bf16 v[172:175], a[164:167], a[124:127], v[172:175]
    ds_read_b128 a[88:91], v11 offset:22528
    v_mfma_f32_16x16x32_bf16 v[172:175], a[160:163], a[120:123], v[172:175]
    buffer_load_dwordx4 v7, s[8:11], 0 offen offset:3072 lds
    s_add_u32 s8, s8, 128
    v_mfma_f32_16x16x32_bf16 v[176:179], a[168:171], a[120:123], v[176:179]
    ds_read_b64_tr_b16 a[136:137], v14 offset:16384
    s_addc_u32 s9, s9, 0
    v_mfma_f32_16x16x32_bf16 v[176:179], a[172:175], a[124:127], v[176:179]
    ds_read_b64_tr_b16 a[138:139], v14 offset:16896
    v_mfma_f32_16x16x32_bf16 v[152:155], a[172:175], a[116:119], v[152:155]
    ds_read_b64_tr_b16 a[140:141], v14 offset:20480
    s_add_u32 m0, s45, 131072
    v_mfma_f32_16x16x32_bf16 v[152:155], a[168:171], a[112:115], v[152:155]
    buffer_load_dwordx4 v8, s[28:31], 0 offen offset:0 lds
    v_mfma_f32_16x16x32_bf16 v[128:131], a[168:171], a[104:107], v[128:131]
    ds_read_b64_tr_b16 a[142:143], v14 offset:20992
    v_mfma_f32_16x16x32_bf16 v[128:131], a[172:175], a[108:111], v[128:131]
    s_cmp_lg_u32 s93, 1
    s_cselect_b32 s94, 0x80000000, 0
    v_or_b32 v40, s94, v2
    v_mfma_f32_16x16x32_bf16 v[104:107], a[172:175], a[100:103], v[104:107]
    v_sin_f32 v29, v25
    v_mfma_f32_16x16x32_bf16 v[104:107], a[168:171], a[96:99], v[104:107]
    buffer_atomic_add v19, v40, s[32:35], s46 offen
    s_waitcnt lgkmcnt(1)
    v_mfma_f32_16x16x32_bf16 v[108:111], a[128:131], a[64:67], v[108:111]
    ds_read_b64_tr_b16 a[144:145], v15 offset:16384
    v_mfma_f32_16x16x32_bf16 v[108:111], a[132:135], a[68:71], v[108:111]
    buffer_load_dwordx4 v9, s[28:31], 0 offen offset:1024 lds
    s_add_u32 s28, s28, 2048
    v_mfma_f32_16x16x32_bf16 v[132:135], a[132:135], a[76:79], v[132:135]
    ds_read_b64_tr_b16 a[146:147], v15 offset:16896
    s_addc_u32 s29, s29, 0
    v_mfma_f32_16x16x32_bf16 v[132:135], a[128:131], a[72:75], v[132:135]
    ds_read_b64_tr_b16 a[148:149], v15 offset:20480
    v_mfma_f32_16x16x32_bf16 v[156:159], a[128:131], a[80:83], v[156:159]
    ds_read_b64_tr_b16 a[150:151], v15 offset:20992
    s_add_u32 m0, s45, 114688
    v_mfma_f32_16x16x32_bf16 v[156:159], a[132:135], a[84:87], v[156:159]
    buffer_load_dwordx4 v8, s[28:31], 0 offen offset:0 lds
    v_mfma_f32_16x16x32_bf16 v[180:183], a[132:135], a[92:95], v[180:183]
    ds_read_b64_tr_b16 a[152:153], v16 offset:16384
    v_mfma_f32_16x16x32_bf16 v[180:183], a[128:131], a[88:91], v[180:183]
    ds_read_b64_tr_b16 a[154:155], v16 offset:16896
    v_mfma_f32_16x16x32_bf16 v[184:187], a[136:139], a[88:91], v[184:187]
    ds_read_b64_tr_b16 a[156:157], v16 offset:20480
    s_waitcnt lgkmcnt(3)
    v_mfma_f32_16x16x32_bf16 v[184:187], a[140:143], a[92:95], v[184:187]
    buffer_load_dwordx4 v9, s[28:31], 0 offen offset:1024 lds
    s_sub_u32 s28, s28, 4096
    v_mfma_f32_16x16x32_bf16 v[160:163], a[140:143], a[84:87], v[160:163]
    ds_read_b64_tr_b16 a[158:159], v16 offset:20992
    s_subb_u32 s29, s29, 0
    v_mfma_f32_16x16x32_bf16 v[160:163], a[136:139], a[80:83], v[160:163]
    ds_read_b64_tr_b16 a[160:161], v15 offset:24576
    v_mfma_f32_16x16x32_bf16 v[136:139], a[136:139], a[72:75], v[136:139]
    ds_read_b64_tr_b16 a[162:163], v15 offset:25088
    v_mfma_f32_16x16x32_bf16 v[136:139], a[140:143], a[76:79], v[136:139]
    ds_read_b64_tr_b16 a[164:165], v15 offset:28672
    v_mfma_f32_16x16x32_bf16 v[112:115], a[140:143], a[68:71], v[112:115]
    ds_read_b64_tr_b16 a[166:167], v15 offset:29184
    v_mfma_f32_16x16x32_bf16 v[112:115], a[136:139], a[64:67], v[112:115]
    ds_read_b64_tr_b16 a[168:169], v16 offset:24576
    s_add_u32 m0, s45, 122880
    v_mfma_f32_16x16x32_bf16 v[116:119], a[64:67], a[144:147], v[116:119]
    buffer_load_dwordx4 v8, s[28:31], 0 offen offset:0 lds
    v_mfma_f32_16x16x32_bf16 v[116:119], a[68:71], a[148:151], v[116:119]
    ds_read_b64_tr_b16 a[170:171], v16 offset:25088
    v_mfma_f32_16x16x32_bf16 v[140:143], a[76:79], a[148:151], v[140:143]
    ds_read_b64_tr_b16 a[172:173], v16 offset:28672
    v_mfma_f32_16x16x32_bf16 v[140:143], a[72:75], a[144:147], v[140:143]
    ds_read_b64_tr_b16 a[174:175], v16 offset:29184
    v_mfma_f32_16x16x32_bf16 v[164:167], a[80:83], a[144:147], v[164:167]
    buffer_load_dwordx4 v9, s[28:31], 0 offen offset:1024 lds
    s_add_u32 s28, s28, 395264
    v_mfma_f32_16x16x32_bf16 v[164:167], a[84:87], a[148:151], v[164:167]
    s_addc_u32 s29, s29, 0
    v_mfma_f32_16x16x32_bf16 v[188:191], a[92:95], a[148:151], v[188:191]
    v_mfma_f32_16x16x32_bf16 v[188:191], a[88:91], a[144:147], v[188:191]
    s_waitcnt lgkmcnt(1)
    v_mfma_f32_16x16x32_bf16 v[192:195], a[88:91], a[152:155], v[192:195]
    s_waitcnt vmcnt(11) lgkmcnt(0)
    s_barrier
    ds_read_b128 a[96:99], v11 offset:32768
    v_mfma_f32_16x16x32_bf16 v[192:195], a[92:95], a[156:159], v[192:195]
    ds_read_b64_tr_b16 a[128:129], v13 offset:24576
    s_add_u32 m0, s44, 0
    v_mfma_f32_16x16x32_bf16 v[168:171], a[84:87], a[156:159], v[168:171]
    buffer_load_dwordx4 v4, s[8:11], 0 offen offset:0 lds
    v_mfma_f32_16x16x32_bf16 v[168:171], a[80:83], a[152:155], v[168:171]
    ds_read_b64_tr_b16 a[130:131], v13 offset:25088
    v_mfma_f32_16x16x32_bf16 v[144:147], a[72:75], a[152:155], v[144:147]
    ds_read_b128 a[100:103], v12 offset:32768
    v_mfma_f32_16x16x32_bf16 v[144:147], a[76:79], a[156:159], v[144:147]
    ds_read_b64_tr_b16 a[132:133], v13 offset:28672
    v_mfma_f32_16x16x32_bf16 v[120:123], a[68:71], a[156:159], v[120:123]
    buffer_load_dwordx4 v5, s[8:11], 0 offen offset:1024 lds
    v_mfma_f32_16x16x32_bf16 v[120:123], a[64:67], a[152:155], v[120:123]
    ds_read_b64_tr_b16 a[134:135], v13 offset:29184
    v_mfma_f32_16x16x32_bf16 v[100:103], a[160:163], a[64:67], v[100:103]
    ds_read_b128 a[108:111], v12 offset:34816
    v_mfma_f32_16x16x32_bf16 v[100:103], a[164:167], a[68:71], v[100:103]
    ds_read_b128 a[104:107], v11 offset:34816
    v_mfma_f32_16x16x32_bf16 v[124:127], a[164:167], a[76:79], v[124:127]
    buffer_load_dwordx4 v6, s[8:11], 0 offen offset:2048 lds
    v_mfma_f32_16x16x32_bf16 v[124:127], a[160:163], a[72:75], v[124:127]
    ds_read_b128 a[112:115], v11 offset:36864
    v_mfma_f32_16x16x32_bf16 v[148:151], a[160:163], a[80:83], v[148:151]
    ds_read_b128 a[116:119], v12 offset:36864
    v_mfma_f32_16x16x32_bf16 v[148:151], a[164:167], a[84:87], v[148:151]
    ds_read_b128 a[124:127], v12 offset:38912
    v_mfma_f32_16x16x32_bf16 v[172:175], a[164:167], a[92:95], v[172:175]
    ds_read_b128 a[120:123], v11 offset:38912
    v_mfma_f32_16x16x32_bf16 v[172:175], a[160:163], a[88:91], v[172:175]
    buffer_load_dwordx4 v7, s[8:11], 0 offen offset:3072 lds
    s_add_u32 s8, s8, 128
    v_mfma_f32_16x16x32_bf16 v[176:179], a[168:171], a[88:91], v[176:179]
    ds_read_b64_tr_b16 a[136:137], v14 offset:24576
    s_addc_u32 s9, s9, 0
    v_mfma_f32_16x16x32_bf16 v[176:179], a[172:175], a[92:95], v[176:179]
    ds_read_b64_tr_b16 a[138:139], v14 offset:25088
    v_mfma_f32_16x16x32_bf16 v[152:155], a[172:175], a[84:87], v[152:155]
    ds_read_b64_tr_b16 a[140:141], v14 offset:28672
    s_add_u32 m0, s45, 139264
    v_mfma_f32_16x16x32_bf16 v[152:155], a[168:171], a[80:83], v[152:155]
    buffer_load_dwordx4 v8, s[28:31], 0 offen offset:0 lds
    v_mfma_f32_16x16x32_bf16 v[128:131], a[168:171], a[72:75], v[128:131]
    ds_read_b64_tr_b16 a[142:143], v14 offset:29184
    v_mfma_f32_16x16x32_bf16 v[128:131], a[172:175], a[76:79], v[128:131]
    s_cmp_lg_u32 s93, 2
    s_cselect_b32 s94, 0x80000000, 0
    v_or_b32 v40, s94, v2
    v_mfma_f32_16x16x32_bf16 v[104:107], a[172:175], a[68:71], v[104:107]
    v_cvt_pk_bf16_f32 v24, v26, v27
    v_cvt_pk_bf16_f32 v25, v28, v29
    v_mfma_f32_16x16x32_bf16 v[104:107], a[168:171], a[64:67], v[104:107]
    buffer_atomic_add v19, v40, s[32:35], s46 offen
    s_waitcnt lgkmcnt(1)
    v_mfma_f32_16x16x32_bf16 v[108:111], a[128:131], a[96:99], v[108:111]
    ds_read_b64_tr_b16 a[144:145], v15 offset:32768
    v_mfma_f32_16x16x32_bf16 v[108:111], a[132:135], a[100:103], v[108:111]
    buffer_load_dwordx4 v9, s[28:31], 0 offen offset:1024 lds
    s_add_u32 s28, s28, 2048
    v_mfma_f32_16x16x32_bf16 v[132:135], a[132:135], a[108:111], v[132:135]
    ds_read_b64_tr_b16 a[146:147], v15 offset:33280
    s_addc_u32 s29, s29, 0
    v_mfma_f32_16x16x32_bf16 v[132:135], a[128:131], a[104:107], v[132:135]
    ds_read_b64_tr_b16 a[148:149], v15 offset:36864
    v_mfma_f32_16x16x32_bf16 v[156:159], a[128:131], a[112:115], v[156:159]
    ds_read_b64_tr_b16 a[150:151], v15 offset:37376
    s_add_u32 m0, s45, 65536
    v_mfma_f32_16x16x32_bf16 v[156:159], a[132:135], a[116:119], v[156:159]
    buffer_load_dwordx4 v8, s[28:31], 0 offen offset:0 lds
    v_mfma_f32_16x16x32_bf16 v[180:183], a[132:135], a[124:127], v[180:183]
    ds_read_b64_tr_b16 a[152:153], v16 offset:32768
    v_mfma_f32_16x16x32_bf16 v[180:183], a[128:131], a[120:123], v[180:183]
    ds_read_b64_tr_b16 a[154:155], v16 offset:33280
    v_mfma_f32_16x16x32_bf16 v[184:187], a[136:139], a[120:123], v[184:187]
    ds_read_b64_tr_b16 a[156:157], v16 offset:36864
    s_waitcnt lgkmcnt(3)
    v_mfma_f32_16x16x32_bf16 v[184:187], a[140:143], a[124:127], v[184:187]
    buffer_load_dwordx4 v9, s[28:31], 0 offen offset:1024 lds
    s_sub_u32 s28, s28, 4096
    v_mfma_f32_16x16x32_bf16 v[160:163], a[140:143], a[116:119], v[160:163]
    ds_read_b64_tr_b16 a[158:159], v16 offset:37376
    s_subb_u32 s29, s29, 0
    v_mfma_f32_16x16x32_bf16 v[160:163], a[136:139], a[112:115], v[160:163]
    ds_read_b64_tr_b16 a[160:161], v15 offset:40960
    v_mfma_f32_16x16x32_bf16 v[136:139], a[136:139], a[104:107], v[136:139]
    ds_read_b64_tr_b16 a[162:163], v15 offset:41472
    v_mfma_f32_16x16x32_bf16 v[136:139], a[140:143], a[108:111], v[136:139]
    ds_read_b64_tr_b16 a[164:165], v15 offset:45056
    v_mfma_f32_16x16x32_bf16 v[112:115], a[140:143], a[100:103], v[112:115]
    ds_read_b64_tr_b16 a[166:167], v15 offset:45568
    v_mfma_f32_16x16x32_bf16 v[112:115], a[136:139], a[96:99], v[112:115]
    ds_read_b64_tr_b16 a[168:169], v16 offset:40960
    s_add_u32 m0, s45, 73728
    v_mfma_f32_16x16x32_bf16 v[116:119], a[96:99], a[144:147], v[116:119]
    buffer_load_dwordx4 v8, s[28:31], 0 offen offset:0 lds
    v_mfma_f32_16x16x32_bf16 v[116:119], a[100:103], a[148:151], v[116:119]
    ds_read_b64_tr_b16 a[170:171], v16 offset:41472
    v_mfma_f32_16x16x32_bf16 v[140:143], a[108:111], a[148:151], v[140:143]
    ds_read_b64_tr_b16 a[172:173], v16 offset:45056
    v_mfma_f32_16x16x32_bf16 v[140:143], a[104:107], a[144:147], v[140:143]
    ds_read_b64_tr_b16 a[174:175], v16 offset:45568
    v_mfma_f32_16x16x32_bf16 v[164:167], a[112:115], a[144:147], v[164:167]
    buffer_load_dwordx4 v9, s[28:31], 0 offen offset:1024 lds
    s_add_u32 s28, s28, 395264
    v_mfma_f32_16x16x32_bf16 v[164:167], a[116:119], a[148:151], v[164:167]
    s_addc_u32 s29, s29, 0
    v_mfma_f32_16x16x32_bf16 v[188:191], a[124:127], a[148:151], v[188:191]
    v_mfma_f32_16x16x32_bf16 v[188:191], a[120:123], a[144:147], v[188:191]
    s_waitcnt lgkmcnt(1)
    v_mfma_f32_16x16x32_bf16 v[192:195], a[120:123], a[152:155], v[192:195]
    s_waitcnt vmcnt(11) lgkmcnt(0)
    s_barrier
    ds_read_b128 a[64:67], v11 offset:49152
    v_mfma_f32_16x16x32_bf16 v[192:195], a[124:127], a[156:159], v[192:195]
    ds_read_b64_tr_b16 a[128:129], v13 offset:0
    s_add_u32 m0, s44, 16384
    v_mfma_f32_16x16x32_bf16 v[168:171], a[116:119], a[156:159], v[168:171]
    buffer_load_dwordx4 v4, s[8:11], 0 offen offset:0 lds
    v_mfma_f32_16x16x32_bf16 v[168:171], a[112:115], a[152:155], v[168:171]
    ds_read_b64_tr_b16 a[130:131], v13 offset:512
    v_mfma_f32_16x16x32_bf16 v[144:147], a[104:107], a[152:155], v[144:147]
    ds_read_b128 a[68:71], v12 offset:49152
    v_mfma_f32_16x16x32_bf16 v[144:147], a[108:111], a[156:159], v[144:147]
    ds_read_b64_tr_b16 a[132:133], v13 offset:4096
    v_mfma_f32_16x16x32_bf16 v[120:123], a[100:103], a[156:159], v[120:123]
    buffer_load_dwordx4 v5, s[8:11], 0 offen offset:1024 lds
    v_mfma_f32_16x16x32_bf16 v[120:123], a[96:99], a[152:155], v[120:123]
    ds_read_b64_tr_b16 a[134:135], v13 offset:4608
    v_mfma_f32_16x16x32_bf16 v[100:103], a[160:163], a[96:99], v[100:103]
    ds_read_b128 a[76:79], v12 offset:51200
    v_mfma_f32_16x16x32_bf16 v[100:103], a[164:167], a[100:103], v[100:103]
    ds_read_b128 a[72:75], v11 offset:51200
    v_mfma_f32_16x16x32_bf16 v[124:127], a[164:167], a[108:111], v[124:127]
    buffer_load_dwordx4 v6, s[8:11], 0 offen offset:2048 lds
    v_mfma_f32_16x16x32_bf16 v[124:127], a[160:163], a[104:107], v[124:127]
    ds_read_b128 a[80:83], v11 offset:53248
    v_mfma_f32_16x16x32_bf16 v[148:151], a[160:163], a[112:115], v[148:151]
    ds_read_b128 a[84:87], v12 offset:53248
    v_mfma_f32_16x16x32_bf16 v[148:151], a[164:167], a[116:119], v[148:151]
    ds_read_b128 a[92:95], v12 offset:55296
    v_mfma_f32_16x16x32_bf16 v[172:175], a[164:167], a[124:127], v[172:175]
    ds_read_b128 a[88:91], v11 offset:55296
    v_mfma_f32_16x16x32_bf16 v[172:175], a[160:163], a[120:123], v[172:175]
    buffer_load_dwordx4 v7, s[8:11], 0 offen offset:3072 lds
    s_add_u32 s8, s8, 128
    v_mfma_f32_16x16x32_bf16 v[176:179], a[168:171], a[120:123], v[176:179]
    ds_read_b64_tr_b16 a[136:137], v14 offset:0
    s_addc_u32 s9, s9, 0
    v_mfma_f32_16x16x32_bf16 v[176:179], a[172:175], a[124:127], v[176:179]
    ds_read_b64_tr_b16 a[138:139], v14 offset:512
    v_mfma_f32_16x16x32_bf16 v[152:155], a[172:175], a[116:119], v[152:155]
    ds_read_b64_tr_b16 a[140:141], v14 offset:4096
    s_add_u32 m0, s45, 147456
    v_mfma_f32_16x16x32_bf16 v[152:155], a[168:171], a[112:115], v[152:155]
    buffer_load_dwordx4 v8, s[28:31], 0 offen offset:0 lds
    v_mfma_f32_16x16x32_bf16 v[128:131], a[168:171], a[104:107], v[128:131]
    ds_read_b64_tr_b16 a[142:143], v14 offset:4608
    v_mfma_f32_16x16x32_bf16 v[128:131], a[172:175], a[108:111], v[128:131]
    s_cmp_lg_u32 s93, 3
    s_cselect_b32 s94, 0x80000000, 0
    v_or_b32 v40, s94, v2
    v_mfma_f32_16x16x32_bf16 v[104:107], a[172:175], a[100:103], v[104:107]
    v_xor_b32 v26, v22, v24
    v_xor_b32 v27, v22, v25
    v_mfma_f32_16x16x32_bf16 v[104:107], a[168:171], a[96:99], v[104:107]
    buffer_atomic_add v19, v40, s[32:35], s46 offen
    s_waitcnt lgkmcnt(1)
    v_mfma_f32_16x16x32_bf16 v[108:111], a[128:131], a[64:67], v[108:111]
    ds_read_b64_tr_b16 a[144:145], v15 offset:49152
    v_accvgpr_write_b32 a0, v24
    v_mfma_f32_16x16x32_bf16 v[108:111], a[132:135], a[68:71], v[108:111]
    buffer_load_dwordx4 v9, s[28:31], 0 offen offset:1024 lds
    s_add_u32 s28, s28, 2048
    v_mfma_f32_16x16x32_bf16 v[132:135], a[132:135], a[76:79], v[132:135]
    ds_read_b64_tr_b16 a[146:147], v15 offset:49664
    s_addc_u32 s29, s29, 0
    v_mfma_f32_16x16x32_bf16 v[132:135], a[128:131], a[72:75], v[132:135]
    ds_read_b64_tr_b16 a[148:149], v15 offset:53248
    v_accvgpr_write_b32 a16, v25
    v_mfma_f32_16x16x32_bf16 v[156:159], a[128:131], a[80:83], v[156:159]
    ds_read_b64_tr_b16 a[150:151], v15 offset:53760
    s_add_u32 m0, s45, 81920
    v_mfma_f32_16x16x32_bf16 v[156:159], a[132:135], a[84:87], v[156:159]
    buffer_load_dwordx4 v8, s[28:31], 0 offen offset:0 lds
    v_accvgpr_write_b32 a8, v26
    v_mfma_f32_16x16x32_bf16 v[180:183], a[132:135], a[92:95], v[180:183]
    ds_read_b64_tr_b16 a[152:153], v16 offset:49152
    v_accvgpr_write_b32 a24, v27
    v_mfma_f32_16x16x32_bf16 v[180:183], a[128:131], a[88:91], v[180:183]
    ds_read_b64_tr_b16 a[154:155], v16 offset:49664
    v_xor_b32 v25, s73, v25
    v_mfma_f32_16x16x32_bf16 v[184:187], a[136:139], a[88:91], v[184:187]
    ds_read_b64_tr_b16 a[156:157], v16 offset:53248
    s_waitcnt lgkmcnt(3)
    v_mfma_f32_16x16x32_bf16 v[184:187], a[140:143], a[92:95], v[184:187]
    buffer_load_dwordx4 v9, s[28:31], 0 offen offset:1024 lds
    s_sub_u32 s28, s28, 4096
    v_mfma_f32_16x16x32_bf16 v[160:163], a[140:143], a[84:87], v[160:163]
    ds_read_b64_tr_b16 a[158:159], v16 offset:53760
    s_subb_u32 s29, s29, 0
    v_mfma_f32_16x16x32_bf16 v[160:163], a[136:139], a[80:83], v[160:163]
    ds_read_b64_tr_b16 a[160:161], v15 offset:57344
    v_xor_b32 v27, s73, v27
    v_mfma_f32_16x16x32_bf16 v[136:139], a[136:139], a[72:75], v[136:139]
    ds_read_b64_tr_b16 a[162:163], v15 offset:57856
    v_accvgpr_write_b32 a32, v25
    v_mfma_f32_16x16x32_bf16 v[136:139], a[140:143], a[76:79], v[136:139]
    ds_read_b64_tr_b16 a[164:165], v15 offset:61440
    v_accvgpr_write_b32 a40, v27
    v_mfma_f32_16x16x32_bf16 v[112:115], a[140:143], a[68:71], v[112:115]
    ds_read_b64_tr_b16 a[166:167], v15 offset:61952
    v_fmamk_f32 v30, v21, 0x40000000, v20
    v_mfma_f32_16x16x32_bf16 v[112:115], a[136:139], a[64:67], v[112:115]
    ds_read_b64_tr_b16 a[168:169], v16 offset:57344
    s_add_u32 m0, s45, 90112
    v_mfma_f32_16x16x32_bf16 v[116:119], a[64:67], a[144:147], v[116:119]
L_pad_3:
    s_cmp_eq_u32 s3, 1
    s_cbranch_scc1 L_walkret
    buffer_load_dwordx4 v8, s[28:31], 0 offen offset:0 lds
    v_fmamk_f32 v31, v21, 0x40400000, v20
    v_mfma_f32_16x16x32_bf16 v[116:119], a[68:71], a[148:151], v[116:119]
    ds_read_b64_tr_b16 a[170:171], v16 offset:57856
    v_cos_f32 v32, v30
    v_mfma_f32_16x16x32_bf16 v[140:143], a[76:79], a[148:151], v[140:143]
    ds_read_b64_tr_b16 a[172:173], v16 offset:61440
    v_sin_f32 v34, v30
    v_mfma_f32_16x16x32_bf16 v[140:143], a[72:75], a[144:147], v[140:143]
    ds_read_b64_tr_b16 a[174:175], v16 offset:61952
    v_cos_f32 v33, v31
    v_mfma_f32_16x16x32_bf16 v[164:167], a[80:83], a[144:147], v[164:167]
    buffer_load_dwordx4 v9, s[28:31], 0 offen offset:1024 lds
    s_add_u32 s28, s28, 395264
    v_mfma_f32_16x16x32_bf16 v[164:167], a[84:87], a[148:151], v[164:167]
    s_addc_u32 s29, s29, 0
    v_mfma_f32_16x16x32_bf16 v[188:191], a[92:95], a[148:151], v[188:191]
    v_mfma_f32_16x16x32_bf16 v[188:191], a[88:91], a[144:147], v[188:191]
    s_waitcnt lgkmcnt(1)
    v_mfma_f32_16x16x32_bf16 v[192:195], a[88:91], a[152:155], v[192:195]
    s_waitcnt vmcnt(11) lgkmcnt(0)
    s_barrier
    ds_read_b128 a[96:99], v11 offset:0
    v_mfma_f32_16x16x32_bf16 v[192:195], a[92:95], a[156:159], v[192:195]
    ds_read_b64_tr_b16 a[128:129], v13 offset:8192
    s_add_u32 m0, s44, 32768
    v_mfma_f32_16x16x32_bf16 v[168:171], a[84:87], a[156:159], v[168:171]
    buffer_load_dwordx4 v4, s[8:11], 0 offen offset:0 lds
    v_mfma_f32_16x16x32_bf16 v[168:171], a[80:83], a[152:155], v[168:171]
    ds_read_b64_tr_b16 a[130:131], v13 offset:8704
    v_mfma_f32_16x16x32_bf16 v[144:147], a[72:75], a[152:155], v[144:147]
    ds_read_b128 a[100:103], v12 offset:0
    v_mfma_f32_16x16x32_bf16 v[144:147], a[76:79], a[156:159], v[144:147]
    ds_read_b64_tr_b16 a[132:133], v13 offset:12288
    v_mfma_f32_16x16x32_bf16 v[120:123], a[68:71], a[156:159], v[120:123]
    buffer_load_dwordx4 v5, s[8:11], 0 offen offset:1024 lds
    v_mfma_f32_16x16x32_bf16 v[120:123], a[64:67], a[152:155], v[120:123]
    ds_read_b64_tr_b16 a[134:135], v13 offset:12800
    v_mfma_f32_16x16x32_bf16 v[100:103], a[160:163], a[64:67], v[100:103]
    ds_read_b128 a[108:111], v12 offset:2048
    v_mfma_f32_16x16x32_bf16 v[100:103], a[164:167], a[68:71], v[100:103]
    ds_read_b128 a[104:107], v11 offset:2048
    v_sin_f32 v35, v31
    v_mfma_f32_16x16x32_bf16 v[124:127], a[164:167], a[76:79], v[124:127]
    buffer_load_dwordx4 v6, s[8:11], 0 offen offset:2048 lds
    v_cvt_pk_bf16_f32 v30, v32, v33
    v_mfma_f32_16x16x32_bf16 v[124:127], a[160:163], a[72:75], v[124:127]
    ds_read_b128 a[112:115], v11 offset:4096
    v_cvt_pk_bf16_f32 v31, v34, v35
    v_mfma_f32_16x16x32_bf16 v[148:151], a[160:163], a[80:83], v[148:151]
    ds_read_b128 a[116:119], v12 offset:4096
    v_xor_b32 v32, v22, v30
    v_mfma_f32_16x16x32_bf16 v[148:151], a[164:167], a[84:87], v[148:151]
    ds_read_b128 a[124:127], v12 offset:6144
    v_xor_b32 v33, v22, v31
    v_mfma_f32_16x16x32_bf16 v[172:175], a[164:167], a[92:95], v[172:175]
    ds_read_b128 a[120:123], v11 offset:6144
    v_accvgpr_write_b32 a1, v30
    v_mfma_f32_16x16x32_bf16 v[172:175], a[160:163], a[88:91], v[172:175]
    buffer_load_dwordx4 v7, s[8:11], 0 offen offset:3072 lds
    s_add_u32 s8, s8, 128
    v_mfma_f32_16x16x32_bf16 v[176:179], a[168:171], a[88:91], v[176:179]
    ds_read_b64_tr_b16 a[136:137], v14 offset:8192
    s_addc_u32 s9, s9, 0
    v_mfma_f32_16x16x32_bf16 v[176:179], a[172:175], a[92:95], v[176:179]
    ds_read_b64_tr_b16 a[138:139], v14 offset:8704
    v_accvgpr_write_b32 a17, v31
    v_mfma_f32_16x16x32_bf16 v[152:155], a[172:175], a[84:87], v[152:155]
    ds_read_b64_tr_b16 a[140:141], v14 offset:12288
    s_add_u32 m0, s45, 155648
    v_mfma_f32_16x16x32_bf16 v[152:155], a[168:171], a[80:83], v[152:155]
    buffer_load_dwordx4 v8, s[28:31], 0 offen offset:0 lds
    v_accvgpr_write_b32 a9, v32
    v_mfma_f32_16x16x32_bf16 v[128:131], a[168:171], a[72:75], v[128:131]
    ds_read_b64_tr_b16 a[142:143], v14 offset:12800
    v_accvgpr_write_b32 a25, v33
    v_mfma_f32_16x16x32_bf16 v[128:131], a[172:175], a[76:79], v[128:131]
    v_xor_b32 v31, s73, v31
    v_xor_b32 v33, s73, v33
    v_mfma_f32_16x16x32_bf16 v[104:107], a[172:175], a[68:71], v[104:107]
    v_accvgpr_write_b32 a33, v31
    v_accvgpr_write_b32 a41, v33
    v_mfma_f32_16x16x32_bf16 v[104:107], a[168:171], a[64:67], v[104:107]
    v_fmamk_f32 v24, v21, 0x40800000, v20
    v_fmamk_f32 v25, v21, 0x40a00000, v20
    s_waitcnt lgkmcnt(2)
    v_mfma_f32_16x16x32_bf16 v[108:111], a[128:131], a[96:99], v[108:111]
    ds_read_b64_tr_b16 a[144:145], v15 offset:0
    v_cos_f32 v26, v24
    v_mfma_f32_16x16x32_bf16 v[108:111], a[132:135], a[100:103], v[108:111]
    buffer_load_dwordx4 v9, s[28:31], 0 offen offset:1024 lds
    s_add_u32 s28, s28, 2048
    v_mfma_f32_16x16x32_bf16 v[132:135], a[132:135], a[108:111], v[132:135]
    ds_read_b64_tr_b16 a[146:147], v15 offset:512
    s_addc_u32 s29, s29, 0
    v_mfma_f32_16x16x32_bf16 v[132:135], a[128:131], a[104:107], v[132:135]
    ds_read_b64_tr_b16 a[148:149], v15 offset:4096
    v_sin_f32 v28, v24
    v_mfma_f32_16x16x32_bf16 v[156:159], a[128:131], a[112:115], v[156:159]
    ds_read_b64_tr_b16 a[150:151], v15 offset:4608
    s_add_u32 m0, s45, 98304
    v_mfma_f32_16x16x32_bf16 v[156:159], a[132:135], a[116:119], v[156:159]
    buffer_load_dwordx4 v8, s[28:31], 0 offen offset:0 lds
    v_cos_f32 v27, v25
    v_mfma_f32_16x16x32_bf16 v[180:183], a[132:135], a[124:127], v[180:183]
    ds_read_b64_tr_b16 a[152:153], v16 offset:0
    v_sin_f32 v29, v25
    v_mfma_f32_16x16x32_bf16 v[180:183], a[128:131], a[120:123], v[180:183]
    ds_read_b64_tr_b16 a[154:155], v16 offset:512
    v_cvt_pk_bf16_f32 v24, v26, v27
    v_mfma_f32_16x16x32_bf16 v[184:187], a[136:139], a[120:123], v[184:187]
    ds_read_b64_tr_b16 a[156:157], v16 offset:4096
    s_waitcnt lgkmcnt(3)
    v_mfma_f32_16x16x32_bf16 v[184:187], a[140:143], a[124:127], v[184:187]
    buffer_load_dwordx4 v9, s[28:31], 0 offen offset:1024 lds
    s_sub_u32 s28, s28, 4096
    v_mfma_f32_16x16x32_bf16 v[160:163], a[140:143], a[116:119], v[160:163]
    ds_read_b64_tr_b16 a[158:159], v16 offset:4608
    s_subb_u32 s29, s29, 0
    v_mfma_f32_16x16x32_bf16 v[160:163], a[136:139], a[112:115], v[160:163]
    ds_read_b64_tr_b16 a[160:161], v15 offset:8192
    v_cvt_pk_bf16_f32 v25, v28, v29
    v_mfma_f32_16x16x32_bf16 v[136:139], a[136:139], a[104:107], v[136:139]
    ds_read_b64_tr_b16 a[162:163], v15 offset:8704
    v_xor_b32 v26, v22, v24
    v_mfma_f32_16x16x32_bf16 v[136:139], a[140:143], a[108:111], v[136:139]
    ds_read_b64_tr_b16 a[164:165], v15 offset:12288
    v_xor_b32 v27, v22, v25
    v_mfma_f32_16x16x32_bf16 v[112:115], a[140:143], a[100:103], v[112:115]
    ds_read_b64_tr_b16 a[166:167], v15 offset:12800
    v_accvgpr_write_b32 a2, v24
    v_mfma_f32_16x16x32_bf16 v[112:115], a[136:139], a[96:99], v[112:115]
    ds_read_b64_tr_b16 a[168:169], v16 offset:8192
    s_add_u32 m0, s45, 106496
    v_mfma_f32_16x16x32_bf16 v[116:119], a[96:99], a[144:147], v[116:119]
    buffer_load_dwordx4 v8, s[28:31], 0 offen offset:0 lds
    v_accvgpr_write_b32 a18, v25
    v_mfma_f32_16x16x32_bf16 v[116:119], a[100:103], a[148:151], v[116:119]
    ds_read_b64_tr_b16 a[170:171], v16 offset:8704
    v_accvgpr_write_b32 a10, v26
    v_mfma_f32_16x16x32_bf16 v[140:143], a[108:111], a[148:151], v[140:143]
    ds_read_b64_tr_b16 a[172:173], v16 offset:12288
    v_accvgpr_write_b32 a26, v27
    v_mfma_f32_16x16x32_bf16 v[140:143], a[104:107], a[144:147], v[140:143]
    ds_read_b64_tr_b16 a[174:175], v16 offset:12800
    v_xor_b32 v25, s73, v25
    v_mfma_f32_16x16x32_bf16 v[164:167], a[112:115], a[144:147], v[164:167]
    buffer_load_dwordx4 v9, s[28:31], 0 offen offset:1024 lds
    s_add_u32 s28, s28, 395264
    v_mfma_f32_16x16x32_bf16 v[164:167], a[116:119], a[148:151], v[164:167]
    s_addc_u32 s29, s29, 0
    v_mfma_f32_16x16x32_bf16 v[188:191], a[124:127], a[148:151], v[188:191]
    v_mfma_f32_16x16x32_bf16 v[188:191], a[120:123], a[144:147], v[188:191]
    s_waitcnt lgkmcnt(1)
    v_mfma_f32_16x16x32_bf16 v[192:195], a[120:123], a[152:155], v[192:195]
    s_waitcnt vmcnt(10) lgkmcnt(0)
    s_barrier
    ds_read_b128 a[64:67], v11 offset:16384
    v_mfma_f32_16x16x32_bf16 v[192:195], a[124:127], a[156:159], v[192:195]
    ds_read_b64_tr_b16 a[128:129], v13 offset:16384
    s_add_u32 m0, s44, 49152
    v_mfma_f32_16x16x32_bf16 v[168:171], a[116:119], a[156:159], v[168:171]
    buffer_load_dwordx4 v4, s[8:11], 0 offen offset:0 lds
    v_mfma_f32_16x16x32_bf16 v[168:171], a[112:115], a[152:155], v[168:171]
    ds_read_b64_tr_b16 a[130:131], v13 offset:16896
    v_mfma_f32_16x16x32_bf16 v[144:147], a[104:107], a[152:155], v[144:147]
    ds_read_b128 a[68:71], v12 offset:16384
    v_mfma_f32_16x16x32_bf16 v[144:147], a[108:111], a[156:159], v[144:147]
    ds_read_b64_tr_b16 a[132:133], v13 offset:20480
    v_mfma_f32_16x16x32_bf16 v[120:123], a[100:103], a[156:159], v[120:123]
    buffer_load_dwordx4 v5, s[8:11], 0 offen offset:1024 lds
    v_mfma_f32_16x16x32_bf16 v[120:123], a[96:99], a[152:155], v[120:123]
    ds_read_b64_tr_b16 a[134:135], v13 offset:20992
    v_mfma_f32_16x16x32_bf16 v[100:103], a[160:163], a[96:99], v[100:103]
    ds_read_b128 a[76:79], v12 offset:18432
    v_mfma_f32_16x16x32_bf16 v[100:103], a[164:167], a[100:103], v[100:103]
    ds_read_b128 a[72:75], v11 offset:18432
    v_xor_b32 v27, s73, v27
    v_mfma_f32_16x16x32_bf16 v[124:127], a[164:167], a[108:111], v[124:127]
    buffer_load_dwordx4 v6, s[8:11], 0 offen offset:2048 lds
    v_accvgpr_write_b32 a34, v25
    v_mfma_f32_16x16x32_bf16 v[124:127], a[160:163], a[104:107], v[124:127]
    ds_read_b128 a[80:83], v11 offset:20480
    v_accvgpr_write_b32 a42, v27
    v_mfma_f32_16x16x32_bf16 v[148:151], a[160:163], a[112:115], v[148:151]
    ds_read_b128 a[84:87], v12 offset:20480
    v_fmamk_f32 v30, v21, 0x40c00000, v20
    v_mfma_f32_16x16x32_bf16 v[148:151], a[164:167], a[116:119], v[148:151]
    ds_read_b128 a[92:95], v12 offset:22528
    v_fmamk_f32 v31, v21, 0x40e00000, v20
    v_mfma_f32_16x16x32_bf16 v[172:175], a[164:167], a[124:127], v[172:175]
    ds_read_b128 a[88:91], v11 offset:22528
    v_cos_f32 v32, v30
    v_mfma_f32_16x16x32_bf16 v[172:175], a[160:163], a[120:123], v[172:175]
    buffer_load_dwordx4 v7, s[8:11], 0 offen offset:3072 lds
    s_add_u32 s8, s8, 128
    v_mfma_f32_16x16x32_bf16 v[176:179], a[168:171], a[120:123], v[176:179]
    ds_read_b64_tr_b16 a[136:137], v14 offset:16384
    s_addc_u32 s9, s9, 0
    v_mfma_f32_16x16x32_bf16 v[176:179], a[172:175], a[124:127], v[176:179]
    ds_read_b64_tr_b16 a[138:139], v14 offset:16896
    v_sin_f32 v34, v30
    v_mfma_f32_16x16x32_bf16 v[152:155], a[172:175], a[116:119], v[152:155]
    ds_read_b64_tr_b16 a[140:141], v14 offset:20480
    s_add_u32 m0, s45, 131072
    v_mfma_f32_16x16x32_bf16 v[152:155], a[168:171], a[112:115], v[152:155]
    buffer_load_dwordx4 v8, s[28:31], 0 offen offset:0 lds
    v_cos_f32 v33, v31
    v_mfma_f32_16x16x32_bf16 v[128:131], a[168:171], a[104:107], v[128:131]
    ds_read_b64_tr_b16 a[142:143], v14 offset:20992
    v_sin_f32 v35, v31
    v_mfma_f32_16x16x32_bf16 v[128:131], a[172:175], a[108:111], v[128:131]
    v_cvt_pk_bf16_f32 v30, v32, v33
    v_cvt_pk_bf16_f32 v31, v34, v35
    v_mfma_f32_16x16x32_bf16 v[104:107], a[172:175], a[100:103], v[104:107]
    v_xor_b32 v32, v22, v30
    v_xor_b32 v33, v22, v31
    v_mfma_f32_16x16x32_bf16 v[104:107], a[168:171], a[96:99], v[104:107]
    v_accvgpr_write_b32 a3, v30
    v_accvgpr_write_b32 a19, v31
    s_waitcnt lgkmcnt(2)
    v_mfma_f32_16x16x32_bf16 v[108:111], a[128:131], a[64:67], v[108:111]
    ds_read_b64_tr_b16 a[144:145], v15 offset:16384
    v_accvgpr_write_b32 a11, v32
    v_mfma_f32_16x16x32_bf16 v[108:111], a[132:135], a[68:71], v[108:111]
    buffer_load_dwordx4 v9, s[28:31], 0 offen offset:1024 lds
    s_add_u32 s28, s28, 2048
    v_mfma_f32_16x16x32_bf16 v[132:135], a[132:135], a[76:79], v[132:135]
    ds_read_b64_tr_b16 a[146:147], v15 offset:16896
    s_addc_u32 s29, s29, 0
    v_mfma_f32_16x16x32_bf16 v[132:135], a[128:131], a[72:75], v[132:135]
    ds_read_b64_tr_b16 a[148:149], v15 offset:20480
    v_accvgpr_write_b32 a27, v33
    v_mfma_f32_16x16x32_bf16 v[156:159], a[128:131], a[80:83], v[156:159]
    ds_read_b64_tr_b16 a[150:151], v15 offset:20992
    s_add_u32 m0, s45, 114688
    v_mfma_f32_16x16x32_bf16 v[156:159], a[132:135], a[84:87], v[156:159]
    buffer_load_dwordx4 v8, s[28:31], 0 offen offset:0 lds
    v_xor_b32 v31, s73, v31
    v_mfma_f32_16x16x32_bf16 v[180:183], a[132:135], a[92:95], v[180:183]
    ds_read_b64_tr_b16 a[152:153], v16 offset:16384
    v_xor_b32 v33, s73, v33
    v_mfma_f32_16x16x32_bf16 v[180:183], a[128:131], a[88:91], v[180:183]
    ds_read_b64_tr_b16 a[154:155], v16 offset:16896
    v_accvgpr_write_b32 a35, v31
    v_mfma_f32_16x16x32_bf16 v[184:187], a[136:139], a[88:91], v[184:187]
    ds_read_b64_tr_b16 a[156:157], v16 offset:20480
    s_waitcnt lgkmcnt(3)
    v_mfma_f32_16x16x32_bf16 v[184:187], a[140:143], a[92:95], v[184:187]
    buffer_load_dwordx4 v9, s[28:31], 0 offen offset:1024 lds
    s_sub_u32 s28, s28, 4096
    v_mfma_f32_16x16x32_bf16 v[160:163], a[140:143], a[84:87], v[160:163]
    ds_read_b64_tr_b16 a[158:159], v16 offset:20992
    s_subb_u32 s29, s29, 0
    v_mfma_f32_16x16x32_bf16 v[160:163], a[136:139], a[80:83], v[160:163]
    ds_read_b64_tr_b16 a[160:161], v15 offset:24576
    v_accvgpr_write_b32 a43, v33
    v_mfma_f32_16x16x32_bf16 v[136:139], a[136:139], a[72:75], v[136:139]
    ds_read_b64_tr_b16 a[162:163], v15 offset:25088
    v_fmamk_f32 v24, v21, 0x41800000, v20
    v_mfma_f32_16x16x32_bf16 v[136:139], a[140:143], a[76:79], v[136:139]
    ds_read_b64_tr_b16 a[164:165], v15 offset:28672
    v_fmamk_f32 v25, v21, 0x41880000, v20
    v_mfma_f32_16x16x32_bf16 v[112:115], a[140:143], a[68:71], v[112:115]
    ds_read_b64_tr_b16 a[166:167], v15 offset:29184
    v_cos_f32 v26, v24
    v_mfma_f32_16x16x32_bf16 v[112:115], a[136:139], a[64:67], v[112:115]
    ds_read_b64_tr_b16 a[168:169], v16 offset:24576
    s_add_u32 m0, s45, 122880
    v_mfma_f32_16x16x32_bf16 v[116:119], a[64:67], a[144:147], v[116:119]
    buffer_load_dwordx4 v8, s[28:31], 0 offen offset:0 lds
    v_sin_f32 v28, v24
    v_mfma_f32_16x16x32_bf16 v[116:119], a[68:71], a[148:151], v[116:119]
    ds_read_b64_tr_b16 a[170:171], v16 offset:25088
    v_cos_f32 v27, v25
    v_mfma_f32_16x16x32_bf16 v[140:143], a[76:79], a[148:151], v[140:143]
    ds_read_b64_tr_b16 a[172:173], v16 offset:28672
    v_sin_f32 v29, v25
    v_mfma_f32_16x16x32_bf16 v[140:143], a[72:75], a[144:147], v[140:143]
    ds_read_b64_tr_b16 a[174:175], v16 offset:29184
    v_cvt_pk_bf16_f32 v24, v26, v27
    v_mfma_f32_16x16x32_bf16 v[164:167], a[80:83], a[144:147], v[164:167]
    buffer_load_dwordx4 v9, s[28:31], 0 offen offset:1024 lds
    s_add_u32 s28, s28, 395264
    v_mfma_f32_16x16x32_bf16 v[164:167], a[84:87], a[148:151], v[164:167]
    s_addc_u32 s29, s29, 0
    v_mfma_f32_16x16x32_bf16 v[188:191], a[92:95], a[148:151], v[188:191]
    v_mfma_f32_16x16x32_bf16 v[188:191], a[88:91], a[144:147], v[188:191]
    s_waitcnt lgkmcnt(1)
    v_mfma_f32_16x16x32_bf16 v[192:195], a[88:91], a[152:155], v[192:195]
    s_waitcnt vmcnt(10) lgkmcnt(0)
    s_barrier
    ds_read_b128 a[96:99], v11 offset:32768
    v_mfma_f32_16x16x32_bf16 v[192:195], a[92:95], a[156:159], v[192:195]
    ds_read_b64_tr_b16 a[128:129], v13 offset:24576
    s_add_u32 m0, s44, 0
    v_mfma_f32_16x16x32_bf16 v[168:171], a[84:87], a[156:159], v[168:171]
    buffer_load_dwordx4 v4, s[8:11], 0 offen offset:0 lds
    v_mfma_f32_16x16x32_bf16 v[168:171], a[80:83], a[152:155], v[168:171]
    ds_read_b64_tr_b16 a[130:131], v13 offset:25088
    v_mfma_f32_16x16x32_bf16 v[144:147], a[72:75], a[152:155], v[144:147]
    ds_read_b128 a[100:103], v12 offset:32768
    v_mfma_f32_16x16x32_bf16 v[144:147], a[76:79], a[156:159], v[144:147]
    ds_read_b64_tr_b16 a[132:133], v13 offset:28672
    v_mfma_f32_16x16x32_bf16 v[120:123], a[68:71], a[156:159], v[120:123]
    buffer_load_dwordx4 v5, s[8:11], 0 offen offset:1024 lds
    v_mfma_f32_16x16x32_bf16 v[120:123], a[64:67], a[152:155], v[120:123]
    ds_read_b64_tr_b16 a[134:135], v13 offset:29184
    v_mfma_f32_16x16x32_bf16 v[100:103], a[160:163], a[64:67], v[100:103]
    ds_read_b128 a[108:111], v12 offset:34816
    v_mfma_f32_16x16x32_bf16 v[100:103], a[164:167], a[68:71], v[100:103]
    ds_read_b128 a[104:107], v11 offset:34816
    v_cvt_pk_bf16_f32 v25, v28, v29
    v_mfma_f32_16x16x32_bf16 v[124:127], a[164:167], a[76:79], v[124:127]
    buffer_load_dwordx4 v6, s[8:11], 0 offen offset:2048 lds
    v_xor_b32 v26, v22, v24
    v_mfma_f32_16x16x32_bf16 v[124:127], a[160:163], a[72:75], v[124:127]
    ds_read_b128 a[112:115], v11 offset:36864
    v_xor_b32 v27, v22, v25
    v_mfma_f32_16x16x32_bf16 v[148:151], a[160:163], a[80:83], v[148:151]
    ds_read_b128 a[116:119], v12 offset:36864
    v_accvgpr_write_b32 a4, v24
    v_mfma_f32_16x16x32_bf16 v[148:151], a[164:167], a[84:87], v[148:151]
    ds_read_b128 a[124:127], v12 offset:38912
    v_accvgpr_write_b32 a20, v25
    v_mfma_f32_16x16x32_bf16 v[172:175], a[164:167], a[92:95], v[172:175]
    ds_read_b128 a[120:123], v11 offset:38912
    v_accvgpr_write_b32 a12, v26
    v_mfma_f32_16x16x32_bf16 v[172:175], a[160:163], a[88:91], v[172:175]
    buffer_load_dwordx4 v7, s[8:11], 0 offen offset:3072 lds
    s_add_u32 s8, s8, 128
    v_mfma_f32_16x16x32_bf16 v[176:179], a[168:171], a[88:91], v[176:179]
    ds_read_b64_tr_b16 a[136:137], v14 offset:24576
    s_addc_u32 s9, s9, 0
    v_mfma_f32_16x16x32_bf16 v[176:179], a[172:175], a[92:95], v[176:179]
    ds_read_b64_tr_b16 a[138:139], v14 offset:25088
    v_accvgpr_write_b32 a28, v27
    v_mfma_f32_16x16x32_bf16 v[152:155], a[172:175], a[84:87], v[152:155]
    ds_read_b64_tr_b16 a[140:141], v14 offset:28672
    s_add_u32 m0, s45, 139264
    v_mfma_f32_16x16x32_bf16 v[152:155], a[168:171], a[80:83], v[152:155]
    buffer_load_dwordx4 v8, s[28:31], 0 offen offset:0 lds
    v_xor_b32 v25, s73, v25
    v_mfma_f32_16x16x32_bf16 v[128:131], a[168:171], a[72:75], v[128:131]
    ds_read_b64_tr_b16 a[142:143], v14 offset:29184
    v_xor_b32 v27, s73, v27
    v_mfma_f32_16x16x32_bf16 v[128:131], a[172:175], a[76:79], v[128:131]
    v_accvgpr_write_b32 a36, v25
    v_accvgpr_write_b32 a44, v27
    v_mfma_f32_16x16x32_bf16 v[104:107], a[172:175], a[68:71], v[104:107]
    v_fmamk_f32 v30, v21, 0x41900000, v20
    v_fmamk_f32 v31, v21, 0x41980000, v20
    v_mfma_f32_16x16x32_bf16 v[104:107], a[168:171], a[64:67], v[104:107]
    v_cos_f32 v32, v30
    s_waitcnt lgkmcnt(2)
    v_mfma_f32_16x16x32_bf16 v[108:111], a[128:131], a[96:99], v[108:111]
    ds_read_b64_tr_b16 a[144:145], v15 offset:32768
    v_sin_f32 v34, v30
    v_mfma_f32_16x16x32_bf16 v[108:111], a[132:135], a[100:103], v[108:111]
    buffer_load_dwordx4 v9, s[28:31], 0 offen offset:1024 lds
    s_add_u32 s28, s28, 2048
    v_mfma_f32_16x16x32_bf16 v[132:135], a[132:135], a[108:111], v[132:135]
    ds_read_b64_tr_b16 a[146:147], v15 offset:33280
    s_addc_u32 s29, s29, 0
    v_mfma_f32_16x16x32_bf16 v[132:135], a[128:131], a[104:107], v[132:135]
    ds_read_b64_tr_b16 a[148:149], v15 offset:36864
    v_cos_f32 v33, v31
    v_mfma_f32_16x16x32_bf16 v[156:159], a[128:131], a[112:115], v[156:159]
    ds_read_b64_tr_b16 a[150:151], v15 offset:37376
    s_add_u32 m0, s45, 65536
    v_mfma_f32_16x16x32_bf16 v[156:159], a[132:135], a[116:119], v[156:159]
    buffer_load_dwordx4 v8, s[28:31], 0 offen offset:0 lds
    v_sin_f32 v35, v31
    v_mfma_f32_16x16x32_bf16 v[180:183], a[132:135], a[124:127], v[180:183]
    ds_read_b64_tr_b16 a[152:153], v16 offset:32768
    v_cvt_pk_bf16_f32 v30, v32, v33
    v_mfma_f32_16x16x32_bf16 v[180:183], a[128:131], a[120:123], v[180:183]
    ds_read_b64_tr_b16 a[154:155], v16 offset:33280
    v_cvt_pk_bf16_f32 v31, v34, v35
    v_mfma_f32_16x16x32_bf16 v[184:187], a[136:139], a[120:123], v[184:187]
    ds_read_b64_tr_b16 a[156:157], v16 offset:36864
    s_waitcnt lgkmcnt(3)
    v_mfma_f32_16x16x32_bf16 v[184:187], a[140:143], a[124:127], v[184:187]
    buffer_load_dwordx4 v9, s[28:31], 0 offen offset:1024 lds
    s_sub_u32 s28, s28, 4096
    v_mfma_f32_16x16x32_bf16 v[160:163], a[140:143], a[116:119], v[160:163]
    ds_read_b64_tr_b16 a[158:159], v16 offset:37376
    s_subb_u32 s29, s29, 0
    v_mfma_f32_16x16x32_bf16 v[160:163], a[136:139], a[112:115], v[160:163]
    ds_read_b64_tr_b16 a[160:161], v15 offset:40960
    v_xor_b32 v32, v22, v30
    v_mfma_f32_16x16x32_bf16 v[136:139], a[136:139], a[104:107], v[136:139]
    ds_read_b64_tr_b16 a[162:163], v15 offset:41472
    v_xor_b32 v33, v22, v31
    v_mfma_f32_16x16x32_bf16 v[136:139], a[140:143], a[108:111], v[136:139]
    ds_read_b64_tr_b16 a[164:165], v15 offset:45056
    v_accvgpr_write_b32 a5, v30
    v_mfma_f32_16x16x32_bf16 v[112:115], a[140:143], a[100:103], v[112:115]
    ds_read_b64_tr_b16 a[166:167], v15 offset:45568
    v_accvgpr_write_b32 a21, v31
    v_mfma_f32_16x16x32_bf16 v[112:115], a[136:139], a[96:99], v[112:115]
    ds_read_b64_tr_b16 a[168:169], v16 offset:40960
    s_add_u32 m0, s45, 73728
    v_mfma_f32_16x16x32_bf16 v[116:119], a[96:99], a[144:147], v[116:119]
    buffer_load_dwordx4 v8, s[28:31], 0 offen offset:0 lds
    v_accvgpr_write_b32 a13, v32
    v_mfma_f32_16x16x32_bf16 v[116:119], a[100:103], a[148:151], v[116:119]
    ds_read_b64_tr_b16 a[170:171], v16 offset:41472
    v_accvgpr_write_b32 a29, v33
    v_mfma_f32_16x16x32_bf16 v[140:143], a[108:111], a[148:151], v[140:143]
    ds_read_b64_tr_b16 a[172:173], v16 offset:45056
    v_xor_b32 v31, s73, v31
    v_mfma_f32_16x16x32_bf16 v[140:143], a[104:107], a[144:147], v[140:143]
    ds_read_b64_tr_b16 a[174:175], v16 offset:45568
    v_xor_b32 v33, s73, v33
    v_mfma_f32_16x16x32_bf16 v[164:167], a[112:115], a[144:147], v[164:167]
    buffer_load_dwordx4 v9, s[28:31], 0 offen offset:1024 lds
    s_add_u32 s28, s28, 395264
    v_mfma_f32_16x16x32_bf16 v[164:167], a[116:119], a[148:151], v[164:167]
    s_addc_u32 s29, s29, 0
    v_mfma_f32_16x16x32_bf16 v[188:191], a[124:127], a[148:151], v[188:191]
    v_mfma_f32_16x16x32_bf16 v[188:191], a[120:123], a[144:147], v[188:191]
    s_waitcnt lgkmcnt(1)
    v_mfma_f32_16x16x32_bf16 v[192:195], a[120:123], a[152:155], v[192:195]
    s_waitcnt vmcnt(10) lgkmcnt(0)
    s_barrier
    ds_read_b128 a[64:67], v11 offset:49152
    v_mfma_f32_16x16x32_bf16 v[192:195], a[124:127], a[156:159], v[192:195]
    ds_read_b64_tr_b16 a[128:129], v13 offset:0
    s_add_u32 m0, s44, 16384
    v_mfma_f32_16x16x32_bf16 v[168:171], a[116:119], a[156:159], v[168:171]
    buffer_load_dwordx4 v4, s[8:11], 0 offen offset:0 lds
    v_mfma_f32_16x16x32_bf16 v[168:171], a[112:115], a[152:155], v[168:171]
    ds_read_b64_tr_b16 a[130:131], v13 offset:512
    v_mfma_f32_16x16x32_bf16 v[144:147], a[104:107], a[152:155], v[144:147]
    ds_read_b128 a[68:71], v12 offset:49152
    v_mfma_f32_16x16x32_bf16 v[144:147], a[108:111], a[156:159], v[144:147]
    ds_read_b64_tr_b16 a[132:133], v13 offset:4096
    v_mfma_f32_16x16x32_bf16 v[120:123], a[100:103], a[156:159], v[120:123]
    buffer_load_dword v244, v233, s[32:35], 0 offen sc1
    v_mfma_f32_16x16x32_bf16 v[120:123], a[96:99], a[152:155], v[120:123]
    ds_read_b64_tr_b16 a[134:135], v13 offset:4608
    v_mfma_f32_16x16x32_bf16 v[100:103], a[160:163], a[96:99], v[100:103]
    ds_read_b128 a[76:79], v12 offset:51200
    v_mfma_f32_16x16x32_bf16 v[100:103], a[164:167], a[100:103], v[100:103]
    ds_read_b128 a[72:75], v11 offset:51200
    v_accvgpr_write_b32 a37, v31
    v_mfma_f32_16x16x32_bf16 v[124:127], a[164:167], a[108:111], v[124:127]
    buffer_load_dwordx4 v5, s[8:11], 0 offen offset:1024 lds
    v_accvgpr_write_b32 a45, v33
    v_mfma_f32_16x16x32_bf16 v[124:127], a[160:163], a[104:107], v[124:127]
    ds_read_b128 a[80:83], v11 offset:53248
    v_fmamk_f32 v24, v21, 0x41a00000, v20
    v_mfma_f32_16x16x32_bf16 v[148:151], a[160:163], a[112:115], v[148:151]
    ds_read_b128 a[84:87], v12 offset:53248
    v_fmamk_f32 v25, v21, 0x41a80000, v20
    v_mfma_f32_16x16x32_bf16 v[148:151], a[164:167], a[116:119], v[148:151]
    ds_read_b128 a[92:95], v12 offset:55296
    v_cos_f32 v26, v24
    v_mfma_f32_16x16x32_bf16 v[172:175], a[164:167], a[124:127], v[172:175]
    ds_read_b128 a[88:91], v11 offset:55296
    v_sin_f32 v28, v24
    v_mfma_f32_16x16x32_bf16 v[172:175], a[160:163], a[120:123], v[172:175]
    buffer_load_dwordx4 v6, s[8:11], 0 offen offset:2048 lds
    v_cos_f32 v27, v25
    v_mfma_f32_16x16x32_bf16 v[176:179], a[168:171], a[120:123], v[176:179]
    ds_read_b64_tr_b16 a[136:137], v14 offset:0
    v_sin_f32 v29, v25
    v_mfma_f32_16x16x32_bf16 v[176:179], a[172:175], a[124:127], v[176:179]
    ds_read_b64_tr_b16 a[138:139], v14 offset:512
    v_cvt_pk_bf16_f32 v24, v26, v27
    v_mfma_f32_16x16x32_bf16 v[152:155], a[172:175], a[116:119], v[152:155]
    ds_read_b64_tr_b16 a[140:141], v14 offset:4096
    v_cvt_pk_bf16_f32 v25, v28, v29
    v_mfma_f32_16x16x32_bf16 v[152:155], a[168:171], a[112:115], v[152:155]
    buffer_load_dwordx4 v7, s[8:11], 0 offen offset:3072 lds
    s_add_u32 s8, s8, 128
    v_mfma_f32_16x16x32_bf16 v[128:131], a[168:171], a[104:107], v[128:131]
    ds_read_b64_tr_b16 a[142:143], v14 offset:4608
    s_addc_u32 s9, s9, 0
    v_mfma_f32_16x16x32_bf16 v[128:131], a[172:175], a[108:111], v[128:131]
    v_xor_b32 v26, v22, v24
    v_xor_b32 v27, v22, v25
    v_mfma_f32_16x16x32_bf16 v[104:107], a[172:175], a[100:103], v[104:107]
    v_accvgpr_write_b32 a6, v24
    v_accvgpr_write_b32 a22, v25
    v_mfma_f32_16x16x32_bf16 v[104:107], a[168:171], a[96:99], v[104:107]
    v_accvgpr_write_b32 a14, v26
    v_accvgpr_write_b32 a30, v27
    s_waitcnt lgkmcnt(1)
    v_mfma_f32_16x16x32_bf16 v[108:111], a[128:131], a[64:67], v[108:111]
    ds_read_b64_tr_b16 a[144:145], v15 offset:49152
    s_add_u32 m0, s45, 147456
    v_mfma_f32_16x16x32_bf16 v[108:111], a[132:135], a[68:71], v[108:111]
    buffer_load_dwordx4 v8, s[28:31], 0 offen offset:0 lds
    v_xor_b32 v25, s73, v25
    v_mfma_f32_16x16x32_bf16 v[132:135], a[132:135], a[76:79], v[132:135]
    ds_read_b64_tr_b16 a[146:147], v15 offset:49664
    v_xor_b32 v27, s73, v27
    v_mfma_f32_16x16x32_bf16 v[132:135], a[128:131], a[72:75], v[132:135]
    ds_read_b64_tr_b16 a[148:149], v15 offset:53248
    v_accvgpr_write_b32 a38, v25
    v_mfma_f32_16x16x32_bf16 v[156:159], a[128:131], a[80:83], v[156:159]
    ds_read_b64_tr_b16 a[150:151], v15 offset:53760
    v_accvgpr_write_b32 a46, v27
    v_mfma_f32_16x16x32_bf16 v[156:159], a[132:135], a[84:87], v[156:159]
    buffer_load_dwordx4 v9, s[28:31], 0 offen offset:1024 lds
    s_add_u32 s28, s28, 2048
    v_mfma_f32_16x16x32_bf16 v[180:183], a[132:135], a[92:95], v[180:183]
    ds_read_b64_tr_b16 a[152:153], v16 offset:49152
    s_addc_u32 s29, s29, 0
    v_mfma_f32_16x16x32_bf16 v[180:183], a[128:131], a[88:91], v[180:183]
    ds_read_b64_tr_b16 a[154:155], v16 offset:49664
    v_fmamk_f32 v30, v21, 0x41b00000, v20
    v_mfma_f32_16x16x32_bf16 v[184:187], a[136:139], a[88:91], v[184:187]
    ds_read_b64_tr_b16 a[156:157], v16 offset:53248
    s_add_u32 m0, s45, 81920
    s_waitcnt lgkmcnt(3)
    v_mfma_f32_16x16x32_bf16 v[184:187], a[140:143], a[92:95], v[184:187]
    buffer_load_dwordx4 v8, s[28:31], 0 offen offset:0 lds
    v_fmamk_f32 v31, v21, 0x41b80000, v20
    v_mfma_f32_16x16x32_bf16 v[160:163], a[140:143], a[84:87], v[160:163]
    ds_read_b64_tr_b16 a[158:159], v16 offset:53760
    v_cos_f32 v32, v30
    v_mfma_f32_16x16x32_bf16 v[160:163], a[136:139], a[80:83], v[160:163]
    ds_read_b64_tr_b16 a[160:161], v15 offset:57344
    v_sin_f32 v34, v30
    v_mfma_f32_16x16x32_bf16 v[136:139], a[136:139], a[72:75], v[136:139]
    ds_read_b64_tr_b16 a[162:163], v15 offset:57856
    v_cos_f32 v33, v31
    v_mfma_f32_16x16x32_bf16 v[136:139], a[140:143], a[76:79], v[136:139]
    ds_read_b64_tr_b16 a[164:165], v15 offset:61440
    v_sin_f32 v35, v31
    v_mfma_f32_16x16x32_bf16 v[112:115], a[140:143], a[68:71], v[112:115]
    ds_read_b64_tr_b16 a[166:167], v15 offset:61952
    v_cvt_pk_bf16_f32 v30, v32, v33
    v_mfma_f32_16x16x32_bf16 v[112:115], a[136:139], a[64:67], v[112:115]
    ds_read_b64_tr_b16 a[168:169], v16 offset:57344
    v_cvt_pk_bf16_f32 v31, v34, v35
    v_mfma_f32_16x16x32_bf16 v[116:119], a[64:67], a[144:147], v[116:119]
    buffer_load_dwordx4 v9, s[28:31], 0 offen offset:1024 lds
    s_sub_u32 s28, s28, 4096
    v_mfma_f32_16x16x32_bf16 v[116:119], a[68:71], a[148:151], v[116:119]
    ds_read_b64_tr_b16 a[170:171], v16 offset:57856
    s_subb_u32 s29, s29, 0
    v_mfma_f32_16x16x32_bf16 v[140:143], a[76:79], a[148:151], v[140:143]
    ds_read_b64_tr_b16 a[172:173], v16 offset:61440
    v_xor_b32 v32, v22, v30
    v_mfma_f32_16x16x32_bf16 v[140:143], a[72:75], a[144:147], v[140:143]
    ds_read_b64_tr_b16 a[174:175], v16 offset:61952
    s_add_u32 m0, s45, 90112
    v_mfma_f32_16x16x32_bf16 v[164:167], a[80:83], a[144:147], v[164:167]
    buffer_load_dwordx4 v8, s[28:31], 0 offen offset:0 lds
    v_mfma_f32_16x16x32_bf16 v[164:167], a[84:87], a[148:151], v[164:167]
    v_mfma_f32_16x16x32_bf16 v[188:191], a[92:95], a[148:151], v[188:191]
L_pad_4:
    s_cmp_eq_u32 s3, 1
    s_cbranch_scc1 L_walkret
    v_mfma_f32_16x16x32_bf16 v[188:191], a[88:91], a[144:147], v[188:191]
    s_waitcnt lgkmcnt(2)
    v_mfma_f32_16x16x32_bf16 v[192:195], a[88:91], a[152:155], v[192:195]
    s_waitcnt vmcnt(10) lgkmcnt(0)
    s_barrier
    ds_read_b128 a[96:99], v11 offset:0
    v_mfma_f32_16x16x32_bf16 v[192:195], a[92:95], a[156:159], v[192:195]
    ds_read_b64_tr_b16 a[128:129], v13 offset:8192
    v_mfma_f32_16x16x32_bf16 v[168:171], a[84:87], a[156:159], v[168:171]
    buffer_load_dwordx4 v9, s[28:31], 0 offen offset:1024 lds
    s_add_u32 s28, s28, 395264
    v_mfma_f32_16x16x32_bf16 v[168:171], a[80:83], a[152:155], v[168:171]
    ds_read_b64_tr_b16 a[130:131], v13 offset:8704
    s_addc_u32 s29, s29, 0
    v_mfma_f32_16x16x32_bf16 v[144:147], a[72:75], a[152:155], v[144:147]
    ds_read_b128 a[100:103], v12 offset:0
    v_mfma_f32_16x16x32_bf16 v[144:147], a[76:79], a[156:159], v[144:147]
    ds_read_b64_tr_b16 a[132:133], v13 offset:12288
    s_add_u32 m0, s44, 32768
    v_mfma_f32_16x16x32_bf16 v[120:123], a[68:71], a[156:159], v[120:123]
    buffer_load_dwordx4 v4, s[8:11], 0 offen offset:0 lds
    v_mfma_f32_16x16x32_bf16 v[120:123], a[64:67], a[152:155], v[120:123]
    ds_read_b64_tr_b16 a[134:135], v13 offset:12800
    v_mfma_f32_16x16x32_bf16 v[100:103], a[160:163], a[64:67], v[100:103]
    ds_read_b128 a[108:111], v12 offset:2048
    v_mfma_f32_16x16x32_bf16 v[100:103], a[164:167], a[68:71], v[100:103]
    ds_read_b128 a[104:107], v11 offset:2048
    v_xor_b32 v33, v22, v31
    v_mfma_f32_16x16x32_bf16 v[124:127], a[164:167], a[76:79], v[124:127]
    buffer_load_dwordx4 v5, s[8:11], 0 offen offset:1024 lds
    v_accvgpr_write_b32 a7, v30
    v_mfma_f32_16x16x32_bf16 v[124:127], a[160:163], a[72:75], v[124:127]
    ds_read_b128 a[112:115], v11 offset:4096
    v_accvgpr_write_b32 a23, v31
    v_mfma_f32_16x16x32_bf16 v[148:151], a[160:163], a[80:83], v[148:151]
    ds_read_b128 a[116:119], v12 offset:4096
    v_accvgpr_write_b32 a15, v32
    v_mfma_f32_16x16x32_bf16 v[148:151], a[164:167], a[84:87], v[148:151]
    ds_read_b128 a[124:127], v12 offset:6144
    v_accvgpr_write_b32 a31, v33
    v_mfma_f32_16x16x32_bf16 v[172:175], a[164:167], a[92:95], v[172:175]
    ds_read_b128 a[120:123], v11 offset:6144
    v_xor_b32 v31, s73, v31
    v_mfma_f32_16x16x32_bf16 v[172:175], a[160:163], a[88:91], v[172:175]
    buffer_load_dwordx4 v6, s[8:11], 0 offen offset:2048 lds
    v_xor_b32 v33, s73, v33
    v_mfma_f32_16x16x32_bf16 v[176:179], a[168:171], a[88:91], v[176:179]
    ds_read_b64_tr_b16 a[136:137], v14 offset:8192
    v_accvgpr_write_b32 a39, v31
    v_mfma_f32_16x16x32_bf16 v[176:179], a[172:175], a[92:95], v[176:179]
    ds_read_b64_tr_b16 a[138:139], v14 offset:8704
    v_accvgpr_write_b32 a47, v33
    v_mfma_f32_16x16x32_bf16 v[152:155], a[172:175], a[84:87], v[152:155]
    ds_read_b64_tr_b16 a[140:141], v14 offset:12288
    v_mov_b32 v232, 0xdddddddd
    v_mfma_f32_16x16x32_bf16 v[152:155], a[168:171], a[80:83], v[152:155]
    buffer_load_dwordx4 v7, s[8:11], 0 offen offset:3072 lds
    s_add_u32 s8, s8, 128
    v_mfma_f32_16x16x32_bf16 v[128:131], a[168:171], a[72:75], v[128:131]
    ds_read_b64_tr_b16 a[142:143], v14 offset:12800
    s_addc_u32 s9, s9, 0
    v_mfma_f32_16x16x32_bf16 v[128:131], a[172:175], a[76:79], v[128:131]
    v_and_b32 v248, 15, v1
    v_min_u32 v249, 1, v248
    v_mfma_f32_16x16x32_bf16 v[104:107], a[172:175], a[68:71], v[104:107]
    v_add_u32 v249, -1, v249
    v_and_b32 v228, 0x3f803f80, v249
    v_mfma_f32_16x16x32_bf16 v[104:107], a[168:171], a[64:67], v[104:107]
    v_mov_b32 v229, v228
    v_xor_b32 v248, 4, v248
    s_waitcnt lgkmcnt(1)
    v_mfma_f32_16x16x32_bf16 v[108:111], a[128:131], a[96:99], v[108:111]
    ds_read_b64_tr_b16 a[144:145], v15 offset:0
    s_add_u32 m0, s45, 155648
    v_mfma_f32_16x16x32_bf16 v[108:111], a[132:135], a[100:103], v[108:111]
    buffer_load_dwordx4 v8, s[28:31], 0 offen offset:0 lds
    v_min_u32 v249, 1, v248
    v_mfma_f32_16x16x32_bf16 v[132:135], a[132:135], a[108:111], v[132:135]
    ds_read_b64_tr_b16 a[146:147], v15 offset:512
    v_add_u32 v249, -1, v249
    v_mfma_f32_16x16x32_bf16 v[132:135], a[128:131], a[104:107], v[132:135]
    ds_read_b64_tr_b16 a[148:149], v15 offset:4096
    v_and_b32 v230, 0x3f803f80, v249
    v_mfma_f32_16x16x32_bf16 v[156:159], a[128:131], a[112:115], v[156:159]
    ds_read_b64_tr_b16 a[150:151], v15 offset:4608
    v_mov_b32 v231, v230
    v_mfma_f32_16x16x32_bf16 v[156:159], a[132:135], a[116:119], v[156:159]
    buffer_load_dwordx4 v9, s[28:31], 0 offen offset:1024 lds
    s_add_u32 s28, s28, 2048
    v_mfma_f32_16x16x32_bf16 v[180:183], a[132:135], a[124:127], v[180:183]
    ds_read_b64_tr_b16 a[152:153], v16 offset:0
    s_addc_u32 s29, s29, 0
    v_mfma_f32_16x16x32_bf16 v[180:183], a[128:131], a[120:123], v[180:183]
    ds_read_b64_tr_b16 a[154:155], v16 offset:512
    s_mov_b32 s71, 0
    v_mfma_f32_16x16x32_bf16 v[184:187], a[136:139], a[120:123], v[184:187]
    ds_read_b64_tr_b16 a[156:157], v16 offset:4096
    s_add_u32 m0, s45, 98304
    s_waitcnt lgkmcnt(3)
    v_mfma_f32_16x16x32_bf16 v[184:187], a[140:143], a[124:127], v[184:187]
    buffer_load_dwordx4 v8, s[28:31], 0 offen offset:0 lds
    v_mov_b32 v82, 0xbf00bf00
    v_mfma_f32_16x16x32_bf16 v[160:163], a[140:143], a[116:119], v[160:163]
    ds_read_b64_tr_b16 a[158:159], v16 offset:4608
    v_mov_b32 v83, 0
    v_mfma_f32_16x16x32_bf16 v[160:163], a[136:139], a[112:115], v[160:163]
    ds_read_b64_tr_b16 a[160:161], v15 offset:8192
    v_mov_b32 v234, 0
    v_mfma_f32_16x16x32_bf16 v[136:139], a[136:139], a[104:107], v[136:139]
    ds_read_b64_tr_b16 a[162:163], v15 offset:8704
    v_mov_b32 v235, 0xbf00bf00
    v_mfma_f32_16x16x32_bf16 v[136:139], a[140:143], a[108:111], v[136:139]
    ds_read_b64_tr_b16 a[164:165], v15 offset:12288
    s_lshl_b32 s47, s36, 13
    v_mfma_f32_16x16x32_bf16 v[112:115], a[140:143], a[100:103], v[112:115]
    buffer_load_dwordx4 v9, s[28:31], 0 offen offset:1024 lds
    s_sub_u32 s28, s28, 4096
    v_mfma_f32_16x16x32_bf16 v[112:115], a[136:139], a[96:99], v[112:115]
    ds_read_b64_tr_b16 a[166:167], v15 offset:12800
    s_subb_u32 s29, s29, 0
    v_mfma_f32_16x16x32_bf16 v[116:119], a[96:99], a[144:147], v[116:119]
    ds_read_b64_tr_b16 a[168:169], v16 offset:8192
    s_add_u32 s47, s47, 16384
    v_mfma_f32_16x16x32_bf16 v[116:119], a[100:103], a[148:151], v[116:119]
    ds_read_b64_tr_b16 a[170:171], v16 offset:8704
    s_lshl_b32 s48, s36, 12
    v_mfma_f32_16x16x32_bf16 v[140:143], a[108:111], a[148:151], v[140:143]
    ds_read_b64_tr_b16 a[172:173], v16 offset:12288
    s_add_u32 s48, s48, 65536
    v_mfma_f32_16x16x32_bf16 v[140:143], a[104:107], a[144:147], v[140:143]
    ds_read_b64_tr_b16 a[174:175], v16 offset:12800
    s_add_u32 m0, s45, 106496
    v_mfma_f32_16x16x32_bf16 v[164:167], a[112:115], a[144:147], v[164:167]
    buffer_load_dwordx4 v8, s[28:31], 0 offen offset:0 lds
    v_mfma_f32_16x16x32_bf16 v[164:167], a[116:119], a[148:151], v[164:167]
    v_mfma_f32_16x16x32_bf16 v[188:191], a[124:127], a[148:151], v[188:191]
    v_mfma_f32_16x16x32_bf16 v[188:191], a[120:123], a[144:147], v[188:191]
    s_waitcnt lgkmcnt(2)
    v_mfma_f32_16x16x32_bf16 v[192:195], a[120:123], a[152:155], v[192:195]
    s_waitcnt vmcnt(9) lgkmcnt(0)
    s_barrier
    ds_read_b128 a[64:67], v11 offset:16384
    v_mfma_f32_16x16x32_bf16 v[192:195], a[124:127], a[156:159], v[192:195]
    v_cmp_le_u32 vcc, 4, v244
    s_nop 0
    s_cmp_eq_u64 vcc, exec
    s_cbranch_scc0 L_sa_slow
L_sa_ok:
    v_mfma_f32_16x16x32_bf16 v[168:171], a[116:119], a[156:159], v[168:171]
    buffer_load_dwordx4 v9, s[28:31], 0 offen offset:1024 lds
    s_add_u32 s28, s28, 395264
    v_mfma_f32_16x16x32_bf16 v[168:171], a[112:115], a[152:155], v[168:171]
    ds_read_b64_tr_b16 a[128:129], v13 offset:16384
    s_addc_u32 s29, s29, 0
    v_mfma_f32_16x16x32_bf16 v[144:147], a[104:107], a[152:155], v[144:147]
    ds_read_b64_tr_b16 a[130:131], v13 offset:16896
    v_mfma_f32_16x16x32_bf16 v[144:147], a[108:111], a[156:159], v[144:147]
    ds_read_b128 a[68:71], v12 offset:16384
    s_add_u32 m0, s44, 49152
    v_mfma_f32_16x16x32_bf16 v[120:123], a[100:103], a[156:159], v[120:123]
    buffer_load_dwordx4 v4, s[8:11], 0 offen offset:0 lds
    v_mfma_f32_16x16x32_bf16 v[120:123], a[96:99], a[152:155], v[120:123]
    ds_read_b64_tr_b16 a[132:133], v13 offset:20480
    v_mfma_f32_16x16x32_bf16 v[100:103], a[160:163], a[96:99], v[100:103]
    ds_read_b64_tr_b16 a[134:135], v13 offset:20992
    v_mfma_f32_16x16x32_bf16 v[100:103], a[164:167], a[100:103], v[100:103]
    ds_read_b128 a[76:79], v12 offset:18432
    v_bfe_u32 v252, v1, 4, 1
    v_mfma_f32_16x16x32_bf16 v[124:127], a[164:167], a[108:111], v[124:127]
    buffer_load_dwordx4 v5, s[8:11], 0 offen offset:1024 lds
    v_lshlrev_b32 v252, 10, v252
    v_mfma_f32_16x16x32_bf16 v[124:127], a[160:163], a[104:107], v[124:127]
    ds_read_b128 a[72:75], v11 offset:18432
    v_lshrrev_b32 v249, 5, v1
    v_mfma_f32_16x16x32_bf16 v[148:151], a[160:163], a[112:115], v[148:151]
    ds_read_b128 a[80:83], v11 offset:20480
    v_lshl_add_u32 v252, v249, 9, v252
    v_mfma_f32_16x16x32_bf16 v[148:151], a[164:167], a[116:119], v[148:151]
    ds_read_b128 a[84:87], v12 offset:20480
    v_bfe_u32 v249, v1, 2, 2
    v_mfma_f32_16x16x32_bf16 v[172:175], a[164:167], a[124:127], v[172:175]
    ds_read_b128 a[92:95], v12 offset:22528
    v_lshl_add_u32 v248, v249, 7, v252
    v_mfma_f32_16x16x32_bf16 v[172:175], a[160:163], a[120:123], v[172:175]
    buffer_load_dwordx4 v6, s[8:11], 0 offen offset:2048 lds
    v_and_b32 v250, 3, v1
    v_mfma_f32_16x16x32_bf16 v[176:179], a[168:171], a[120:123], v[176:179]
    ds_read_b128 a[88:91], v11 offset:22528
    v_lshl_add_u32 v248, v250, 4, v248
    v_mfma_f32_16x16x32_bf16 v[176:179], a[172:175], a[124:127], v[176:179]
    ds_read_b64_tr_b16 a[136:137], v14 offset:16384
    v_add_u32 v68, s47, v248
    v_mfma_f32_16x16x32_bf16 v[152:155], a[172:175], a[116:119], v[152:155]
    ds_read_b64_tr_b16 a[138:139], v14 offset:16896
    v_and_b32 v251, 15, v1
    v_mfma_f32_16x16x32_bf16 v[152:155], a[168:171], a[112:115], v[152:155]
    buffer_load_dwordx4 v7, s[8:11], 0 offen offset:3072 lds
    s_add_u32 s8, s8, 128
    v_mfma_f32_16x16x32_bf16 v[128:131], a[168:171], a[104:107], v[128:131]
    ds_read_b64_tr_b16 a[140:141], v14 offset:20480
    s_addc_u32 s9, s9, 0
    v_mfma_f32_16x16x32_bf16 v[128:131], a[172:175], a[108:111], v[128:131]
    ds_read_b64_tr_b16 a[142:143], v14 offset:20992
    v_lshl_add_u32 v250, v251, 4, v252
    v_mfma_f32_16x16x32_bf16 v[104:107], a[172:175], a[100:103], v[104:107]
    v_add_u32 v70, s48, v250
    v_lshrrev_b32 v250, 4, v1
    v_mfma_f32_16x16x32_bf16 v[104:107], a[168:171], a[96:99], v[104:107]
    v_lshlrev_b32 v250, 9, v250
    v_lshl_add_u32 v41, v251, 4, v250
    s_waitcnt lgkmcnt(2)
    v_mfma_f32_16x16x32_bf16 v[108:111], a[128:131], a[64:67], v[108:111]
    ds_read_b64_tr_b16 a[144:145], v15 offset:16384
    s_add_u32 m0, s45, 131072
    v_mfma_f32_16x16x32_bf16 v[108:111], a[132:135], a[68:71], v[108:111]
    buffer_load_dwordx4 v8, s[28:31], 0 offen offset:0 lds
    v_add_u32 v69, s47, v41
    v_mfma_f32_16x16x32_bf16 v[132:135], a[132:135], a[76:79], v[132:135]
    ds_read_b64_tr_b16 a[146:147], v15 offset:16896
    v_add_u32 v71, s47, v3
    v_mfma_f32_16x16x32_bf16 v[132:135], a[128:131], a[72:75], v[132:135]
    ds_read_b64_tr_b16 a[148:149], v15 offset:20480
    v_add_u32 v73, s48, v3
    v_mfma_f32_16x16x32_bf16 v[156:159], a[128:131], a[80:83], v[156:159]
    ds_read_b64_tr_b16 a[150:151], v15 offset:20992
    s_lshl_b32 s47, s40, 13
    v_mfma_f32_16x16x32_bf16 v[156:159], a[132:135], a[84:87], v[156:159]
    buffer_load_dwordx4 v9, s[28:31], 0 offen offset:1024 lds
    s_add_u32 s28, s28, 2048
    v_mfma_f32_16x16x32_bf16 v[180:183], a[132:135], a[92:95], v[180:183]
    ds_read_b64_tr_b16 a[152:153], v16 offset:16384
    s_addc_u32 s29, s29, 0
    v_mfma_f32_16x16x32_bf16 v[180:183], a[128:131], a[88:91], v[180:183]
    ds_read_b64_tr_b16 a[154:155], v16 offset:16896
    s_add_u32 s47, s47, 16384
    v_mfma_f32_16x16x32_bf16 v[184:187], a[136:139], a[88:91], v[184:187]
    ds_read_b64_tr_b16 a[156:157], v16 offset:20480
    s_add_u32 m0, s45, 114688
    s_waitcnt lgkmcnt(3)
    v_mfma_f32_16x16x32_bf16 v[184:187], a[140:143], a[92:95], v[184:187]
    buffer_load_dwordx4 v8, s[28:31], 0 offen offset:0 lds
    v_add_u32 v76, s47, v3
    v_mfma_f32_16x16x32_bf16 v[160:163], a[140:143], a[84:87], v[160:163]
    ds_read_b64_tr_b16 a[158:159], v16 offset:20992
    s_lshl_b32 s47, s39, 1
    v_mfma_f32_16x16x32_bf16 v[160:163], a[136:139], a[80:83], v[160:163]
    ds_read_b64_tr_b16 a[160:161], v15 offset:24576
    v_xor_b32 v249, s47, v249
    v_mfma_f32_16x16x32_bf16 v[136:139], a[136:139], a[72:75], v[136:139]
    ds_read_b64_tr_b16 a[162:163], v15 offset:25088
    v_lshlrev_b32 v249, 4, v249
    v_mfma_f32_16x16x32_bf16 v[136:139], a[140:143], a[76:79], v[136:139]
    ds_read_b64_tr_b16 a[164:165], v15 offset:28672
    v_lshl_add_u32 v74, v1, 6, v249
    v_mfma_f32_16x16x32_bf16 v[112:115], a[140:143], a[68:71], v[112:115]
    buffer_load_dwordx4 v9, s[28:31], 0 offen offset:1024 lds
    s_sub_u32 s28, s28, 4096
    v_mfma_f32_16x16x32_bf16 v[112:115], a[136:139], a[64:67], v[112:115]
    ds_read_b64_tr_b16 a[166:167], v15 offset:29184
    s_subb_u32 s29, s29, 0
    v_mfma_f32_16x16x32_bf16 v[116:119], a[64:67], a[144:147], v[116:119]
    ds_read_b64_tr_b16 a[168:169], v16 offset:24576
    v_xor_b32 v75, 16, v74
    v_mfma_f32_16x16x32_bf16 v[116:119], a[68:71], a[148:151], v[116:119]
    ds_read_b64_tr_b16 a[170:171], v16 offset:25088
    v_xor_b32 v72, 8192, v73
    v_mfma_f32_16x16x32_bf16 v[140:143], a[76:79], a[148:151], v[140:143]
    ds_read_b64_tr_b16 a[172:173], v16 offset:28672
    s_lshl_b32 s47, s36, 11
    v_mfma_f32_16x16x32_bf16 v[140:143], a[72:75], a[144:147], v[140:143]
    ds_read_b64_tr_b16 a[174:175], v16 offset:29184
    s_add_u32 m0, s45, 122880
    v_mfma_f32_16x16x32_bf16 v[164:167], a[80:83], a[144:147], v[164:167]
    buffer_load_dwordx4 v8, s[28:31], 0 offen offset:0 lds
    v_mfma_f32_16x16x32_bf16 v[164:167], a[84:87], a[148:151], v[164:167]
    v_mfma_f32_16x16x32_bf16 v[188:191], a[92:95], a[148:151], v[188:191]
    v_mfma_f32_16x16x32_bf16 v[188:191], a[88:91], a[144:147], v[188:191]
    s_waitcnt lgkmcnt(2)
    v_mfma_f32_16x16x32_bf16 v[192:195], a[88:91], a[152:155], v[192:195]
    s_waitcnt vmcnt(9) lgkmcnt(0)
    s_barrier
    ds_read_b128 a[96:99], v11 offset:32768
    v_mfma_f32_16x16x32_bf16 v[192:195], a[92:95], a[156:159], v[192:195]
    ds_read_b64_tr_b16 a[128:129], v13 offset:24576
    v_mfma_f32_16x16x32_bf16 v[168:171], a[84:87], a[156:159], v[168:171]
    buffer_load_dwordx4 v9, s[28:31], 0 offen offset:1024 lds
    s_add_u32 s28, s28, 395264
    v_mfma_f32_16x16x32_bf16 v[168:171], a[80:83], a[152:155], v[168:171]
    ds_read_b64_tr_b16 a[130:131], v13 offset:25088
    s_addc_u32 s29, s29, 0
    v_mfma_f32_16x16x32_bf16 v[144:147], a[72:75], a[152:155], v[144:147]
    ds_read_b128 a[100:103], v12 offset:32768
    v_mfma_f32_16x16x32_bf16 v[144:147], a[76:79], a[156:159], v[144:147]
    ds_read_b64_tr_b16 a[132:133], v13 offset:28672
    s_add_u32 m0, s44, 0
    v_mfma_f32_16x16x32_bf16 v[120:123], a[68:71], a[156:159], v[120:123]
    buffer_load_dwordx4 v254, s[16:19], s96 offen offset:0 sc1 lds
    s_add_u32 s96, s96, 1024
    v_mfma_f32_16x16x32_bf16 v[120:123], a[64:67], a[152:155], v[120:123]
    ds_read_b64_tr_b16 a[134:135], v13 offset:29184
    v_mfma_f32_16x16x32_bf16 v[100:103], a[160:163], a[64:67], v[100:103]
    ds_read_b128 a[108:111], v12 offset:34816
    v_mfma_f32_16x16x32_bf16 v[100:103], a[164:167], a[68:71], v[100:103]
    ds_read_b128 a[104:107], v11 offset:34816
    s_add_u32 s47, s47, 81920
    v_mfma_f32_16x16x32_bf16 v[124:127], a[164:167], a[76:79], v[124:127]
    ds_read_b128 a[112:115], v11 offset:36864
    v_bfe_u32 v248, v1, 3, 2
    v_mfma_f32_16x16x32_bf16 v[124:127], a[160:163], a[72:75], v[124:127]
    ds_read_b128 a[116:119], v12 offset:36864
    v_xor_b32 v248, v248, v1
    v_mfma_f32_16x16x32_bf16 v[148:151], a[160:163], a[80:83], v[148:151]
    ds_read_b128 a[124:127], v12 offset:38912
    v_lshl_add_u32 v77, v248, 4, s47
    v_mfma_f32_16x16x32_bf16 v[148:151], a[164:167], a[84:87], v[148:151]
    ds_read_b128 a[120:123], v11 offset:38912
    v_and_b32 v248, 31, v1
    v_mfma_f32_16x16x32_bf16 v[172:175], a[164:167], a[92:95], v[172:175]
    ds_read_b64_tr_b16 a[136:137], v14 offset:24576
    v_lshl_add_u32 v248, v248, 6, s47
    v_mfma_f32_16x16x32_bf16 v[172:175], a[160:163], a[88:91], v[172:175]
    buffer_load_dwordx4 v254, s[16:19], s96 offen offset:1024 sc1 lds
    s_add_u32 s96, s96, 1024
    v_mfma_f32_16x16x32_bf16 v[176:179], a[168:171], a[88:91], v[176:179]
    ds_read_b64_tr_b16 a[138:139], v14 offset:25088
    v_lshrrev_b32 v249, 5, v1
    v_mfma_f32_16x16x32_bf16 v[176:179], a[172:175], a[92:95], v[176:179]
    ds_read_b64_tr_b16 a[140:141], v14 offset:28672
    v_lshl_add_u32 v248, v249, 3, v248
    v_mfma_f32_16x16x32_bf16 v[152:155], a[172:175], a[84:87], v[152:155]
    ds_read_b64_tr_b16 a[142:143], v14 offset:29184
    v_bfe_u32 v249, v1, 1, 2
    v_mfma_f32_16x16x32_bf16 v[152:155], a[168:171], a[80:83], v[152:155]
    v_lshl_add_u32 v78, v249, 4, v248
    v_xor_b32 v79, 16, v78
    v_mfma_f32_16x16x32_bf16 v[128:131], a[168:171], a[72:75], v[128:131]
    v_xor_b32 v80, 32, v78
    v_xor_b32 v81, 48, v78
    v_mfma_f32_16x16x32_bf16 v[128:131], a[172:175], a[76:79], v[128:131]
    v_mov_b64 v[52:53], 0
    v_mov_b64 v[54:55], 0
    v_mfma_f32_16x16x32_bf16 v[104:107], a[172:175], a[68:71], v[104:107]
    v_mov_b64 v[56:57], 0
    v_mov_b64 v[58:59], 0
    v_mfma_f32_16x16x32_bf16 v[104:107], a[168:171], a[64:67], v[104:107]
    v_mov_b64 v[60:61], 0
    v_mov_b64 v[62:63], 0
    s_waitcnt lgkmcnt(2)
    v_mfma_f32_16x16x32_bf16 v[108:111], a[128:131], a[96:99], v[108:111]
    ds_read_b64_tr_b16 a[144:145], v15 offset:32768
    v_mov_b64 v[64:65], 0
    v_mfma_f32_16x16x32_bf16 v[108:111], a[132:135], a[100:103], v[108:111]
    buffer_load_dwordx4 v254, s[16:19], s96 offen offset:2048 sc1 lds
    s_add_u32 s96, s96, 1024
    v_mfma_f32_16x16x32_bf16 v[132:135], a[132:135], a[108:111], v[132:135]
    ds_read_b64_tr_b16 a[146:147], v15 offset:33280
    v_mov_b64 v[66:67], 0
    v_mfma_f32_16x16x32_bf16 v[132:135], a[128:131], a[104:107], v[132:135]
    ds_read_b64_tr_b16 a[148:149], v15 offset:36864
    v_mov_b64 v[84:85], 0
    v_mfma_f32_16x16x32_bf16 v[156:159], a[128:131], a[112:115], v[156:159]
    ds_read_b64_tr_b16 a[150:151], v15 offset:37376
    v_mov_b64 v[86:87], 0
    v_mfma_f32_16x16x32_bf16 v[156:159], a[132:135], a[116:119], v[156:159]
    ds_read_b64_tr_b16 a[152:153], v16 offset:32768
    v_mov_b64 v[88:89], 0
    v_mfma_f32_16x16x32_bf16 v[180:183], a[132:135], a[124:127], v[180:183]
    ds_read_b64_tr_b16 a[154:155], v16 offset:33280
    v_mov_b64 v[90:91], 0
    v_mfma_f32_16x16x32_bf16 v[180:183], a[128:131], a[120:123], v[180:183]
    ds_read_b64_tr_b16 a[156:157], v16 offset:36864
    v_mov_b64 v[92:93], 0
    v_mfma_f32_16x16x32_bf16 v[184:187], a[136:139], a[120:123], v[184:187]
    ds_read_b64_tr_b16 a[158:159], v16 offset:37376
    s_waitcnt lgkmcnt(5)
    v_mfma_f32_16x16x32_bf16 v[184:187], a[140:143], a[124:127], v[184:187]
    buffer_load_dwordx4 v254, s[16:19], s96 offen offset:3072 sc1 lds
    s_add_u32 s96, s96, 1024
    v_mfma_f32_16x16x32_bf16 v[160:163], a[140:143], a[116:119], v[160:163]
    ds_read_b64_tr_b16 a[160:161], v15 offset:40960
    v_mov_b64 v[94:95], 0
    v_mfma_f32_16x16x32_bf16 v[160:163], a[136:139], a[112:115], v[160:163]
    ds_read_b64_tr_b16 a[162:163], v15 offset:41472
    v_mov_b64 v[96:97], 0
    v_mfma_f32_16x16x32_bf16 v[136:139], a[136:139], a[104:107], v[136:139]
    ds_read_b64_tr_b16 a[164:165], v15 offset:45056
    v_mov_b64 v[98:99], 0
    v_mfma_f32_16x16x32_bf16 v[136:139], a[140:143], a[108:111], v[136:139]
    ds_read_b64_tr_b16 a[166:167], v15 offset:45568
    v_mfma_f32_16x16x32_bf16 v[112:115], a[140:143], a[100:103], v[112:115]
    ds_read_b64_tr_b16 a[168:169], v16 offset:40960
    v_mfma_f32_16x16x32_bf16 v[112:115], a[136:139], a[96:99], v[112:115]
    ds_read_b64_tr_b16 a[170:171], v16 offset:41472
    v_mfma_f32_16x16x32_bf16 v[116:119], a[96:99], a[144:147], v[116:119]
    ds_read_b64_tr_b16 a[172:173], v16 offset:45056
    s_waitcnt lgkmcnt(5)
    v_mfma_f32_16x16x32_bf16 v[116:119], a[100:103], a[148:151], v[116:119]
    ds_read_b64_tr_b16 a[174:175], v16 offset:45568
    v_mfma_f32_16x16x32_bf16 v[140:143], a[108:111], a[148:151], v[140:143]
    v_mfma_f32_16x16x32_bf16 v[140:143], a[104:107], a[144:147], v[140:143]
    v_mfma_f32_16x16x32_bf16 v[164:167], a[112:115], a[144:147], v[164:167]
    v_mfma_f32_16x16x32_bf16 v[164:167], a[116:119], a[148:151], v[164:167]
    v_mfma_f32_16x16x32_bf16 v[188:191], a[124:127], a[148:151], v[188:191]
    v_mfma_f32_16x16x32_bf16 v[188:191], a[120:123], a[144:147], v[188:191]
    v_mfma_f32_16x16x32_bf16 v[192:195], a[120:123], a[152:155], v[192:195]
    s_waitcnt vmcnt(4) lgkmcnt(0)
    s_barrier
    ds_read_b128 a[64:67], v11 offset:49152
    v_mfma_f32_16x16x32_bf16 v[192:195], a[124:127], a[156:159], v[192:195]
    ds_read_b64_tr_b16 a[128:129], v13 offset:0
    v_mfma_f32_16x16x32_bf16 v[168:171], a[116:119], a[156:159], v[168:171]
    ds_read_b64_tr_b16 a[130:131], v13 offset:512
    v_mfma_f32_16x16x32_bf16 v[168:171], a[112:115], a[152:155], v[168:171]
    ds_read_b128 a[68:71], v12 offset:49152
    v_mfma_f32_16x16x32_bf16 v[144:147], a[104:107], a[152:155], v[144:147]
    ds_read_b64_tr_b16 a[132:133], v13 offset:4096
    v_mfma_f32_16x16x32_bf16 v[144:147], a[108:111], a[156:159], v[144:147]
    ds_read_b64_tr_b16 a[134:135], v13 offset:4608
    v_mfma_f32_16x16x32_bf16 v[120:123], a[100:103], a[156:159], v[120:123]
    ds_read_b128 a[76:79], v12 offset:51200
    v_mfma_f32_16x16x32_bf16 v[120:123], a[96:99], a[152:155], v[120:123]
    ds_read_b128 a[72:75], v11 offset:51200
    v_mfma_f32_16x16x32_bf16 v[100:103], a[160:163], a[96:99], v[100:103]
    ds_read_b128 a[80:83], v11 offset:53248
    v_mfma_f32_16x16x32_bf16 v[100:103], a[164:167], a[100:103], v[100:103]
    ds_read_b128 a[84:87], v12 offset:53248
    v_mfma_f32_16x16x32_bf16 v[124:127], a[164:167], a[108:111], v[124:127]
    ds_read_b128 a[92:95], v12 offset:55296
    v_mfma_f32_16x16x32_bf16 v[124:127], a[160:163], a[104:107], v[124:127]
    ds_read_b128 a[88:91], v11 offset:55296
    v_mfma_f32_16x16x32_bf16 v[148:151], a[160:163], a[112:115], v[148:151]
    ds_read_b64_tr_b16 a[136:137], v14 offset:0
    v_mfma_f32_16x16x32_bf16 v[148:151], a[164:167], a[116:119], v[148:151]
    ds_read_b64_tr_b16 a[138:139], v14 offset:512
    v_mfma_f32_16x16x32_bf16 v[172:175], a[164:167], a[124:127], v[172:175]
    ds_read_b64_tr_b16 a[140:141], v14 offset:4096
    v_mfma_f32_16x16x32_bf16 v[172:175], a[160:163], a[120:123], v[172:175]
    ds_read_b64_tr_b16 a[142:143], v14 offset:4608
    v_mfma_f32_16x16x32_bf16 v[176:179], a[168:171], a[120:123], v[176:179]
    v_mfma_f32_16x16x32_bf16 v[176:179], a[172:175], a[124:127], v[176:179]
    v_mfma_f32_16x16x32_bf16 v[152:155], a[172:175], a[116:119], v[152:155]
    v_mfma_f32_16x16x32_bf16 v[152:155], a[168:171], a[112:115], v[152:155]
    v_mfma_f32_16x16x32_bf16 v[128:131], a[168:171], a[104:107], v[128:131]
    v_mfma_f32_16x16x32_bf16 v[128:131], a[172:175], a[108:111], v[128:131]
    v_mfma_f32_16x16x32_bf16 v[104:107], a[172:175], a[100:103], v[104:107]
    v_mfma_f32_16x16x32_bf16 v[104:107], a[168:171], a[96:99], v[104:107]
    s_waitcnt lgkmcnt(1)
    v_mfma_f32_16x16x32_bf16 v[108:111], a[128:131], a[64:67], v[108:111]
    ds_read_b64_tr_b16 a[144:145], v15 offset:49152
    v_mfma_f32_16x16x32_bf16 v[108:111], a[132:135], a[68:71], v[108:111]
    ds_read_b64_tr_b16 a[146:147], v15 offset:49664
    v_mfma_f32_16x16x32_bf16 v[132:135], a[132:135], a[76:79], v[132:135]
    ds_read_b64_tr_b16 a[148:149], v15 offset:53248
    v_mfma_f32_16x16x32_bf16 v[132:135], a[128:131], a[72:75], v[132:135]
    ds_read_b64_tr_b16 a[150:151], v15 offset:53760
    v_mfma_f32_16x16x32_bf16 v[156:159], a[128:131], a[80:83], v[156:159]
    ds_read_b64_tr_b16 a[152:153], v16 offset:49152
    v_mfma_f32_16x16x32_bf16 v[156:159], a[132:135], a[84:87], v[156:159]
    ds_read_b64_tr_b16 a[154:155], v16 offset:49664
    v_mfma_f32_16x16x32_bf16 v[180:183], a[132:135], a[92:95], v[180:183]
    ds_read_b64_tr_b16 a[156:157], v16 offset:53248
    v_mfma_f32_16x16x32_bf16 v[180:183], a[128:131], a[88:91], v[180:183]
    ds_read_b64_tr_b16 a[158:159], v16 offset:53760
    v_mfma_f32_16x16x32_bf16 v[184:187], a[136:139], a[88:91], v[184:187]
    ds_read_b64_tr_b16 a[160:161], v15 offset:57344
    s_waitcnt lgkmcnt(5)
    v_mfma_f32_16x16x32_bf16 v[184:187], a[140:143], a[92:95], v[184:187]
    ds_read_b64_tr_b16 a[162:163], v15 offset:57856
    v_mfma_f32_16x16x32_bf16 v[160:163], a[140:143], a[84:87], v[160:163]
    ds_read_b64_tr_b16 a[164:165], v15 offset:61440
    v_mfma_f32_16x16x32_bf16 v[160:163], a[136:139], a[80:83], v[160:163]
    ds_read_b64_tr_b16 a[166:167], v15 offset:61952
    v_mfma_f32_16x16x32_bf16 v[136:139], a[136:139], a[72:75], v[136:139]
    ds_read_b64_tr_b16 a[168:169], v16 offset:57344
    v_mfma_f32_16x16x32_bf16 v[136:139], a[140:143], a[76:79], v[136:139]
    ds_read_b64_tr_b16 a[170:171], v16 offset:57856
    v_cvt_pk_bf16_f32 v180, v180, v181
    v_mfma_f32_16x16x32_bf16 v[112:115], a[140:143], a[68:71], v[112:115]
    ds_read_b64_tr_b16 a[172:173], v16 offset:61440
    v_cvt_pk_bf16_f32 v181, v182, v183
    v_mfma_f32_16x16x32_bf16 v[112:115], a[136:139], a[64:67], v[112:115]
    ds_read_b64_tr_b16 a[174:175], v16 offset:61952
    v_cvt_pk_bf16_f32 v182, v184, v185
    v_mfma_f32_16x16x32_bf16 v[116:119], a[64:67], a[144:147], v[116:119]
    v_cvt_pk_bf16_f32 v183, v186, v187
    v_mfma_f32_16x16x32_bf16 v[116:119], a[68:71], a[148:151], v[116:119]
    ds_write_b128 v68, v[180:183] offset:4160
    v_mfma_f32_16x16x32_bf16 v[140:143], a[76:79], a[148:151], v[140:143]
    v_cvt_pk_bf16_f32 v156, v156, v157
    v_cvt_pk_bf16_f32 v157, v158, v159
    v_mfma_f32_16x16x32_bf16 v[140:143], a[72:75], a[144:147], v[140:143]
    v_cvt_pk_bf16_f32 v158, v160, v161
    v_cvt_pk_bf16_f32 v159, v162, v163
    v_mfma_f32_16x16x32_bf16 v[164:167], a[80:83], a[144:147], v[164:167]
    ds_write_b128 v68, v[156:159] offset:4096
    v_mfma_f32_16x16x32_bf16 v[164:167], a[84:87], a[148:151], v[164:167]
    v_cvt_pk_bf16_f32 v132, v132, v133
    v_cvt_pk_bf16_f32 v133, v134, v135
    v_mfma_f32_16x16x32_bf16 v[188:191], a[92:95], a[148:151], v[188:191]
    v_cvt_pk_bf16_f32 v134, v136, v137
    v_cvt_pk_bf16_f32 v135, v138, v139
    v_mfma_f32_16x16x32_bf16 v[188:191], a[88:91], a[144:147], v[188:191]
    ds_write_b128 v68, v[132:135] offset:64
    s_waitcnt lgkmcnt(2)
    v_mfma_f32_16x16x32_bf16 v[192:195], a[88:91], a[152:155], v[192:195]
    v_cvt_pk_bf16_f32 v108, v108, v109
    v_cvt_pk_bf16_f32 v109, v110, v111
    v_mfma_f32_16x16x32_bf16 v[192:195], a[92:95], a[156:159], v[192:195]
    v_cvt_pk_bf16_f32 v110, v112, v113
    v_cvt_pk_bf16_f32 v111, v114, v115
    v_mfma_f32_16x16x32_bf16 v[168:171], a[84:87], a[156:159], v[168:171]
    ds_write_b128 v68, v[108:111] offset:0
    v_mfma_f32_16x16x32_bf16 v[168:171], a[80:83], a[152:155], v[168:171]
    ds_read_b128 a[96:99], v71 offset:0
    v_mfma_f32_16x16x32_bf16 v[144:147], a[72:75], a[152:155], v[144:147]
    ds_read_b128 a[100:103], v71 offset:1024
    v_mfma_f32_16x16x32_bf16 v[144:147], a[76:79], a[156:159], v[144:147]
    ds_read_b128 a[112:115], v71 offset:4096
    v_mfma_f32_16x16x32_bf16 v[120:123], a[68:71], a[156:159], v[120:123]
    ds_read_b128 a[116:119], v71 offset:5120
    v_cvt_pk_bf16_f32 v116, v116, v117
    v_mfma_f32_16x16x32_bf16 v[120:123], a[64:67], a[152:155], v[120:123]
    v_cvt_pk_bf16_f32 v117, v118, v119
    v_cvt_pk_bf16_f32 v118, v140, v141
    v_mfma_f32_16x16x32_bf16 v[100:103], a[160:163], a[64:67], v[100:103]
    v_cvt_pk_bf16_f32 v119, v142, v143
    v_mfma_f32_16x16x32_bf16 v[100:103], a[164:167], a[68:71], v[100:103]
    ds_write_b128 v69, v[116:119] offset:2048
    v_mfma_f32_16x16x32_bf16 v[124:127], a[164:167], a[76:79], v[124:127]
    s_waitcnt lgkmcnt(1)
    buffer_store_dwordx4 a[96:99], v3, s[16:19], s67 offen offset:0 sc1
    v_mfma_f32_16x16x32_bf16 v[124:127], a[160:163], a[72:75], v[124:127]
    v_cvt_pk_bf16_f32 v164, v164, v165
    v_cvt_pk_bf16_f32 v165, v166, v167
    v_mfma_f32_16x16x32_bf16 v[148:151], a[160:163], a[80:83], v[148:151]
    v_cvt_pk_bf16_f32 v166, v188, v189
    v_cvt_pk_bf16_f32 v167, v190, v191
    v_mfma_f32_16x16x32_bf16 v[148:151], a[164:167], a[84:87], v[148:151]
    ds_write_b128 v69, v[164:167] offset:6144
    v_mfma_f32_16x16x32_bf16 v[172:175], a[164:167], a[92:95], v[172:175]
    buffer_store_dwordx4 a[100:103], v3, s[16:19], s67 offen offset:1024 sc1
    v_mfma_f32_16x16x32_bf16 v[172:175], a[160:163], a[88:91], v[172:175]
    v_cvt_pk_bf16_f32 v168, v168, v169
    v_cvt_pk_bf16_f32 v169, v170, v171
    v_mfma_f32_16x16x32_bf16 v[176:179], a[168:171], a[88:91], v[176:179]
    v_cvt_pk_bf16_f32 v170, v192, v193
    v_cvt_pk_bf16_f32 v171, v194, v195
    v_mfma_f32_16x16x32_bf16 v[176:179], a[172:175], a[92:95], v[176:179]
    ds_write_b128 v69, v[168:171] offset:6400
    v_mfma_f32_16x16x32_bf16 v[152:155], a[172:175], a[84:87], v[152:155]
    buffer_store_dwordx4 a[112:115], v3, s[16:19], s84 offen offset:0 sc1
    v_mfma_f32_16x16x32_bf16 v[152:155], a[168:171], a[80:83], v[152:155]
    v_cvt_pk_bf16_f32 v120, v120, v121
    v_cvt_pk_bf16_f32 v121, v122, v123
    v_mfma_f32_16x16x32_bf16 v[128:131], a[168:171], a[72:75], v[128:131]
    v_cvt_pk_bf16_f32 v122, v144, v145
    v_cvt_pk_bf16_f32 v123, v146, v147
    v_mfma_f32_16x16x32_bf16 v[128:131], a[172:175], a[76:79], v[128:131]
    ds_write_b128 v69, v[120:123] offset:2304
    v_mfma_f32_16x16x32_bf16 v[104:107], a[172:175], a[68:71], v[104:107]
    buffer_store_dwordx4 a[116:119], v3, s[16:19], s84 offen offset:1024 sc1
    v_mfma_f32_16x16x32_bf16 v[104:107], a[168:171], a[64:67], v[104:107]
L_pad_5:
    s_cmp_eq_u32 s3, 1
    s_cbranch_scc1 L_walkret
    v_mov_b32 v248, s85
    v_mov_b32 v249, s85
    ds_read_b128 a[104:107], v71 offset:2048
    ds_read_b128 a[108:111], v71 offset:3072
    ds_read_b128 a[120:123], v71 offset:6144
    ds_read_b128 a[124:127], v71 offset:7168
    v_pk_mul_f32 v[172:173], v[172:173], v[248:249]
    v_pk_mul_f32 v[174:175], v[174:175], v[248:249]
    v_pk_mul_f32 v[176:177], v[176:177], v[248:249]
    v_pk_mul_f32 v[178:179], v[178:179], v[248:249]
    v_cvt_pk_bf16_f32 v172, v172, v173
    v_cvt_pk_bf16_f32 v173, v174, v175
    v_cvt_pk_bf16_f32 v174, v176, v177
    v_cvt_pk_bf16_f32 v175, v178, v179
    ds_write_b128 v70, v[172:175] offset:2304
    s_waitcnt lgkmcnt(1)
    buffer_store_dwordx4 a[104:107], v3, s[16:19], s67 offen offset:2048 sc1
    v_pk_mul_f32 v[148:149], v[148:149], v[248:249]
    v_pk_mul_f32 v[150:151], v[150:151], v[248:249]
    v_pk_mul_f32 v[152:153], v[152:153], v[248:249]
    v_pk_mul_f32 v[154:155], v[154:155], v[248:249]
    v_cvt_pk_bf16_f32 v148, v148, v149
    v_cvt_pk_bf16_f32 v149, v150, v151
    v_cvt_pk_bf16_f32 v150, v152, v153
    v_cvt_pk_bf16_f32 v151, v154, v155
    ds_write_b128 v70, v[148:151] offset:2048
    buffer_store_dwordx4 a[108:111], v3, s[16:19], s67 offen offset:3072 sc1
    v_pk_mul_f32 v[124:125], v[124:125], v[248:249]
    v_pk_mul_f32 v[126:127], v[126:127], v[248:249]
    v_pk_mul_f32 v[128:129], v[128:129], v[248:249]
    v_pk_mul_f32 v[130:131], v[130:131], v[248:249]
    v_cvt_pk_bf16_f32 v124, v124, v125
    v_cvt_pk_bf16_f32 v125, v126, v127
    v_cvt_pk_bf16_f32 v126, v128, v129
    v_cvt_pk_bf16_f32 v127, v130, v131
    ds_write_b128 v70, v[124:127] offset:256
    buffer_store_dwordx4 a[120:123], v3, s[16:19], s84 offen offset:2048 sc1
    v_pk_mul_f32 v[100:101], v[100:101], v[248:249]
    v_pk_mul_f32 v[102:103], v[102:103], v[248:249]
    v_pk_mul_f32 v[104:105], v[104:105], v[248:249]
    v_pk_mul_f32 v[106:107], v[106:107], v[248:249]
    v_cvt_pk_bf16_f32 v100, v100, v101
    v_cvt_pk_bf16_f32 v101, v102, v103
    v_cvt_pk_bf16_f32 v102, v104, v105
    v_cvt_pk_bf16_f32 v103, v106, v107
    ds_write_b128 v70, v[100:103] offset:0
    buffer_store_dwordx4 a[124:127], v3, s[16:19], s84 offen offset:3072 sc1
    s_waitcnt vmcnt(8) lgkmcnt(0)
    s_barrier
    ds_read_b128 a[128:131], v76 offset:0
    ds_read_b128 a[64:67], v72 offset:0
    ds_read_b128 a[132:135], v76 offset:1024
    ds_read_b128 a[68:71], v72 offset:1024
    ds_read_b128 a[72:75], v72 offset:2048
    ds_read_b128 a[76:79], v72 offset:3072
    s_waitcnt lgkmcnt(4)
    v_mfma_f32_32x32x16_bf16 v[100:115], a[128:131], a[64:67], 0
    ds_read_b128 a[80:83], v73 offset:0
    ds_read_b128 a[84:87], v73 offset:1024
    ds_read_b128 a[88:91], v73 offset:2048
    s_waitcnt lgkmcnt(5)
    v_mfma_f32_32x32x16_bf16 v[100:115], a[132:135], a[68:71], v[100:115]
    ds_read_b128 a[92:95], v73 offset:3072
    ds_read_b128 a[176:179], v74 offset:0
    ds_read_b128 a[180:183], v74 offset:4096
    s_waitcnt lgkmcnt(7)
    v_mfma_f32_32x32x16_bf16 v[116:131], a[128:131], a[72:75], 0
    ds_read_b128 a[184:187], v74 offset:8192
    ds_read_b128 a[188:191], v74 offset:12288
    ds_read_b128 a[192:195], v75 offset:0
    s_waitcnt lgkmcnt(7)
    v_mfma_f32_32x32x16_bf16 v[116:131], a[132:135], a[76:79], v[116:131]
    ds_read_b128 a[196:199], v75 offset:4096
    ds_read_b128 a[200:203], v75 offset:8192
    ds_read_b128 a[204:207], v75 offset:12288
    v_add_u32 v70, s38, v1
    v_mfma_f32_32x32x16_bf16 v[132:147], a[128:131], a[80:83], 0
    v_and_b32 v69, 15, v70
    v_lshlrev_b32 v8, 15, v69
    s_lshr_b32 s54, s38, 1
    v_add_u32 v70, s54, v1
    v_bfi_b32 v69, 7, v70, v1
    v_and_b32 v69, 15, v69
    v_lshlrev_b32 v7, 11, v69
    v_mfma_f32_32x32x16_bf16 v[132:147], a[132:135], a[84:87], v[132:147]
    s_lshl_b32 s47, s38, 6
    s_sub_u32 s48, 0, s81
    s_mul_i32 s49, s81, 1025
    v_lshrrev_b32 v68, 2, v1
    v_add_u32 v68, s47, v68
    v_xor_b32 v68, s48, v68
    v_add_u32 v68, s49, v68
    s_waitcnt lgkmcnt(0)
    v_mfma_f32_32x32x16_bf16 v[148:163], a[128:131], a[88:91], 0
    v_lshrrev_b32 v69, 5, v1
    v_mul_u32_u24 v69, 3, v69
    v_xor_b32 v69, v69, v1
    v_and_b32 v69, 3, v69
    v_lshlrev_b32 v69, 4, v69
    v_lshl_add_u32 v5, v68, 12, v69
    v_mfma_f32_32x32x16_bf16 v[148:163], a[132:135], a[92:95], v[148:163]
    v_add_u32 v68, s47, v1
    v_xor_b32 v68, s48, v68
    v_add_lshl_u32 v6, v68, s49, 12
    s_andn2_b32 s47, 0x80000000, s48
    v_or_b32 v6, s47, v6
    s_mul_i32 s47, s81, 15
    s_xor_b32 s47, s47, s38
    s_cmp_eq_u32 s65, 0
    s_cbranch_scc1 L_nyq
L_nyq_done:
    v_mfma_f32_32x32x16_bf16 v[20:35], a[176:179], a[0:3], 0
    v_max_f32 v248, v100, v101
    v_max3_f32 v248, v102, v103, v248
    v_max3_f32 v248, v104, v105, v248
    v_max3_f32 v248, v106, v107, v248
    v_max3_f32 v248, v108, v109, v248
    v_max3_f32 v248, v110, v111, v248
    v_mfma_f32_32x32x16_bf16 v[20:35], a[180:183], a[4:7], v[20:35]
    v_max3_f32 v248, v112, v113, v248
    v_max3_f32 v248, v114, v115, v248
    v_add_f32 v248, 0x41f00000, v248
    v_and_b32 v249, 0xffff0000, v248
    v_sub_f32 v248, v248, v249
    v_cvt_pk_bf16_f32 v250, v249, v248
    v_mfma_f32_32x32x16_bf16 v[20:35], a[184:187], a[8:11], v[20:35]
    v_max_f32 v248, v116, v117
    v_max3_f32 v248, v118, v119, v248
    v_max3_f32 v248, v120, v121, v248
    v_max3_f32 v248, v122, v123, v248
    v_max3_f32 v248, v124, v125, v248
    v_max3_f32 v248, v126, v127, v248
    v_mfma_f32_32x32x16_bf16 v[20:35], a[188:191], a[12:15], v[20:35]
    v_max3_f32 v248, v128, v129, v248
    v_max3_f32 v248, v130, v131, v248
    v_add_f32 v248, 0x41f00000, v248
    v_and_b32 v249, 0xffff0000, v248
    v_sub_f32 v248, v248, v249
    v_cvt_pk_bf16_f32 v251, v249, v248
    v_mfma_f32_32x32x16_bf16 v[36:51], a[176:179], a[32:35], 0
    v_max_f32 v248, v132, v133
    v_max3_f32 v248, v134, v135, v248
    v_max3_f32 v248, v136, v137, v248
    v_max3_f32 v248, v138, v139, v248
    v_max3_f32 v248, v140, v141, v248
    v_max3_f32 v248, v142, v143, v248
    v_mfma_f32_32x32x16_bf16 v[36:51], a[180:183], a[36:39], v[36:51]
    v_max3_f32 v248, v144, v145, v248
    v_max3_f32 v248, v146, v147, v248
    v_add_f32 v248, 0x41f00000, v248
    v_and_b32 v249, 0xffff0000, v248
    v_sub_f32 v248, v248, v249
    v_cvt_pk_bf16_f32 v252, v249, v248
    v_mfma_f32_32x32x16_bf16 v[36:51], a[184:187], a[40:43], v[36:51]
    v_max_f32 v248, v148, v149
    v_max3_f32 v248, v150, v151, v248
    v_max3_f32 v248, v152, v153, v248
    v_max3_f32 v248, v154, v155, v248
    v_max3_f32 v248, v156, v157, v248
    v_max3_f32 v248, v158, v159, v248
    v_mfma_f32_32x32x16_bf16 v[36:51], a[188:191], a[44:47], v[36:51]
    v_max3_f32 v248, v160, v161, v248
    v_max3_f32 v248, v162, v163, v248
    v_add_f32 v248, 0x41f00000, v248
    v_and_b32 v249, 0xffff0000, v248
    v_sub_f32 v248, v248, v249
    v_cvt_pk_bf16_f32 v253, v249, v248
    s_lshl_b32 s47, s47, 5
    v_mfma_f32_32x32x16_bf16 v[20:35], a[192:195], a[16:19], v[20:35]
    s_add_u32 s48, s81, 31
    v_min_u32 v68, s48, v1
    v_add_u32 v68, s47, v68
    v_and_b32 v68, 255, v68
    v_lshlrev_b32 v4, 11, v68
    v_bfe_u32 v68, v1, 3, 1
    v_mul_u32_u24 v68, 3, v68
    v_mfma_f32_32x32x16_bf16 v[20:35], a[196:199], a[20:23], v[20:35]
    v_lshrrev_b32 v69, 4, v1
    v_xor_b32 v68, v68, v69
    v_lshlrev_b32 v68, 4, v68
    v_and_b32 v69, 15, v1
    v_lshl_add_u32 v17, v69, 6, v68
    v_mfma_f32_32x32x16_bf16 v[20:35], a[200:203], a[24:27], v[20:35]
    v_mfma_f32_32x32x16_bf16 v[20:35], a[204:207], a[28:31], v[20:35]
    v_mfma_f32_32x32x16_bf16 v[36:51], a[192:195], a[0:3], v[36:51]
    v_mfma_f32_32x32x16_bf16 v[36:51], a[196:199], a[4:7], v[36:51]
    v_mfma_f32_32x32x16_bf16 v[36:51], a[200:203], a[8:11], v[36:51]
    v_mfma_f32_32x32x16_bf16 v[36:51], a[204:207], a[12:15], v[36:51]
    v_mfma_f32_32x32x8_bf16 v[164:179], v[82:83], v[250:251], 0
    v_mfma_f32_32x32x8_bf16 v[180:195], v[234:235], v[250:251], 0
    s_waitcnt vmcnt(0)
    buffer_store_dword v19, v2, s[16:19], s53 offen offset:128 sc1
    s_nop 3
    v_pk_mul_f32 v[150:151], v[20:21], v[212:213]
    s_nop 2
    v_pk_mul_f32 v[148:149], v[36:37], v[212:213]
    v_pk_fma_f32 v[150:151], v[36:37], v[196:197], v[150:151] neg_lo:[0,0,1] neg_hi:[0,0,1]
    v_pk_fma_f32 v[148:149], v[20:21], v[196:197], v[148:149]
    v_cvt_pk_bf16_f32 v124, v150, v151
    v_cvt_pk_bf16_f32 v116, v148, v149
    v_pk_mul_f32 v[154:155], v[22:23], v[214:215]
    v_pk_mul_f32 v[152:153], v[38:39], v[214:215]
    v_pk_fma_f32 v[154:155], v[38:39], v[198:199], v[154:155] neg_lo:[0,0,1] neg_hi:[0,0,1]
    v_pk_fma_f32 v[152:153], v[22:23], v[198:199], v[152:153]
    v_cvt_pk_bf16_f32 v125, v154, v155
    v_cvt_pk_bf16_f32 v117, v152, v153
    v_pk_mul_f32 v[150:151], v[24:25], v[216:217]
    v_pk_mul_f32 v[148:149], v[40:41], v[216:217]
    v_pk_fma_f32 v[150:151], v[40:41], v[200:201], v[150:151] neg_lo:[0,0,1] neg_hi:[0,0,1]
    v_pk_fma_f32 v[148:149], v[24:25], v[200:201], v[148:149]
    v_cvt_pk_bf16_f32 v126, v150, v151
    v_cvt_pk_bf16_f32 v118, v148, v149
    v_pk_mul_f32 v[154:155], v[26:27], v[218:219]
    v_pk_mul_f32 v[152:153], v[42:43], v[218:219]
    v_pk_fma_f32 v[154:155], v[42:43], v[202:203], v[154:155] neg_lo:[0,0,1] neg_hi:[0,0,1]
    v_pk_fma_f32 v[152:153], v[26:27], v[202:203], v[152:153]
    v_cvt_pk_bf16_f32 v127, v154, v155
    v_cvt_pk_bf16_f32 v119, v152, v153
    v_pk_mul_f32 v[150:151], v[28:29], v[220:221]
    v_pk_mul_f32 v[148:149], v[44:45], v[220:221]
    v_pk_fma_f32 v[150:151], v[44:45], v[204:205], v[150:151] neg_lo:[0,0,1] neg_hi:[0,0,1]
    v_pk_fma_f32 v[148:149], v[28:29], v[204:205], v[148:149]
    v_cvt_pk_bf16_f32 v128, v150, v151
    v_cvt_pk_bf16_f32 v120, v148, v149
    v_pk_mul_f32 v[154:155], v[30:31], v[222:223]
    v_pk_mul_f32 v[152:153], v[46:47], v[222:223]
    v_pk_fma_f32 v[154:155], v[46:47], v[206:207], v[154:155] neg_lo:[0,0,1] neg_hi:[0,0,1]
    v_pk_fma_f32 v[152:153], v[30:31], v[206:207], v[152:153]
    v_cvt_pk_bf16_f32 v129, v154, v155
    v_cvt_pk_bf16_f32 v121, v152, v153
    v_pk_mul_f32 v[150:151], v[32:33], v[224:225]
    v_pk_mul_f32 v[148:149], v[48:49], v[224:225]
    v_pk_fma_f32 v[150:151], v[48:49], v[208:209], v[150:151] neg_lo:[0,0,1] neg_hi:[0,0,1]
    v_pk_fma_f32 v[148:149], v[32:33], v[208:209], v[148:149]
    v_cvt_pk_bf16_f32 v130, v150, v151
    v_cvt_pk_bf16_f32 v122, v148, v149
    v_pk_mul_f32 v[154:155], v[34:35], v[226:227]
    v_pk_mul_f32 v[152:153], v[50:51], v[226:227]
    v_pk_fma_f32 v[154:155], v[50:51], v[210:211], v[154:155] neg_lo:[0,0,1] neg_hi:[0,0,1]
    v_pk_fma_f32 v[152:153], v[34:35], v[210:211], v[152:153]
    v_cvt_pk_bf16_f32 v131, v154, v155
    v_cvt_pk_bf16_f32 v123, v152, v153
    v_mfma_f32_32x32x16_bf16 v[132:147], v[116:119], a[48:51], 0
    v_mfma_f32_32x32x16_bf16 v[132:147], v[124:127], a[56:59], v[132:147]
    v_mov_b64 v[20:21], 0
    v_mov_b64 v[22:23], 0
    v_mov_b64 v[24:25], 0
    v_mov_b64 v[26:27], 0
    v_mov_b64 v[28:29], 0
    v_mov_b64 v[30:31], 0
    v_mfma_f32_32x32x16_bf16 v[132:147], v[120:123], a[52:55], v[132:147]
    v_mov_b64 v[32:33], 0
    v_mov_b64 v[34:35], 0
    v_mov_b64 v[36:37], 0
    v_mov_b64 v[38:39], 0
    v_mov_b64 v[40:41], 0
    v_mov_b64 v[42:43], 0
    v_mfma_f32_32x32x16_bf16 v[132:147], v[128:131], a[60:63], v[132:147]
    v_mov_b64 v[44:45], 0
    v_mov_b64 v[46:47], 0
    v_mov_b64 v[48:49], 0
    v_mov_b64 v[50:51], 0
    v_mov_b64 v[68:69], 0
    v_mov_b64 v[70:71], 0
    v_mfma_f32_32x32x8_bf16 v[196:211], v[82:83], v[252:253], 0
    v_mov_b64 v[72:73], 0
    v_mov_b64 v[74:75], 0
    v_mov_b32 v16, v3
    v_mov_b32 v18, v2
    v_mfma_f32_32x32x16_bf16 v[100:115], a[96:99], a[64:67], v[164:179]
    v_cvt_pk_bf16_f32 v156, v132, v133
    v_cvt_pk_bf16_f32 v157, v134, v135
    v_mfma_f32_32x32x16_bf16 v[100:115], a[100:103], a[68:71], v[100:115]
    ds_write_b64 v78, v[156:157]
    v_cvt_pk_bf16_f32 v158, v136, v137
    v_cvt_pk_bf16_f32 v159, v138, v139
    v_mfma_f32_32x32x8_bf16 v[212:227], v[234:235], v[252:253], 0
    ds_write_b64 v79, v[158:159]
    v_cvt_pk_bf16_f32 v160, v140, v141
    v_cvt_pk_bf16_f32 v161, v142, v143
    ds_write_b64 v80, v[160:161]
    v_cvt_pk_bf16_f32 v162, v144, v145
    v_cvt_pk_bf16_f32 v163, v146, v147
    ds_write_b64 v81, v[162:163]
    ds_read_b128 a[208:211], v77 offset:0
    ds_read_b128 a[212:215], v77 offset:1024
    v_mov_b64 v[76:77], 0
    v_mov_b64 v[78:79], 0
    v_mov_b64 v[80:81], 0
    v_mov_b64 v[82:83], 0
    s_waitcnt lgkmcnt(0)
    s_barrier
L_att:
    v_mfma_f32_32x32x16_bf16 v[116:131], a[96:99], a[72:75], v[180:195]
    s_add_u32 s68, s68, 16384
    v_exp_f32 v100, v100
    v_exp_f32 v101, v101
    v_exp_f32 v102, v102
    v_mfma_f32_32x32x16_bf16 v[116:131], a[100:103], a[76:79], v[116:131]
    s_and_b32 s68, s68, 0x3ffff
    v_exp_f32 v103, v103
    v_exp_f32 v104, v104
    v_exp_f32 v105, v105
    v_exp_f32 v106, v106
    v_exp_f32 v107, v107
    v_exp_f32 v108, v108
    v_exp_f32 v109, v109
    v_exp_f32 v110, v110
    v_smfmac_f32_32x32x32_bf16 v[20:35], a[104:107], v[100:107], v232
    s_add_u32 s62, s16, s66
    s_addc_u32 s63, s17, 0
    v_exp_f32 v111, v111
    v_exp_f32 v112, v112
    v_exp_f32 v113, v113
    v_smfmac_f32_16x16x64_bf16 v[84:87], v[228:231], v[100:107], v232
    s_add_u32 s8, s62, s68
    s_addc_u32 s9, s63, 0
    v_exp_f32 v114, v114
    v_exp_f32 v115, v115
    v_mfma_f32_32x32x16_bf16 v[132:147], a[96:99], a[80:83], v[196:211]
    s_mov_b32 s10, 4096
    v_exp_f32 v116, v116
    v_exp_f32 v117, v117
    v_exp_f32 v118, v118
    v_mfma_f32_32x32x16_bf16 v[132:147], a[100:103], a[84:87], v[132:147]
    s_lshr_b32 s74, s37, 1
    v_exp_f32 v119, v119
    v_exp_f32 v120, v120
    v_exp_f32 v121, v121
    v_smfmac_f32_32x32x32_bf16 v[20:35], a[108:111], v[108:115], v232
    s_add_u32 s4, s20, s69
    s_addc_u32 s5, s21, 0
    v_exp_f32 v122, v122
    v_exp_f32 v123, v123
    v_exp_f32 v124, v124
    v_smfmac_f32_16x16x64_bf16 v[84:87], v[228:231], v[108:115], v232
    s_mov_b32 s14, 14464
    s_mov_b32 s46, 6
    v_exp_f32 v125, v125
    v_exp_f32 v126, v126
    v_smfmac_f32_32x32x32_bf16 v[36:51], a[104:107], v[116:123], v232
    buffer_load_dword v244, v8, s[16:19], s82 offen offset:128 sc1
    v_exp_f32 v127, v127
    v_exp_f32 v128, v128
    v_exp_f32 v129, v129
    v_smfmac_f32_16x16x64_bf16 v[88:91], v[228:231], v[116:123], v232
    v_exp_f32 v130, v130
    v_exp_f32 v131, v131
    v_mfma_f32_32x32x16_bf16 v[148:163], a[96:99], a[88:91], v[212:227]
    s_mul_i32 s74, s74, 16384
    v_exp_f32 v132, v132
    v_exp_f32 v133, v133
    v_exp_f32 v134, v134
    v_mfma_f32_32x32x16_bf16 v[148:163], a[100:103], a[92:95], v[148:163]
    v_exp_f32 v135, v135
    v_exp_f32 v136, v136
    v_exp_f32 v137, v137
    v_smfmac_f32_32x32x32_bf16 v[36:51], a[108:111], v[124:131], v232
    s_add_u32 m0, s70, s74
    s_lshl_b32 s93, s74, 4
    v_exp_f32 v138, v138
    v_exp_f32 v139, v139
    v_exp_f32 v140, v140
    v_smfmac_f32_16x16x64_bf16 v[88:91], v[228:231], v[124:131], v232
    s_add_u32 s12, s4, s93
    s_addc_u32 s13, s5, 0
    v_exp_f32 v141, v141
    v_exp_f32 v142, v142
    v_smfmac_f32_32x32x32_bf16 v[52:67], a[104:107], v[132:139], v232
    v_exp_f32 v143, v143
    v_exp_f32 v144, v144
    v_exp_f32 v145, v145
    v_smfmac_f32_16x16x64_bf16 v[92:95], v[228:231], v[132:139], v232
    v_exp_f32 v146, v146
    v_exp_f32 v147, v147
    v_mfma_f32_32x32x16_bf16 v[100:115], a[112:115], a[64:67], v[164:179]
    s_waitcnt vmcnt(0)
    v_cmp_eq_u32 vcc, 1, v244
    v_exp_f32 v148, v148
    v_exp_f32 v149, v149
    v_exp_f32 v150, v150
    v_mfma_f32_32x32x16_bf16 v[100:115], a[116:119], a[68:71], v[100:115]
    s_andn2_b32 s47, 6, vcc_lo
    s_cmp_eq_u32 s47, 0
    s_cbranch_scc0 L_fb0_slow
L_fb0_ok:
    v_exp_f32 v151, v151
    v_exp_f32 v152, v152
    v_exp_f32 v153, v153
    v_smfmac_f32_32x32x32_bf16 v[52:67], a[108:111], v[140:147], v232
    buffer_load_dwordx4 a[128:131], v3, s[8:11], 0 offen offset:0 sc1
    v_exp_f32 v154, v154
    v_exp_f32 v155, v155
    v_exp_f32 v156, v156
    v_smfmac_f32_16x16x64_bf16 v[92:95], v[228:231], v[140:147], v232
    buffer_load_dwordx4 a[132:135], v3, s[8:11], 0 offen offset:1024 sc1
    v_exp_f32 v157, v157
    v_exp_f32 v158, v158
    v_smfmac_f32_32x32x32_bf16 v[68:83], a[104:107], v[148:155], v232
    v_exp_f32 v159, v159
    v_exp_f32 v160, v160
    v_exp_f32 v161, v161
    v_smfmac_f32_16x16x64_bf16 v[96:99], v[228:231], v[148:155], v232
    v_exp_f32 v162, v162
    v_exp_f32 v163, v163
    v_mfma_f32_32x32x16_bf16 v[116:131], a[112:115], a[72:75], v[180:195]
    v_exp_f32 v100, v100
    v_exp_f32 v101, v101
    v_exp_f32 v102, v102
    v_mfma_f32_32x32x16_bf16 v[116:131], a[116:119], a[76:79], v[116:131]
    v_exp_f32 v103, v103
    v_exp_f32 v104, v104
    v_exp_f32 v105, v105
    v_smfmac_f32_32x32x32_bf16 v[68:83], a[108:111], v[156:163], v232
    v_exp_f32 v106, v106
    v_exp_f32 v107, v107
    v_exp_f32 v108, v108
    v_smfmac_f32_16x16x64_bf16 v[96:99], v[228:231], v[156:163], v232
    buffer_load_dwordx4 a[136:139], v3, s[8:11], 0 offen offset:2048 sc1
    v_exp_f32 v109, v109
    v_exp_f32 v110, v110
    v_smfmac_f32_32x32x32_bf16 v[20:35], a[120:123], v[100:107], v232
    buffer_load_dwordx4 a[140:143], v3, s[8:11], 0 offen offset:3072 sc1
    v_exp_f32 v111, v111
    v_exp_f32 v112, v112
    v_exp_f32 v113, v113
    v_smfmac_f32_16x16x64_bf16 v[84:87], v[228:231], v[100:107], v232
    s_add_u32 s8, s8, 4096
    s_addc_u32 s9, s9, 0
    v_exp_f32 v114, v114
    v_exp_f32 v115, v115
    buffer_load_dword v244, v8, s[16:19], s82 offen offset:128 sc1
    v_mfma_f32_32x32x16_bf16 v[132:147], a[112:115], a[80:83], v[196:211]
    s_add_u32 s68, s68, 16384
    v_exp_f32 v116, v116
    v_exp_f32 v117, v117
    v_exp_f32 v118, v118
    v_mfma_f32_32x32x16_bf16 v[132:147], a[116:119], a[84:87], v[132:147]
    buffer_load_dwordx4 a[144:147], v3, s[8:11], 0 offen offset:0 sc1
    v_exp_f32 v119, v119
    v_exp_f32 v120, v120
    v_exp_f32 v121, v121
    v_smfmac_f32_32x32x32_bf16 v[20:35], a[124:127], v[108:115], v232
    s_and_b32 s68, s68, 0x3ffff
    v_exp_f32 v122, v122
    v_exp_f32 v123, v123
    v_exp_f32 v124, v124
    v_smfmac_f32_16x16x64_bf16 v[84:87], v[228:231], v[108:115], v232
    buffer_load_dwordx4 a[148:151], v3, s[8:11], 0 offen offset:1024 sc1
    v_exp_f32 v125, v125
    v_exp_f32 v126, v126
    v_smfmac_f32_32x32x32_bf16 v[36:51], a[120:123], v[116:123], v232
    buffer_load_dwordx4 a[152:155], v3, s[8:11], 0 offen offset:2048 sc1
    v_exp_f32 v127, v127
    v_exp_f32 v128, v128
    v_exp_f32 v129, v129
    v_smfmac_f32_16x16x64_bf16 v[88:91], v[228:231], v[116:123], v232
    buffer_load_dwordx4 a[156:159], v3, s[8:11], 0 offen offset:3072 sc1
    v_exp_f32 v130, v130
    v_exp_f32 v131, v131
    v_mfma_f32_32x32x16_bf16 v[148:163], a[112:115], a[88:91], v[212:227]
    v_exp_f32 v132, v132
    v_exp_f32 v133, v133
    v_exp_f32 v134, v134
    v_mfma_f32_32x32x16_bf16 v[148:163], a[116:119], a[92:95], v[148:163]
    v_exp_f32 v135, v135
    v_exp_f32 v136, v136
    v_exp_f32 v137, v137
    v_smfmac_f32_32x32x32_bf16 v[36:51], a[124:127], v[124:131], v232
    s_add_u32 s8, s62, s68
    s_addc_u32 s9, s63, 0
    v_exp_f32 v138, v138
    v_exp_f32 v139, v139
    v_exp_f32 v140, v140
    v_smfmac_f32_16x16x64_bf16 v[88:91], v[228:231], v[124:131], v232
    buffer_load_dwordx4 a[96:99], v3, s[8:11], 0 offen offset:0 sc1
    v_exp_f32 v141, v141
    v_exp_f32 v142, v142
    v_smfmac_f32_32x32x32_bf16 v[52:67], a[120:123], v[132:139], v232
    buffer_load_dwordx4 a[100:103], v3, s[8:11], 0 offen offset:1024 sc1
    v_exp_f32 v143, v143
    v_exp_f32 v144, v144
    v_exp_f32 v145, v145
    v_smfmac_f32_16x16x64_bf16 v[92:95], v[228:231], v[132:139], v232
    buffer_load_dwordx4 a[104:107], v3, s[8:11], 0 offen offset:2048 sc1
    v_exp_f32 v146, v146
    v_exp_f32 v147, v147
    s_waitcnt vmcnt(10)
    v_mfma_f32_32x32x16_bf16 v[100:115], a[128:131], a[64:67], v[164:179]
    v_exp_f32 v148, v148
    v_exp_f32 v149, v149
    v_exp_f32 v150, v150
    v_mfma_f32_32x32x16_bf16 v[100:115], a[132:135], a[68:71], v[100:115]
    buffer_load_dwordx4 a[108:111], v3, s[8:11], 0 offen offset:3072 sc1
    v_exp_f32 v151, v151
    v_exp_f32 v152, v152
    v_exp_f32 v153, v153
    v_smfmac_f32_32x32x32_bf16 v[52:67], a[124:127], v[140:147], v232
    v_exp_f32 v154, v154
    v_exp_f32 v155, v155
    v_exp_f32 v156, v156
    v_smfmac_f32_16x16x64_bf16 v[92:95], v[228:231], v[140:147], v232
    s_waitcnt vmcnt(8)
    v_cmp_eq_u32 vcc, 1, v244
    v_exp_f32 v157, v157
    v_exp_f32 v158, v158
    v_smfmac_f32_32x32x32_bf16 v[68:83], a[120:123], v[148:155], v232
    s_cmp_eq_u64 vcc, exec
    s_cbranch_scc0 L_fb_slow
L_fb_ok:
    v_exp_f32 v159, v159
    v_exp_f32 v160, v160
    v_exp_f32 v161, v161
    v_smfmac_f32_16x16x64_bf16 v[96:99], v[228:231], v[148:155], v232
    buffer_store_dwordx4 a[208:211], v16, s[16:19], s75 offen offset:0 sc1
    buffer_store_dwordx4 a[212:215], v16, s[16:19], s75 offen offset:1024 sc1
    v_exp_f32 v162, v162
    v_exp_f32 v163, v163
L_attloop:
    v_mfma_f32_32x32x16_bf16 v[116:131], a[128:131], a[72:75], v[180:195]
    v_exp_f32 v100, v100
    v_exp_f32 v101, v101
    v_exp_f32 v102, v102
    v_mfma_f32_32x32x16_bf16 v[116:131], a[132:135], a[76:79], v[116:131]
    v_exp_f32 v103, v103
    v_exp_f32 v104, v104
    v_exp_f32 v105, v105
    v_smfmac_f32_32x32x32_bf16 v[68:83], a[124:127], v[156:163], v232
    s_add_u32 s8, s8, 4096
    s_addc_u32 s9, s9, 0
    v_exp_f32 v106, v106
    v_exp_f32 v107, v107
    v_exp_f32 v108, v108
    v_smfmac_f32_16x16x64_bf16 v[96:99], v[228:231], v[156:163], v232
    buffer_load_dwordx4 a[112:115], v3, s[8:11], 0 offen offset:0 sc1
    v_exp_f32 v109, v109
    v_exp_f32 v110, v110
    v_smfmac_f32_32x32x32_bf16 v[20:35], a[136:139], v[100:107], v232
    v_exp_f32 v111, v111
    v_exp_f32 v112, v112
    v_exp_f32 v113, v113
    v_smfmac_f32_16x16x64_bf16 v[84:87], v[228:231], v[100:107], v232
    buffer_load_dwordx4 v237, s[12:15], 0 offen lds
    v_exp_f32 v114, v114
    v_exp_f32 v115, v115
    v_mfma_f32_32x32x16_bf16 v[132:147], a[128:131], a[80:83], v[196:211]
    s_add_u32 s74, s74, 4096
    v_exp_f32 v116, v116
    v_exp_f32 v117, v117
    v_exp_f32 v118, v118
    v_mfma_f32_32x32x16_bf16 v[132:147], a[132:135], a[84:87], v[132:147]
    v_exp_f32 v119, v119
    v_exp_f32 v120, v120
    v_exp_f32 v121, v121
    v_smfmac_f32_32x32x32_bf16 v[20:35], a[140:143], v[108:115], v232
    s_cmp_eq_u32 s74, 126976
    s_cselect_b32 s74, 0, s74
    v_exp_f32 v122, v122
    v_exp_f32 v123, v123
    v_exp_f32 v124, v124
    v_smfmac_f32_16x16x64_bf16 v[84:87], v[228:231], v[108:115], v232
    buffer_load_dwordx4 a[116:119], v3, s[8:11], 0 offen offset:1024 sc1
    v_exp_f32 v125, v125
    v_exp_f32 v126, v126
    v_smfmac_f32_32x32x32_bf16 v[36:51], a[136:139], v[116:123], v232
    s_add_u32 m0, s70, s74
    s_lshl_b32 s93, s74, 4
    v_exp_f32 v127, v127
    v_exp_f32 v128, v128
    v_exp_f32 v129, v129
    v_smfmac_f32_16x16x64_bf16 v[88:91], v[228:231], v[116:123], v232
    v_exp_f32 v130, v130
    v_exp_f32 v131, v131
    v_mfma_f32_32x32x16_bf16 v[148:163], a[128:131], a[88:91], v[212:227]
    v_exp_f32 v132, v132
    v_exp_f32 v133, v133
    v_exp_f32 v134, v134
    v_mfma_f32_32x32x16_bf16 v[148:163], a[132:135], a[92:95], v[148:163]
    v_exp_f32 v135, v135
    v_exp_f32 v136, v136
    v_exp_f32 v137, v137
    v_smfmac_f32_32x32x32_bf16 v[36:51], a[140:143], v[124:131], v232
    s_add_u32 s12, s4, s93
    s_addc_u32 s13, s5, 0
    v_exp_f32 v138, v138
    v_exp_f32 v139, v139
    v_exp_f32 v140, v140
    v_smfmac_f32_16x16x64_bf16 v[88:91], v[228:231], v[124:131], v232
    buffer_load_dwordx4 a[120:123], v3, s[8:11], 0 offen offset:2048 sc1
    v_exp_f32 v141, v141
    v_exp_f32 v142, v142
    v_smfmac_f32_32x32x32_bf16 v[52:67], a[136:139], v[132:139], v232
    v_exp_f32 v143, v143
    v_exp_f32 v144, v144
    v_exp_f32 v145, v145
    v_smfmac_f32_16x16x64_bf16 v[92:95], v[228:231], v[132:139], v232
    s_waitcnt vmcnt(10)
    v_exp_f32 v146, v146
    v_exp_f32 v147, v147
    v_mfma_f32_32x32x16_bf16 v[100:115], a[144:147], a[64:67], v[164:179]
    v_exp_f32 v148, v148
    v_exp_f32 v149, v149
    v_exp_f32 v150, v150
    v_mfma_f32_32x32x16_bf16 v[100:115], a[148:151], a[68:71], v[100:115]
    v_exp_f32 v151, v151
    v_exp_f32 v152, v152
    v_exp_f32 v153, v153
    v_smfmac_f32_32x32x32_bf16 v[52:67], a[140:143], v[140:147], v232
    v_exp_f32 v154, v154
    v_exp_f32 v155, v155
    v_exp_f32 v156, v156
    v_smfmac_f32_16x16x64_bf16 v[92:95], v[228:231], v[140:147], v232
    buffer_load_dwordx4 a[124:127], v3, s[8:11], 0 offen offset:3072 sc1
    v_exp_f32 v157, v157
    v_exp_f32 v158, v158
    v_smfmac_f32_32x32x32_bf16 v[68:83], a[136:139], v[148:155], v232
    v_exp_f32 v159, v159
    v_exp_f32 v160, v160
    v_exp_f32 v161, v161
    v_smfmac_f32_16x16x64_bf16 v[96:99], v[228:231], v[148:155], v232
    v_exp_f32 v162, v162
    v_exp_f32 v163, v163
    v_mfma_f32_32x32x16_bf16 v[116:131], a[144:147], a[72:75], v[180:195]
    s_add_u32 s68, s68, 16384
    v_exp_f32 v100, v100
    v_exp_f32 v101, v101
    v_exp_f32 v102, v102
    v_mfma_f32_32x32x16_bf16 v[116:131], a[148:151], a[76:79], v[116:131]
    s_and_b32 s68, s68, 0x3ffff
    v_exp_f32 v103, v103
    v_exp_f32 v104, v104
    v_exp_f32 v105, v105
    v_smfmac_f32_32x32x32_bf16 v[68:83], a[140:143], v[156:163], v232
    s_add_u32 s8, s62, s68
    s_addc_u32 s9, s63, 0
    v_exp_f32 v106, v106
    v_exp_f32 v107, v107
    v_exp_f32 v108, v108
    v_smfmac_f32_16x16x64_bf16 v[96:99], v[228:231], v[156:163], v232
    buffer_load_dwordx4 a[128:131], v3, s[8:11], 0 offen offset:0 sc1
    v_exp_f32 v109, v109
    v_exp_f32 v110, v110
    v_smfmac_f32_32x32x32_bf16 v[20:35], a[152:155], v[100:107], v232
    v_exp_f32 v111, v111
    v_exp_f32 v112, v112
    v_exp_f32 v113, v113
    v_smfmac_f32_16x16x64_bf16 v[84:87], v[228:231], v[100:107], v232
    buffer_load_dwordx4 v237, s[12:15], 0 offen lds
    v_exp_f32 v114, v114
    v_exp_f32 v115, v115
    v_mfma_f32_32x32x16_bf16 v[132:147], a[144:147], a[80:83], v[196:211]
    s_add_u32 s74, s74, 4096
    v_exp_f32 v116, v116
    v_exp_f32 v117, v117
    v_exp_f32 v118, v118
    v_mfma_f32_32x32x16_bf16 v[132:147], a[148:151], a[84:87], v[132:147]
    v_exp_f32 v119, v119
    v_exp_f32 v120, v120
    v_exp_f32 v121, v121
    v_smfmac_f32_32x32x32_bf16 v[20:35], a[156:159], v[108:115], v232
    s_cmp_eq_u32 s74, 126976
    s_cselect_b32 s74, 0, s74
    v_exp_f32 v122, v122
    v_exp_f32 v123, v123
    v_exp_f32 v124, v124
    v_smfmac_f32_16x16x64_bf16 v[84:87], v[228:231], v[108:115], v232
    buffer_load_dwordx4 a[132:135], v3, s[8:11], 0 offen offset:1024 sc1
    v_exp_f32 v125, v125
    v_exp_f32 v126, v126
    v_smfmac_f32_32x32x32_bf16 v[36:51], a[152:155], v[116:123], v232
    s_add_u32 m0, s70, s74
    s_lshl_b32 s93, s74, 4
    v_exp_f32 v127, v127
    v_exp_f32 v128, v128
    v_exp_f32 v129, v129
    v_smfmac_f32_16x16x64_bf16 v[88:91], v[228:231], v[116:123], v232
    v_exp_f32 v130, v130
    v_exp_f32 v131, v131
    v_mfma_f32_32x32x16_bf16 v[148:163], a[144:147], a[88:91], v[212:227]
    v_exp_f32 v132, v132
    v_exp_f32 v133, v133
    v_exp_f32 v134, v134
    v_mfma_f32_32x32x16_bf16 v[148:163], a[148:151], a[92:95], v[148:163]
    v_exp_f32 v135, v135
    v_exp_f32 v136, v136
    v_exp_f32 v137, v137
    v_smfmac_f32_32x32x32_bf16 v[36:51], a[156:159], v[124:131], v232
L_pad_6:
    s_cmp_eq_u32 s3, 1
    s_cbranch_scc1 L_walkret
    s_add_u32 s12, s4, s93
    s_addc_u32 s13, s5, 0
    v_exp_f32 v138, v138
    v_exp_f32 v139, v139
    v_exp_f32 v140, v140
    v_smfmac_f32_16x16x64_bf16 v[88:91], v[228:231], v[124:131], v232
    buffer_load_dwordx4 a[136:139], v3, s[8:11], 0 offen offset:2048 sc1
    v_exp_f32 v141, v141
    v_exp_f32 v142, v142
    v_smfmac_f32_32x32x32_bf16 v[52:67], a[152:155], v[132:139], v232
    v_exp_f32 v143, v143
    v_exp_f32 v144, v144
    v_exp_f32 v145, v145
    v_smfmac_f32_16x16x64_bf16 v[92:95], v[228:231], v[132:139], v232
    s_waitcnt vmcnt(10)
    v_exp_f32 v146, v146
    v_exp_f32 v147, v147
    v_mfma_f32_32x32x16_bf16 v[100:115], a[96:99], a[64:67], v[164:179]
    v_exp_f32 v148, v148
    v_exp_f32 v149, v149
    v_exp_f32 v150, v150
    v_mfma_f32_32x32x16_bf16 v[100:115], a[100:103], a[68:71], v[100:115]
    v_exp_f32 v151, v151
    v_exp_f32 v152, v152
    v_exp_f32 v153, v153
    v_smfmac_f32_32x32x32_bf16 v[52:67], a[156:159], v[140:147], v232
    v_exp_f32 v154, v154
    v_exp_f32 v155, v155
    v_exp_f32 v156, v156
    v_smfmac_f32_16x16x64_bf16 v[92:95], v[228:231], v[140:147], v232
    buffer_load_dwordx4 a[140:143], v3, s[8:11], 0 offen offset:3072 sc1
    v_exp_f32 v157, v157
    v_exp_f32 v158, v158
    v_smfmac_f32_32x32x32_bf16 v[68:83], a[152:155], v[148:155], v232
    v_exp_f32 v159, v159
    v_exp_f32 v160, v160
    v_exp_f32 v161, v161
    v_smfmac_f32_16x16x64_bf16 v[96:99], v[228:231], v[148:155], v232
    v_exp_f32 v162, v162
    v_exp_f32 v163, v163
    v_mfma_f32_32x32x16_bf16 v[116:131], a[96:99], a[72:75], v[180:195]
    v_exp_f32 v100, v100
    v_exp_f32 v101, v101
    v_exp_f32 v102, v102
    v_mfma_f32_32x32x16_bf16 v[116:131], a[100:103], a[76:79], v[116:131]
    v_exp_f32 v103, v103
    v_exp_f32 v104, v104
    v_exp_f32 v105, v105
    v_smfmac_f32_32x32x32_bf16 v[68:83], a[156:159], v[156:163], v232
    s_add_u32 s8, s8, 4096
    s_addc_u32 s9, s9, 0
    v_exp_f32 v106, v106
    v_exp_f32 v107, v107
    v_exp_f32 v108, v108
    v_smfmac_f32_16x16x64_bf16 v[96:99], v[228:231], v[156:163], v232
    buffer_load_dwordx4 a[144:147], v3, s[8:11], 0 offen offset:0 sc1
    v_exp_f32 v109, v109
    v_exp_f32 v110, v110
    v_smfmac_f32_32x32x32_bf16 v[20:35], a[104:107], v[100:107], v232
    v_exp_f32 v111, v111
    v_exp_f32 v112, v112
    v_exp_f32 v113, v113
    v_smfmac_f32_16x16x64_bf16 v[84:87], v[228:231], v[100:107], v232
    buffer_load_dwordx4 v237, s[12:15], 0 offen lds
    v_exp_f32 v114, v114
    v_exp_f32 v115, v115
    v_mfma_f32_32x32x16_bf16 v[132:147], a[96:99], a[80:83], v[196:211]
    s_add_u32 s74, s74, 4096
    v_exp_f32 v116, v116
    v_exp_f32 v117, v117
    v_exp_f32 v118, v118
    v_mfma_f32_32x32x16_bf16 v[132:147], a[100:103], a[84:87], v[132:147]
    v_exp_f32 v119, v119
    v_exp_f32 v120, v120
    v_exp_f32 v121, v121
    v_smfmac_f32_32x32x32_bf16 v[20:35], a[108:111], v[108:115], v232
    s_cmp_eq_u32 s74, 126976
    s_cselect_b32 s74, 0, s74
    v_exp_f32 v122, v122
    v_exp_f32 v123, v123
    v_exp_f32 v124, v124
    v_smfmac_f32_16x16x64_bf16 v[84:87], v[228:231], v[108:115], v232
    buffer_load_dwordx4 a[148:151], v3, s[8:11], 0 offen offset:1024 sc1
    v_exp_f32 v125, v125
    v_exp_f32 v126, v126
    v_smfmac_f32_32x32x32_bf16 v[36:51], a[104:107], v[116:123], v232
    s_add_u32 m0, s70, s74
    s_lshl_b32 s93, s74, 4
    v_exp_f32 v127, v127
    v_exp_f32 v128, v128
    v_exp_f32 v129, v129
    v_smfmac_f32_16x16x64_bf16 v[88:91], v[228:231], v[116:123], v232
    v_exp_f32 v130, v130
    v_exp_f32 v131, v131
    v_mfma_f32_32x32x16_bf16 v[148:163], a[96:99], a[88:91], v[212:227]
    v_exp_f32 v132, v132
    v_exp_f32 v133, v133
    v_exp_f32 v134, v134
    v_mfma_f32_32x32x16_bf16 v[148:163], a[100:103], a[92:95], v[148:163]
    v_exp_f32 v135, v135
    v_exp_f32 v136, v136
    v_exp_f32 v137, v137
    v_smfmac_f32_32x32x32_bf16 v[36:51], a[108:111], v[124:131], v232
    s_add_u32 s12, s4, s93
    s_addc_u32 s13, s5, 0
    v_exp_f32 v138, v138
    v_exp_f32 v139, v139
    v_exp_f32 v140, v140
    v_smfmac_f32_16x16x64_bf16 v[88:91], v[228:231], v[124:131], v232
    buffer_load_dwordx4 a[152:155], v3, s[8:11], 0 offen offset:2048 sc1
    v_exp_f32 v141, v141
    v_exp_f32 v142, v142
    v_smfmac_f32_32x32x32_bf16 v[52:67], a[104:107], v[132:139], v232
    buffer_load_dwordx4 v237, s[12:15], 0 offen lds
    v_exp_f32 v143, v143
    v_exp_f32 v144, v144
    v_exp_f32 v145, v145
    v_smfmac_f32_16x16x64_bf16 v[92:95], v[228:231], v[132:139], v232
    s_waitcnt vmcnt(10)
    v_exp_f32 v146, v146
    v_exp_f32 v147, v147
    v_mfma_f32_32x32x16_bf16 v[100:115], a[112:115], a[64:67], v[164:179]
    s_add_u32 s74, s74, 4096
    v_exp_f32 v148, v148
    v_exp_f32 v149, v149
    v_exp_f32 v150, v150
    v_mfma_f32_32x32x16_bf16 v[100:115], a[116:119], a[68:71], v[100:115]
    v_exp_f32 v151, v151
    v_exp_f32 v152, v152
    v_exp_f32 v153, v153
    v_smfmac_f32_32x32x32_bf16 v[52:67], a[108:111], v[140:147], v232
    s_cmp_eq_u32 s74, 126976
    s_cselect_b32 s74, 0, s74
    v_exp_f32 v154, v154
    v_exp_f32 v155, v155
    v_exp_f32 v156, v156
    v_smfmac_f32_16x16x64_bf16 v[92:95], v[228:231], v[140:147], v232
    buffer_load_dwordx4 a[156:159], v3, s[8:11], 0 offen offset:3072 sc1
    v_exp_f32 v157, v157
    v_exp_f32 v158, v158
    v_smfmac_f32_32x32x32_bf16 v[68:83], a[104:107], v[148:155], v232
    s_add_u32 m0, s70, s74
    s_lshl_b32 s93, s74, 4
    v_exp_f32 v159, v159
    v_exp_f32 v160, v160
    v_exp_f32 v161, v161
    v_smfmac_f32_16x16x64_bf16 v[96:99], v[228:231], v[148:155], v232
    s_add_u32 s12, s4, s93
    s_addc_u32 s13, s5, 0
    v_exp_f32 v162, v162
    v_exp_f32 v163, v163
    v_mfma_f32_32x32x16_bf16 v[116:131], a[112:115], a[72:75], v[180:195]
    s_add_u32 s68, s68, 16384
    v_exp_f32 v100, v100
    v_exp_f32 v101, v101
    v_exp_f32 v102, v102
    v_mfma_f32_32x32x16_bf16 v[116:131], a[116:119], a[76:79], v[116:131]
    s_and_b32 s68, s68, 0x3ffff
    v_exp_f32 v103, v103
    v_exp_f32 v104, v104
    v_exp_f32 v105, v105
    v_smfmac_f32_32x32x32_bf16 v[68:83], a[108:111], v[156:163], v232
    s_add_u32 s8, s62, s68
    s_addc_u32 s9, s63, 0
    v_exp_f32 v106, v106
    v_exp_f32 v107, v107
    v_exp_f32 v108, v108
    v_smfmac_f32_16x16x64_bf16 v[96:99], v[228:231], v[156:163], v232
    buffer_load_dwordx4 a[96:99], v3, s[8:11], 0 offen offset:0 sc1
    v_exp_f32 v109, v109
    v_exp_f32 v110, v110
    v_smfmac_f32_32x32x32_bf16 v[20:35], a[120:123], v[100:107], v232
    v_exp_f32 v111, v111
    v_exp_f32 v112, v112
    v_exp_f32 v113, v113
    v_smfmac_f32_16x16x64_bf16 v[84:87], v[228:231], v[100:107], v232
    buffer_load_dwordx4 v237, s[12:15], 0 offen lds
    v_exp_f32 v114, v114
    v_exp_f32 v115, v115
    v_mfma_f32_32x32x16_bf16 v[132:147], a[112:115], a[80:83], v[196:211]
    s_add_u32 s74, s74, 4096
    v_exp_f32 v116, v116
    v_exp_f32 v117, v117
    v_exp_f32 v118, v118
    v_mfma_f32_32x32x16_bf16 v[132:147], a[116:119], a[84:87], v[132:147]
    v_exp_f32 v119, v119
    v_exp_f32 v120, v120
    v_exp_f32 v121, v121
    v_smfmac_f32_32x32x32_bf16 v[20:35], a[124:127], v[108:115], v232
    s_cmp_eq_u32 s74, 126976
    s_cselect_b32 s74, 0, s74
    v_exp_f32 v122, v122
    v_exp_f32 v123, v123
    v_exp_f32 v124, v124
    v_smfmac_f32_16x16x64_bf16 v[84:87], v[228:231], v[108:115], v232
    buffer_load_dwordx4 a[100:103], v3, s[8:11], 0 offen offset:1024 sc1
    v_exp_f32 v125, v125
    v_exp_f32 v126, v126
    v_smfmac_f32_32x32x32_bf16 v[36:51], a[120:123], v[116:123], v232
    s_add_u32 m0, s70, s74
    s_lshl_b32 s93, s74, 4
    v_exp_f32 v127, v127
    v_exp_f32 v128, v128
    v_exp_f32 v129, v129
    v_smfmac_f32_16x16x64_bf16 v[88:91], v[228:231], v[116:123], v232
    v_exp_f32 v130, v130
    v_exp_f32 v131, v131
    v_mfma_f32_32x32x16_bf16 v[148:163], a[112:115], a[88:91], v[212:227]
    v_exp_f32 v132, v132
    v_exp_f32 v133, v133
    v_exp_f32 v134, v134
    v_mfma_f32_32x32x16_bf16 v[148:163], a[116:119], a[92:95], v[148:163]
    v_exp_f32 v135, v135
    v_exp_f32 v136, v136
    v_exp_f32 v137, v137
    v_smfmac_f32_32x32x32_bf16 v[36:51], a[124:127], v[124:131], v232
    s_add_u32 s12, s4, s93
    s_addc_u32 s13, s5, 0
    v_exp_f32 v138, v138
    v_exp_f32 v139, v139
    v_exp_f32 v140, v140
    v_smfmac_f32_16x16x64_bf16 v[88:91], v[228:231], v[124:131], v232
    buffer_load_dwordx4 a[104:107], v3, s[8:11], 0 offen offset:2048 sc1
    v_exp_f32 v141, v141
    v_exp_f32 v142, v142
    v_smfmac_f32_32x32x32_bf16 v[52:67], a[120:123], v[132:139], v232
    v_exp_f32 v143, v143
    v_exp_f32 v144, v144
    v_exp_f32 v145, v145
    v_smfmac_f32_16x16x64_bf16 v[92:95], v[228:231], v[132:139], v232
    s_waitcnt vmcnt(10)
    v_exp_f32 v146, v146
    v_exp_f32 v147, v147
    v_mfma_f32_32x32x16_bf16 v[100:115], a[128:131], a[64:67], v[164:179]
    v_exp_f32 v148, v148
    v_exp_f32 v149, v149
    v_exp_f32 v150, v150
    v_mfma_f32_32x32x16_bf16 v[100:115], a[132:135], a[68:71], v[100:115]
    v_exp_f32 v151, v151
    v_exp_f32 v152, v152
    v_exp_f32 v153, v153
    v_smfmac_f32_32x32x32_bf16 v[52:67], a[124:127], v[140:147], v232
    v_exp_f32 v154, v154
    v_exp_f32 v155, v155
    v_exp_f32 v156, v156
    v_smfmac_f32_16x16x64_bf16 v[92:95], v[228:231], v[140:147], v232
    buffer_load_dwordx4 a[108:111], v3, s[8:11], 0 offen offset:3072 sc1
    v_exp_f32 v157, v157
    v_exp_f32 v158, v158
    v_smfmac_f32_32x32x32_bf16 v[68:83], a[120:123], v[148:155], v232
    s_sub_u32 s46, s46, 1
    s_cmp_lg_u32 s46, 0
    v_exp_f32 v159, v159
    v_exp_f32 v160, v160
    v_exp_f32 v161, v161
    v_smfmac_f32_16x16x64_bf16 v[96:99], v[228:231], v[148:155], v232
    buffer_store_dword v19, v18, s[16:19], s99 offen offset:384 sc1
    v_exp_f32 v162, v162
    v_exp_f32 v163, v163
    v_bfrev_b32 v18, 1
    s_cbranch_scc1 L_attloop
    v_mfma_f32_32x32x16_bf16 v[116:131], a[128:131], a[72:75], v[180:195]
    v_exp_f32 v100, v100
    v_exp_f32 v101, v101
    v_exp_f32 v102, v102
    v_mfma_f32_32x32x16_bf16 v[116:131], a[132:135], a[76:79], v[116:131]
    v_exp_f32 v103, v103
    v_exp_f32 v104, v104
    v_exp_f32 v105, v105
    v_smfmac_f32_32x32x32_bf16 v[68:83], a[124:127], v[156:163], v232
    s_add_u32 s8, s8, 4096
    s_addc_u32 s9, s9, 0
    v_exp_f32 v106, v106
    v_exp_f32 v107, v107
    v_exp_f32 v108, v108
    v_smfmac_f32_16x16x64_bf16 v[96:99], v[228:231], v[156:163], v232
    buffer_load_dwordx4 a[112:115], v3, s[8:11], 0 offen offset:0 sc1
    v_exp_f32 v109, v109
    v_exp_f32 v110, v110
    v_smfmac_f32_32x32x32_bf16 v[20:35], a[136:139], v[100:107], v232
    buffer_load_dwordx4 v[244:247], v4, s[16:19], s98 offen offset:384 sc1
    v_exp_f32 v111, v111
    v_exp_f32 v112, v112
    v_exp_f32 v113, v113
    v_smfmac_f32_16x16x64_bf16 v[84:87], v[228:231], v[100:107], v232
    buffer_load_dwordx4 v237, s[12:15], 0 offen lds
    v_exp_f32 v114, v114
    v_exp_f32 v115, v115
    v_and_b32 v252, 0x1f0, v3
    v_lshlrev_b32 v252, 7, v252
    v_and_b32 v253, 0x7fff, v252
    v_mfma_f32_32x32x16_bf16 v[132:147], a[128:131], a[80:83], v[196:211]
    s_add_u32 s48, s86, 32768
    v_exp_f32 v116, v116
    v_exp_f32 v117, v117
    v_exp_f32 v118, v118
    v_mfma_f32_32x32x16_bf16 v[132:147], a[132:135], a[84:87], v[132:147]
    v_exp_f32 v119, v119
    v_exp_f32 v120, v120
    v_exp_f32 v121, v121
    v_smfmac_f32_32x32x32_bf16 v[20:35], a[140:143], v[108:115], v232
    s_add_u32 s12, s4, 2031616
    s_addc_u32 s13, s5, 0
    v_exp_f32 v122, v122
    v_exp_f32 v123, v123
    v_exp_f32 v124, v124
    v_smfmac_f32_16x16x64_bf16 v[84:87], v[228:231], v[108:115], v232
    buffer_load_dwordx4 a[116:119], v3, s[8:11], 0 offen offset:1024 sc1
    v_exp_f32 v125, v125
    v_exp_f32 v126, v126
    v_smfmac_f32_32x32x32_bf16 v[36:51], a[136:139], v[116:123], v232
    v_exp_f32 v127, v127
    v_exp_f32 v128, v128
    v_exp_f32 v129, v129
    v_smfmac_f32_16x16x64_bf16 v[88:91], v[228:231], v[116:123], v232
    buffer_load_dwordx4 a[160:163], v237, s[12:15], 0 offen
    v_exp_f32 v130, v130
    v_exp_f32 v131, v131
    v_mfma_f32_32x32x16_bf16 v[148:163], a[128:131], a[88:91], v[212:227]
    v_exp_f32 v132, v132
    v_exp_f32 v133, v133
    v_exp_f32 v134, v134
    v_mfma_f32_32x32x16_bf16 v[148:163], a[132:135], a[92:95], v[148:163]
    v_exp_f32 v135, v135
    v_exp_f32 v136, v136
    v_exp_f32 v137, v137
    v_smfmac_f32_32x32x32_bf16 v[36:51], a[140:143], v[124:131], v232
    v_exp_f32 v138, v138
    v_exp_f32 v139, v139
    v_exp_f32 v140, v140
    v_smfmac_f32_16x16x64_bf16 v[88:91], v[228:231], v[124:131], v232
    buffer_load_dwordx4 a[120:123], v3, s[8:11], 0 offen offset:2048 sc1
    v_exp_f32 v141, v141
    v_exp_f32 v142, v142
    v_smfmac_f32_32x32x32_bf16 v[52:67], a[136:139], v[132:139], v232
    v_exp_f32 v143, v143
    v_exp_f32 v144, v144
    v_exp_f32 v145, v145
    v_smfmac_f32_16x16x64_bf16 v[92:95], v[228:231], v[132:139], v232
    s_waitcnt vmcnt(12)
    v_exp_f32 v146, v146
    v_exp_f32 v147, v147
    v_mfma_f32_32x32x16_bf16 v[100:115], a[144:147], a[64:67], v[164:179]
    v_exp_f32 v148, v148
    v_exp_f32 v149, v149
    v_exp_f32 v150, v150
    v_mfma_f32_32x32x16_bf16 v[100:115], a[148:151], a[68:71], v[100:115]
    v_exp_f32 v151, v151
    v_exp_f32 v152, v152
    v_exp_f32 v153, v153
    v_smfmac_f32_32x32x32_bf16 v[52:67], a[140:143], v[140:147], v232
    v_exp_f32 v154, v154
    v_exp_f32 v155, v155
    v_exp_f32 v156, v156
    v_smfmac_f32_16x16x64_bf16 v[92:95], v[228:231], v[140:147], v232
    buffer_load_dwordx4 a[124:127], v3, s[8:11], 0 offen offset:3072 sc1
    v_exp_f32 v157, v157
    v_exp_f32 v158, v158
    v_smfmac_f32_32x32x32_bf16 v[68:83], a[136:139], v[148:155], v232
    v_exp_f32 v159, v159
    v_exp_f32 v160, v160
    v_exp_f32 v161, v161
    v_smfmac_f32_16x16x64_bf16 v[96:99], v[228:231], v[148:155], v232
    buffer_load_dwordx2 v[238:239], v252, s[16:19], s97 offen sc1
    v_exp_f32 v162, v162
    v_exp_f32 v163, v163
    v_mfma_f32_32x32x16_bf16 v[116:131], a[144:147], a[72:75], v[180:195]
    s_add_u32 s68, s68, 16384
    v_exp_f32 v100, v100
    v_exp_f32 v101, v101
    v_exp_f32 v102, v102
    v_mfma_f32_32x32x16_bf16 v[116:131], a[148:151], a[76:79], v[116:131]
    s_and_b32 s68, s68, 0x3ffff
    v_exp_f32 v103, v103
    v_exp_f32 v104, v104
    v_exp_f32 v105, v105
    v_smfmac_f32_32x32x32_bf16 v[68:83], a[140:143], v[156:163], v232
    s_add_u32 s8, s62, s68
    s_addc_u32 s9, s63, 0
    v_exp_f32 v106, v106
    v_exp_f32 v107, v107
    v_exp_f32 v108, v108
    v_smfmac_f32_16x16x64_bf16 v[96:99], v[228:231], v[156:163], v232
    buffer_load_dwordx4 a[128:131], v3, s[8:11], 0 offen offset:0 sc1
    v_exp_f32 v109, v109
    v_exp_f32 v110, v110
    v_smfmac_f32_32x32x32_bf16 v[20:35], a[152:155], v[100:107], v232
    v_exp_f32 v111, v111
    v_exp_f32 v112, v112
    v_exp_f32 v113, v113
    v_smfmac_f32_16x16x64_bf16 v[84:87], v[228:231], v[100:107], v232
    buffer_load_dword v9, v253, s[16:19], s86 offen sc1
    v_exp_f32 v114, v114
    v_exp_f32 v115, v115
    v_mfma_f32_32x32x16_bf16 v[132:147], a[144:147], a[80:83], v[196:211]
    s_lshl_b32 s47, s36, 13
    v_exp_f32 v116, v116
    v_exp_f32 v117, v117
    v_exp_f32 v118, v118
    v_mfma_f32_32x32x16_bf16 v[132:147], a[148:151], a[84:87], v[132:147]
    v_exp_f32 v119, v119
    v_exp_f32 v120, v120
    v_exp_f32 v121, v121
    v_smfmac_f32_32x32x32_bf16 v[20:35], a[156:159], v[108:115], v232
    v_exp_f32 v122, v122
    v_exp_f32 v123, v123
    v_exp_f32 v124, v124
    v_smfmac_f32_16x16x64_bf16 v[84:87], v[228:231], v[108:115], v232
    buffer_load_dwordx4 a[132:135], v3, s[8:11], 0 offen offset:1024 sc1
    v_exp_f32 v125, v125
    v_exp_f32 v126, v126
    v_smfmac_f32_32x32x32_bf16 v[36:51], a[152:155], v[116:123], v232
    v_exp_f32 v127, v127
    v_exp_f32 v128, v128
    v_exp_f32 v129, v129
    v_smfmac_f32_16x16x64_bf16 v[88:91], v[228:231], v[116:123], v232
    buffer_load_dword v10, v253, s[16:19], s48 offen sc1
    v_exp_f32 v130, v130
    v_exp_f32 v131, v131
    v_mfma_f32_32x32x16_bf16 v[148:163], a[144:147], a[88:91], v[212:227]
    s_add_u32 s47, s47, 131072
    v_exp_f32 v132, v132
    v_exp_f32 v133, v133
    v_exp_f32 v134, v134
    v_mfma_f32_32x32x16_bf16 v[148:163], a[148:151], a[92:95], v[148:163]
    v_exp_f32 v135, v135
    v_exp_f32 v136, v136
    v_exp_f32 v137, v137
    v_smfmac_f32_32x32x32_bf16 v[36:51], a[156:159], v[124:131], v232
    v_exp_f32 v138, v138
    v_exp_f32 v139, v139
    v_exp_f32 v140, v140
    v_smfmac_f32_16x16x64_bf16 v[88:91], v[228:231], v[124:131], v232
    buffer_load_dwordx4 a[136:139], v3, s[8:11], 0 offen offset:2048 sc1
    v_exp_f32 v141, v141
    v_exp_f32 v142, v142
    v_smfmac_f32_32x32x32_bf16 v[52:67], a[152:155], v[132:139], v232
    v_exp_f32 v143, v143
    v_exp_f32 v144, v144
    v_exp_f32 v145, v145
    v_smfmac_f32_16x16x64_bf16 v[92:95], v[228:231], v[132:139], v232
    s_waitcnt vmcnt(14)
    v_exp_f32 v146, v146
    v_exp_f32 v147, v147
    s_waitcnt vmcnt(11)
    v_and_b32 v244, v244, v245
    v_and_b32 v246, v246, v247
    v_and_b32 v244, v244, v246
    v_cmp_eq_u32 vcc, 1, v244
    v_mfma_f32_32x32x16_bf16 v[100:115], a[96:99], a[64:67], v[164:179]
    v_exp_f32 v148, v148
    v_exp_f32 v149, v149
    v_exp_f32 v150, v150
    v_mfma_f32_32x32x16_bf16 v[100:115], a[100:103], a[68:71], v[100:115]
    v_exp_f32 v151, v151
    v_exp_f32 v152, v152
    v_exp_f32 v153, v153
    v_smfmac_f32_32x32x32_bf16 v[52:67], a[156:159], v[140:147], v232
    s_cmp_eq_u64 vcc, exec
    s_cbranch_scc0 L_fc_slow
L_fc_ok:
    v_exp_f32 v154, v154
    v_exp_f32 v155, v155
    v_exp_f32 v156, v156
    v_smfmac_f32_16x16x64_bf16 v[92:95], v[228:231], v[140:147], v232
    buffer_load_dwordx4 a[140:143], v3, s[8:11], 0 offen offset:3072 sc1
    v_exp_f32 v157, v157
    v_exp_f32 v158, v158
    v_smfmac_f32_32x32x32_bf16 v[68:83], a[152:155], v[148:155], v232
    v_exp_f32 v159, v159
    v_exp_f32 v160, v160
    v_exp_f32 v161, v161
    v_smfmac_f32_16x16x64_bf16 v[96:99], v[228:231], v[148:155], v232
    v_exp_f32 v162, v162
    v_exp_f32 v163, v163
    v_mfma_f32_32x32x16_bf16 v[116:131], a[96:99], a[72:75], v[180:195]
    v_exp_f32 v100, v100
    v_exp_f32 v101, v101
    v_exp_f32 v102, v102
    v_mfma_f32_32x32x16_bf16 v[116:131], a[100:103], a[76:79], v[116:131]
    s_add_u32 m0, s47, 4096
    v_exp_f32 v103, v103
    v_exp_f32 v104, v104
    v_exp_f32 v105, v105
    v_smfmac_f32_32x32x32_bf16 v[68:83], a[156:159], v[156:163], v232
    s_add_u32 s8, s8, 4096
    s_addc_u32 s9, s9, 0
    v_exp_f32 v106, v106
    v_exp_f32 v107, v107
    v_exp_f32 v108, v108
    v_smfmac_f32_16x16x64_bf16 v[96:99], v[228:231], v[156:163], v232
    buffer_load_dwordx4 a[144:147], v3, s[8:11], 0 offen offset:0 sc1
    v_exp_f32 v109, v109
    v_exp_f32 v110, v110
    v_smfmac_f32_32x32x32_bf16 v[20:35], a[104:107], v[100:107], v232
    buffer_load_dwordx4 v5, s[16:19], s88 offen offset:0 sc1 lds
    v_exp_f32 v111, v111
    v_exp_f32 v112, v112
    v_exp_f32 v113, v113
    v_smfmac_f32_16x16x64_bf16 v[84:87], v[228:231], v[100:107], v232
    buffer_load_dwordx4 v5, s[16:19], s89 offen offset:1024 sc1 lds
    v_exp_f32 v114, v114
    v_exp_f32 v115, v115
    v_mfma_f32_32x32x16_bf16 v[132:147], a[96:99], a[80:83], v[196:211]
    v_exp_f32 v116, v116
    v_exp_f32 v117, v117
    v_exp_f32 v118, v118
    v_mfma_f32_32x32x16_bf16 v[132:147], a[100:103], a[84:87], v[132:147]
    v_exp_f32 v119, v119
    v_exp_f32 v120, v120
    v_exp_f32 v121, v121
    v_smfmac_f32_32x32x32_bf16 v[20:35], a[108:111], v[108:115], v232
    buffer_load_dwordx4 v5, s[16:19], s90 offen offset:2048 sc1 lds
    v_exp_f32 v122, v122
    v_exp_f32 v123, v123
    v_exp_f32 v124, v124
    v_smfmac_f32_16x16x64_bf16 v[84:87], v[228:231], v[108:115], v232
    buffer_load_dwordx4 a[148:151], v3, s[8:11], 0 offen offset:1024 sc1
    v_exp_f32 v125, v125
    v_exp_f32 v126, v126
    v_smfmac_f32_32x32x32_bf16 v[36:51], a[104:107], v[116:123], v232
    v_exp_f32 v127, v127
    v_exp_f32 v128, v128
    v_exp_f32 v129, v129
    v_smfmac_f32_16x16x64_bf16 v[88:91], v[228:231], v[116:123], v232
    buffer_load_dwordx4 v5, s[16:19], s91 offen offset:3072 sc1 lds
    v_exp_f32 v130, v130
    v_exp_f32 v131, v131
    v_mfma_f32_32x32x16_bf16 v[148:163], a[96:99], a[88:91], v[212:227]
    v_exp_f32 v132, v132
    v_exp_f32 v133, v133
    v_exp_f32 v134, v134
    v_mfma_f32_32x32x16_bf16 v[148:163], a[100:103], a[92:95], v[148:163]
    v_exp_f32 v135, v135
    v_exp_f32 v136, v136
    v_exp_f32 v137, v137
    v_smfmac_f32_32x32x32_bf16 v[36:51], a[108:111], v[124:131], v232
    v_exp_f32 v138, v138
    v_exp_f32 v139, v139
    v_exp_f32 v140, v140
    v_smfmac_f32_16x16x64_bf16 v[88:91], v[228:231], v[124:131], v232
    buffer_load_dwordx4 a[152:155], v3, s[8:11], 0 offen offset:2048 sc1
    v_exp_f32 v141, v141
    v_exp_f32 v142, v142
    v_smfmac_f32_32x32x32_bf16 v[52:67], a[104:107], v[132:139], v232
    v_exp_f32 v143, v143
    v_exp_f32 v144, v144
    v_exp_f32 v145, v145
    v_smfmac_f32_16x16x64_bf16 v[92:95], v[228:231], v[132:139], v232
    s_waitcnt vmcnt(14)
    v_exp_f32 v146, v146
    v_exp_f32 v147, v147
    v_mfma_f32_32x32x16_bf16 v[100:115], a[112:115], a[64:67], v[164:179]
    v_exp_f32 v148, v148
    v_exp_f32 v149, v149
    v_exp_f32 v150, v150
    v_mfma_f32_32x32x16_bf16 v[100:115], a[116:119], a[68:71], v[100:115]
    v_exp_f32 v151, v151
    v_exp_f32 v152, v152
    v_exp_f32 v153, v153
    v_smfmac_f32_32x32x32_bf16 v[52:67], a[108:111], v[140:147], v232
    v_exp_f32 v154, v154
    v_exp_f32 v155, v155
    v_exp_f32 v156, v156
    v_smfmac_f32_16x16x64_bf16 v[92:95], v[228:231], v[140:147], v232
    buffer_load_dwordx4 a[156:159], v3, s[8:11], 0 offen offset:3072 sc1
    v_exp_f32 v157, v157
    v_exp_f32 v158, v158
    v_smfmac_f32_32x32x32_bf16 v[68:83], a[104:107], v[148:155], v232
    v_exp_f32 v159, v159
    v_exp_f32 v160, v160
    v_exp_f32 v161, v161
    v_smfmac_f32_16x16x64_bf16 v[96:99], v[228:231], v[148:155], v232
    buffer_load_dword v12, v6, s[16:19], s92 offen sc1
    v_exp_f32 v162, v162
    v_exp_f32 v163, v163
    v_mfma_f32_32x32x16_bf16 v[116:131], a[112:115], a[72:75], v[180:195]
    v_exp_f32 v100, v100
    v_exp_f32 v101, v101
    v_exp_f32 v102, v102
    v_mfma_f32_32x32x16_bf16 v[116:131], a[116:119], a[76:79], v[116:131]
    v_exp_f32 v103, v103
    v_exp_f32 v104, v104
    v_exp_f32 v105, v105
    v_smfmac_f32_32x32x32_bf16 v[68:83], a[108:111], v[156:163], v232
    v_exp_f32 v106, v106
    v_exp_f32 v107, v107
    v_exp_f32 v108, v108
    v_smfmac_f32_16x16x64_bf16 v[96:99], v[228:231], v[156:163], v232
    v_exp_f32 v109, v109
    v_exp_f32 v110, v110
    v_smfmac_f32_32x32x32_bf16 v[20:35], a[120:123], v[100:107], v232
    v_exp_f32 v111, v111
    v_exp_f32 v112, v112
    v_exp_f32 v113, v113
    v_smfmac_f32_16x16x64_bf16 v[84:87], v[228:231], v[100:107], v232
    v_exp_f32 v114, v114
    v_exp_f32 v115, v115
    v_mfma_f32_32x32x16_bf16 v[132:147], a[112:115], a[80:83], v[196:211]
    s_add_u32 s48, s70, 126976
    v_exp_f32 v116, v116
    v_exp_f32 v117, v117
    v_exp_f32 v118, v118
    v_mfma_f32_32x32x16_bf16 v[132:147], a[116:119], a[84:87], v[132:147]
    v_exp_f32 v119, v119
    v_exp_f32 v120, v120
    v_exp_f32 v121, v121
    v_smfmac_f32_32x32x32_bf16 v[20:35], a[124:127], v[108:115], v232
    v_exp_f32 v122, v122
    v_exp_f32 v123, v123
    v_exp_f32 v124, v124
    v_smfmac_f32_16x16x64_bf16 v[84:87], v[228:231], v[108:115], v232
    v_exp_f32 v125, v125
    v_exp_f32 v126, v126
    v_smfmac_f32_32x32x32_bf16 v[36:51], a[120:123], v[116:123], v232
    v_exp_f32 v127, v127
    v_exp_f32 v128, v128
    v_exp_f32 v129, v129
    v_smfmac_f32_16x16x64_bf16 v[88:91], v[228:231], v[116:123], v232
    v_exp_f32 v130, v130
    v_exp_f32 v131, v131
    v_add_u32 v248, s47, v3
    v_xor_b32 v249, 16384, v248
    v_add_u32 v251, s48, v3
    v_xor_b32 v250, 2048, v251
    v_add_u32 v252, s47, v17
    v_mfma_f32_32x32x16_bf16 v[148:163], a[112:115], a[88:91], v[212:227]
    v_exp_f32 v132, v132
    v_exp_f32 v133, v133
    v_exp_f32 v134, v134
    v_mfma_f32_32x32x16_bf16 v[148:163], a[116:119], a[92:95], v[148:163]
    v_exp_f32 v135, v135
    v_exp_f32 v136, v136
    v_exp_f32 v137, v137
    v_smfmac_f32_32x32x32_bf16 v[36:51], a[124:127], v[124:131], v232
    v_exp_f32 v138, v138
    v_exp_f32 v139, v139
    v_exp_f32 v140, v140
    v_smfmac_f32_16x16x64_bf16 v[88:91], v[228:231], v[124:131], v232
    v_exp_f32 v141, v141
    v_exp_f32 v142, v142
    v_smfmac_f32_32x32x32_bf16 v[52:67], a[120:123], v[132:139], v232
    v_exp_f32 v143, v143
    v_exp_f32 v144, v144
    v_exp_f32 v145, v145
    v_smfmac_f32_16x16x64_bf16 v[92:95], v[228:231], v[132:139], v232
    s_waitcnt vmcnt(9)
    v_exp_f32 v146, v146
    v_exp_f32 v147, v147
    v_mfma_f32_32x32x16_bf16 v[100:115], a[128:131], a[64:67], v[164:179]
    s_mov_b32 s44, 0
    v_exp_f32 v148, v148
    v_exp_f32 v149, v149
    v_exp_f32 v150, v150
    v_mfma_f32_32x32x16_bf16 v[100:115], a[132:135], a[68:71], v[100:115]
    s_mov_b32 s42, 0
    v_exp_f32 v151, v151
    v_exp_f32 v152, v152
    v_exp_f32 v153, v153
    v_smfmac_f32_32x32x32_bf16 v[52:67], a[124:127], v[140:147], v232
    s_add_u32 s62, s16, s101
    s_addc_u32 s63, s17, 0
    v_exp_f32 v154, v154
    v_exp_f32 v155, v155
    v_exp_f32 v156, v156
    v_smfmac_f32_16x16x64_bf16 v[92:95], v[228:231], v[140:147], v232
    v_exp_f32 v157, v157
    v_exp_f32 v158, v158
    v_smfmac_f32_32x32x32_bf16 v[68:83], a[120:123], v[148:155], v232
    v_exp_f32 v159, v159
    v_exp_f32 v160, v160
    v_exp_f32 v161, v161
    v_smfmac_f32_16x16x64_bf16 v[96:99], v[228:231], v[148:155], v232
    s_waitcnt vmcnt(1)
    v_exp_f32 v162, v162
    v_exp_f32 v163, v163
    v_mfma_f32_32x32x16_bf16 v[116:131], a[144:147], a[64:67], v[164:179]
    v_exp_f32 v100, v100
    v_exp_f32 v101, v101
    v_exp_f32 v102, v102
    v_mfma_f32_32x32x16_bf16 v[116:131], a[148:151], a[68:71], v[116:131]
    v_exp_f32 v103, v103
    v_exp_f32 v104, v104
    v_exp_f32 v105, v105
    v_smfmac_f32_32x32x32_bf16 v[68:83], a[124:127], v[156:163], v232
    v_exp_f32 v106, v106
    v_exp_f32 v107, v107
    v_exp_f32 v108, v108
    v_smfmac_f32_16x16x64_bf16 v[96:99], v[228:231], v[156:163], v232
    ds_read_b128 a[208:211], v252 offset:4096
    v_exp_f32 v109, v109
    v_exp_f32 v110, v110
    v_smfmac_f32_32x32x32_bf16 v[20:35], a[136:139], v[100:107], v232
    v_exp_f32 v111, v111
    v_exp_f32 v112, v112
    v_exp_f32 v113, v113
    v_smfmac_f32_16x16x64_bf16 v[84:87], v[228:231], v[100:107], v232
    ds_read_b128 a[212:215], v252 offset:5120
    v_exp_f32 v114, v114
    v_exp_f32 v115, v115
    v_mfma_f32_32x32x16_bf16 v[132:147], a[128:131], a[72:75], v[180:195]
    v_exp_f32 v116, v116
    v_exp_f32 v117, v117
    v_exp_f32 v118, v118
    v_mfma_f32_32x32x16_bf16 v[132:147], a[132:135], a[76:79], v[132:147]
    v_exp_f32 v119, v119
    v_exp_f32 v120, v120
    v_exp_f32 v121, v121
    v_smfmac_f32_32x32x32_bf16 v[20:35], a[140:143], v[108:115], v232
    v_exp_f32 v122, v122
    v_exp_f32 v123, v123
    v_exp_f32 v124, v124
    v_smfmac_f32_16x16x64_bf16 v[84:87], v[228:231], v[108:115], v232
    ds_read_b128 a[216:219], v252 offset:6144
    v_exp_f32 v125, v125
    v_exp_f32 v126, v126
    v_smfmac_f32_32x32x32_bf16 v[20:35], a[152:155], v[116:123], v232
    v_exp_f32 v127, v127
    v_exp_f32 v128, v128
    v_exp_f32 v129, v129
    v_smfmac_f32_16x16x64_bf16 v[84:87], v[228:231], v[116:123], v232
    ds_read_b128 a[220:223], v252 offset:7168
    v_exp_f32 v130, v130
    v_exp_f32 v131, v131
    v_mfma_f32_32x32x16_bf16 v[148:163], a[144:147], a[72:75], v[180:195]
    v_exp_f32 v132, v132
    v_exp_f32 v133, v133
    v_exp_f32 v134, v134
    v_mfma_f32_32x32x16_bf16 v[148:163], a[148:151], a[76:79], v[148:163]
    v_exp_f32 v135, v135
    v_exp_f32 v136, v136
    v_exp_f32 v137, v137
    v_smfmac_f32_32x32x32_bf16 v[20:35], a[156:159], v[124:131], v232
    v_exp_f32 v138, v138
    v_exp_f32 v139, v139
    v_exp_f32 v140, v140
    v_smfmac_f32_16x16x64_bf16 v[84:87], v[228:231], v[124:131], v232
    s_nop 0
    v_exp_f32 v141, v141
    v_exp_f32 v142, v142
    v_smfmac_f32_32x32x32_bf16 v[36:51], a[136:139], v[132:139], v232
    v_exp_f32 v143, v143
    v_exp_f32 v144, v144
    v_exp_f32 v145, v145
    v_smfmac_f32_16x16x64_bf16 v[88:91], v[228:231], v[132:139], v232
    ds_write_b128 v248, v[20:23] offset:0
    v_exp_f32 v146, v146
    v_exp_f32 v147, v147
    v_mfma_f32_32x32x16_bf16 v[100:115], a[128:131], a[80:83], v[196:211]
    v_exp_f32 v148, v148
    v_exp_f32 v149, v149
    v_exp_f32 v150, v150
    v_mfma_f32_32x32x16_bf16 v[100:115], a[132:135], a[84:87], v[100:115]
    v_exp_f32 v151, v151
    v_exp_f32 v152, v152
    v_exp_f32 v153, v153
    v_smfmac_f32_32x32x32_bf16 v[36:51], a[140:143], v[140:147], v232
    v_exp_f32 v154, v154
    v_exp_f32 v155, v155
    v_exp_f32 v156, v156
    v_smfmac_f32_16x16x64_bf16 v[88:91], v[228:231], v[140:147], v232
    ds_write_b128 v248, v[24:27] offset:1024
    v_exp_f32 v157, v157
    v_exp_f32 v158, v158
    v_smfmac_f32_32x32x32_bf16 v[36:51], a[152:155], v[148:155], v232
    v_exp_f32 v159, v159
    v_exp_f32 v160, v160
    v_exp_f32 v161, v161
    v_smfmac_f32_16x16x64_bf16 v[88:91], v[228:231], v[148:155], v232
    ds_write_b128 v248, v[28:31] offset:2048
    v_exp_f32 v162, v162
    v_exp_f32 v163, v163
    v_mfma_f32_32x32x16_bf16 v[116:131], a[144:147], a[80:83], v[196:211]
    v_exp_f32 v100, v100
    v_exp_f32 v101, v101
    v_exp_f32 v102, v102
    v_mfma_f32_32x32x16_bf16 v[116:131], a[148:151], a[84:87], v[116:131]
    v_exp_f32 v103, v103
    v_exp_f32 v104, v104
    v_exp_f32 v105, v105
    v_smfmac_f32_32x32x32_bf16 v[36:51], a[156:159], v[156:163], v232
L_pad_7:
    s_cmp_eq_u32 s3, 1
    s_cbranch_scc1 L_walkret
    v_exp_f32 v106, v106
    v_exp_f32 v107, v107
    v_exp_f32 v108, v108
    v_smfmac_f32_16x16x64_bf16 v[88:91], v[228:231], v[156:163], v232
    ds_write_b128 v248, v[32:35] offset:3072
    v_exp_f32 v109, v109
    v_exp_f32 v110, v110
    v_smfmac_f32_32x32x32_bf16 v[52:67], a[136:139], v[100:107], v232
    v_exp_f32 v111, v111
    v_exp_f32 v112, v112
    v_exp_f32 v113, v113
    v_smfmac_f32_16x16x64_bf16 v[92:95], v[228:231], v[100:107], v232
    ds_write_b128 v248, v[36:39] offset:4096
    v_exp_f32 v114, v114
    v_exp_f32 v115, v115
    v_mov_b32 v85, v88
    v_mfma_f32_32x32x16_bf16 v[132:147], a[128:131], a[88:91], v[212:227]
    ds_write_b128 v248, v[40:43] offset:5120
    v_exp_f32 v116, v116
    v_exp_f32 v117, v117
    v_exp_f32 v118, v118
    v_mfma_f32_32x32x16_bf16 v[132:147], a[132:135], a[92:95], v[132:147]
    v_exp_f32 v119, v119
    v_exp_f32 v120, v120
    v_exp_f32 v121, v121
    v_smfmac_f32_32x32x32_bf16 v[52:67], a[140:143], v[108:115], v232
    ds_write_b128 v248, v[44:47] offset:6144
    v_exp_f32 v122, v122
    v_exp_f32 v123, v123
    v_exp_f32 v124, v124
    v_smfmac_f32_16x16x64_bf16 v[92:95], v[228:231], v[108:115], v232
    ds_write_b128 v248, v[48:51] offset:7168
    v_exp_f32 v125, v125
    v_exp_f32 v126, v126
    v_smfmac_f32_32x32x32_bf16 v[52:67], a[152:155], v[116:123], v232
    v_exp_f32 v127, v127
    v_exp_f32 v128, v128
    v_exp_f32 v129, v129
    v_smfmac_f32_16x16x64_bf16 v[92:95], v[228:231], v[116:123], v232
    ds_write_b64 v250, v[84:85]
    v_exp_f32 v130, v130
    v_exp_f32 v131, v131
    v_mfma_f32_32x32x16_bf16 v[148:163], a[144:147], a[88:91], v[212:227]
    s_waitcnt lgkmcnt(0)
    s_barrier
    v_exp_f32 v132, v132
    v_exp_f32 v133, v133
    v_exp_f32 v134, v134
    v_mfma_f32_32x32x16_bf16 v[148:163], a[148:151], a[92:95], v[148:163]
    ds_read_b64 v[84:85], v251
    v_exp_f32 v135, v135
    v_exp_f32 v136, v136
    v_exp_f32 v137, v137
    v_smfmac_f32_32x32x32_bf16 v[52:67], a[156:159], v[124:131], v232
    v_exp_f32 v138, v138
    v_exp_f32 v139, v139
    v_exp_f32 v140, v140
    v_smfmac_f32_16x16x64_bf16 v[92:95], v[228:231], v[124:131], v232
    ds_read_b128 v[20:23], v249 offset:0
    ds_read_b128 v[24:27], v249 offset:1024
    v_exp_f32 v141, v141
    v_exp_f32 v142, v142
    v_smfmac_f32_32x32x32_bf16 v[68:83], a[136:139], v[132:139], v232
    v_exp_f32 v143, v143
    v_exp_f32 v144, v144
    v_exp_f32 v145, v145
    v_smfmac_f32_16x16x64_bf16 v[96:99], v[228:231], v[132:139], v232
    ds_read_b128 v[28:31], v249 offset:2048
    ds_read_b128 v[32:35], v249 offset:3072
    v_exp_f32 v146, v146
    v_exp_f32 v147, v147
    v_exp_f32 v148, v148
    v_exp_f32 v149, v149
    v_exp_f32 v150, v150
    v_exp_f32 v151, v151
    v_exp_f32 v152, v152
    v_exp_f32 v153, v153
    v_smfmac_f32_32x32x32_bf16 v[68:83], a[140:143], v[140:147], v232
    buffer_load_dwordx2 v[244:245], v7, s[16:19], s83 offen offset:896 sc1
    v_exp_f32 v154, v154
    v_exp_f32 v155, v155
    v_exp_f32 v156, v156
    v_smfmac_f32_16x16x64_bf16 v[96:99], v[228:231], v[140:147], v232
    ds_read_b128 v[36:39], v249 offset:4096
    ds_read_b128 v[40:43], v249 offset:5120
    v_exp_f32 v157, v157
    v_exp_f32 v158, v158
    v_smfmac_f32_32x32x32_bf16 v[68:83], a[152:155], v[148:155], v232
    v_exp_f32 v159, v159
    v_exp_f32 v160, v160
    v_exp_f32 v161, v161
    v_smfmac_f32_16x16x64_bf16 v[96:99], v[228:231], v[148:155], v232
    ds_read_b128 v[44:47], v249 offset:6144
    ds_read_b128 v[48:51], v249 offset:7168
    v_exp_f32 v162, v162
    v_exp_f32 v163, v163
    s_waitcnt lgkmcnt(4)
    v_add_f32 v104, v92, v84
    v_rcp_f32 v100, v104
    v_smfmac_f32_32x32x32_bf16 v[68:83], a[156:159], v[156:163], v232
    s_add_u32 s48, s87, 65536
    v_mul_f32 v100, v100, v238
    v_mov_b32 v101, v100
    v_bfe_u32 v248, v1, 4, 1
    v_lshlrev_b32 v248, 10, v248
    v_permlane32_swap_b32 v100, v101
    v_lshrrev_b32 v253, 5, v1
    v_smfmac_f32_16x16x64_bf16 v[96:99], v[228:231], v[156:163], v232
    ds_write_b128 v251, a[160:163]
    v_mov_b32 v101, v100
    v_lshl_add_u32 v248, v253, 8, v248
    v_and_b32 v252, 15, v1
    v_lshl_add_u32 v248, v252, 4, v248
    v_pk_mul_f32 v[20:21], v[20:21], v[100:101]
    v_pk_fma_f32 v[20:21], v[52:53], v[100:101], v[20:21]
    v_cvt_pk_bf16_f32 v116, v20, v21
    v_pk_mul_f32 v[22:23], v[22:23], v[100:101]
    v_pk_fma_f32 v[22:23], v[54:55], v[100:101], v[22:23]
    v_cvt_pk_bf16_f32 v117, v22, v23
    v_pk_mul_f32 v[24:25], v[24:25], v[100:101]
    v_pk_fma_f32 v[24:25], v[56:57], v[100:101], v[24:25]
    v_cvt_pk_bf16_f32 v118, v24, v25
    v_pk_mul_f32 v[26:27], v[26:27], v[100:101]
    v_pk_fma_f32 v[26:27], v[58:59], v[100:101], v[26:27]
    v_cvt_pk_bf16_f32 v119, v26, v27
    buffer_store_dwordx4 v[116:119], v248, s[16:19], s87 offen offset:0 sc1
    v_add_f32 v105, v96, v85
    v_rcp_f32 v102, v105
    v_pk_mul_f32 v[28:29], v[28:29], v[100:101]
    v_pk_fma_f32 v[28:29], v[60:61], v[100:101], v[28:29]
    v_cvt_pk_bf16_f32 v120, v28, v29
    v_mul_f32 v102, v102, v239
    v_mov_b32 v103, v102
    v_pk_mul_f32 v[30:31], v[30:31], v[100:101]
    v_pk_fma_f32 v[30:31], v[62:63], v[100:101], v[30:31]
    v_cvt_pk_bf16_f32 v121, v30, v31
    v_permlane32_swap_b32 v102, v103
    v_pk_mul_f32 v[32:33], v[32:33], v[100:101]
    v_pk_fma_f32 v[32:33], v[64:65], v[100:101], v[32:33]
    v_cvt_pk_bf16_f32 v122, v32, v33
    v_mov_b32 v103, v102
    v_pk_mul_f32 v[34:35], v[34:35], v[100:101]
    v_pk_fma_f32 v[34:35], v[66:67], v[100:101], v[34:35]
    v_cvt_pk_bf16_f32 v123, v34, v35
    buffer_store_dwordx4 v[120:123], v248, s[16:19], s87 offen offset:512 sc1
    s_waitcnt lgkmcnt(0)
    v_pk_mul_f32 v[36:37], v[36:37], v[102:103]
    v_pk_fma_f32 v[36:37], v[68:69], v[102:103], v[36:37]
    v_cvt_pk_bf16_f32 v124, v36, v37
    v_pk_mul_f32 v[38:39], v[38:39], v[102:103]
    v_pk_fma_f32 v[38:39], v[70:71], v[102:103], v[38:39]
    v_cvt_pk_bf16_f32 v125, v38, v39
    v_pk_mul_f32 v[40:41], v[40:41], v[102:103]
    v_pk_fma_f32 v[40:41], v[72:73], v[102:103], v[40:41]
    v_cvt_pk_bf16_f32 v126, v40, v41
    v_pk_mul_f32 v[42:43], v[42:43], v[102:103]
    v_pk_fma_f32 v[42:43], v[74:75], v[102:103], v[42:43]
    v_cvt_pk_bf16_f32 v127, v42, v43
    buffer_store_dwordx4 v[124:127], v248, s[16:19], s48 offen offset:0 sc1
    v_pk_mul_f32 v[44:45], v[44:45], v[102:103]
    v_pk_fma_f32 v[44:45], v[76:77], v[102:103], v[44:45]
    v_cvt_pk_bf16_f32 v128, v44, v45
    v_pk_mul_f32 v[46:47], v[46:47], v[102:103]
    v_pk_fma_f32 v[46:47], v[78:79], v[102:103], v[46:47]
    v_cvt_pk_bf16_f32 v129, v46, v47
    v_pk_mul_f32 v[48:49], v[48:49], v[102:103]
    v_pk_fma_f32 v[48:49], v[80:81], v[102:103], v[48:49]
    v_cvt_pk_bf16_f32 v130, v48, v49
    v_pk_mul_f32 v[50:51], v[50:51], v[102:103]
    v_pk_fma_f32 v[50:51], v[82:83], v[102:103], v[50:51]
    v_cvt_pk_bf16_f32 v131, v50, v51
    buffer_store_dwordx4 v[128:131], v248, s[16:19], s48 offen offset:512 sc1
    v_min_f32 v107, v104, v105
    s_mov_b32 s48, 0x21800000
    v_cmp_lt_f32 s[76:77], s48, v107
    v_add_f32 v106, v104, v105
    v_dot2_f32_bf16 v106, v116, 0, v106
    v_dot2_f32_bf16 v106, v117, 0, v106
    v_dot2_f32_bf16 v106, v118, 0, v106
    v_dot2_f32_bf16 v106, v119, 0, v106
    v_dot2_f32_bf16 v106, v120, 0, v106
    v_dot2_f32_bf16 v106, v121, 0, v106
    v_dot2_f32_bf16 v106, v122, 0, v106
    v_dot2_f32_bf16 v106, v123, 0, v106
    v_dot2_f32_bf16 v106, v124, 0, v106
    v_dot2_f32_bf16 v106, v125, 0, v106
    v_dot2_f32_bf16 v106, v126, 0, v106
    v_dot2_f32_bf16 v106, v127, 0, v106
    v_dot2_f32_bf16 v106, v128, 0, v106
    v_dot2_f32_bf16 v106, v129, 0, v106
    v_dot2_f32_bf16 v106, v130, 0, v106
    v_dot2_f32_bf16 v106, v131, 0, v106
    s_mov_b32 s48, 0x67800000
    v_and_b32 v251, 3, v1
    v_lshlrev_b32 v251, 13, v251
    v_cmp_gt_f32 vcc, s48, v106
    v_add_u32 v251, 131072, v251
    s_and_b32 vcc_lo, vcc_lo, s76
    s_cmp_eq_u64 vcc, exec
    s_cselect_b32 s47, 0, 1
    s_andn2_b32 s47, s47, s71
    v_mov_b32 v106, s47
    ds_write_b32 v249, v106 offset:4096
    s_waitcnt lgkmcnt(0)
    s_barrier
    ds_read_b32 v106, v251 offset:4096
    s_waitcnt lgkmcnt(0)
    v_cmp_ne_u32 vcc, 0, v106
    s_nop 0
    s_cmp_lg_u64 vcc, 0
    s_cbranch_scc1 L_fallback
    v_bfrev_b32 v233, 1
    s_waitcnt vmcnt(4)
    v_and_b32 v244, v244, v245
    v_cmp_eq_u32 vcc, 1, v244
    s_nop 0
    s_or_b32 s44, s44, vcc_lo
    s_bfe_u32 s43, s44, 0x80008
    s_and_b32 s41, s44, s43
    v_cndmask_b32 v7, v7, v233, vcc
    s_bcnt1_i32_b32 s43, s41
    v_mov_b32 v18, v2
    s_cmp_lt_u32 s43, 2
    s_cbranch_scc1 L_late
L_p3:
    s_andn2_b32 s43, s41, s42
    s_cbranch_scc0 L_dry_185
L_wet_185:
    s_ff1_i32_b32 s56, s43
    s_bitset1_b32 s42, s56
    s_add_u32 s56, s56, s54
    s_and_b32 s56, s56, 7
    s_lshl_b32 s56, s56, 13
    s_add_u32 s8, s62, s56
    s_addc_u32 s9, s63, 0
    buffer_load_dwordx4 a[0:3], v3, s[8:11], 0 offen offset:0 sc1
    v_lshl_add_u32 v228, s56, 1, v240
    v_xor_b32 v229, 32, v228
    v_xor_b32 v230, 64, v228
    v_xor_b32 v231, 96, v228
    ds_read_b64_tr_b16 a[64:65], v228 offset:0
    ds_read_b64_tr_b16 a[66:67], v228 offset:1024
    ds_read_b64_tr_b16 a[80:81], v228 offset:4096
    ds_read_b64_tr_b16 a[82:83], v228 offset:5120
    ds_read_b64_tr_b16 a[68:69], v229 offset:0
    buffer_load_dwordx4 a[4:7], v3, s[8:11], 0 offen offset:1024 sc1
    ds_read_b64_tr_b16 a[70:71], v229 offset:1024
    ds_read_b64_tr_b16 a[84:85], v229 offset:4096
    ds_read_b64_tr_b16 a[86:87], v229 offset:5120
    ds_read_b64_tr_b16 a[72:73], v230 offset:0
    ds_read_b64_tr_b16 a[74:75], v230 offset:1024
    buffer_load_dwordx4 a[8:11], v3, s[8:11], 0 offen offset:2048 sc1
    ds_read_b64_tr_b16 a[88:89], v230 offset:4096
    ds_read_b64_tr_b16 a[90:91], v230 offset:5120
    ds_read_b64_tr_b16 a[76:77], v231 offset:0
    ds_read_b64_tr_b16 a[78:79], v231 offset:1024
    ds_read_b64_tr_b16 a[92:93], v231 offset:4096
    buffer_load_dwordx4 a[12:15], v3, s[8:11], 0 offen offset:3072 sc1
    ds_read_b64_tr_b16 a[94:95], v231 offset:5120
    s_add_u32 s8, s8, 4096
    s_addc_u32 s9, s9, 0
    buffer_load_dwordx4 a[16:19], v3, s[8:11], 0 offen offset:0 sc1
    ds_read_b64_tr_b16 a[96:97], v228 offset:8192
    ds_read_b64_tr_b16 a[98:99], v228 offset:9216
    ds_read_b64_tr_b16 a[112:113], v228 offset:12288
    ds_read_b64_tr_b16 a[114:115], v228 offset:13312
    ds_read_b64_tr_b16 a[100:101], v229 offset:8192
    buffer_load_dwordx4 a[20:23], v3, s[8:11], 0 offen offset:1024 sc1
    ds_read_b64_tr_b16 a[102:103], v229 offset:9216
    ds_read_b64_tr_b16 a[116:117], v229 offset:12288
    ds_read_b64_tr_b16 a[118:119], v229 offset:13312
    ds_read_b64_tr_b16 a[104:105], v230 offset:8192
    ds_read_b64_tr_b16 a[106:107], v230 offset:9216
    buffer_load_dwordx4 a[24:27], v3, s[8:11], 0 offen offset:2048 sc1
    ds_read_b64_tr_b16 a[120:121], v230 offset:12288
    ds_read_b64_tr_b16 a[122:123], v230 offset:13312
    ds_read_b64_tr_b16 a[108:109], v231 offset:8192
    ds_read_b64_tr_b16 a[110:111], v231 offset:9216
    ds_read_b64_tr_b16 a[124:125], v231 offset:12288
    buffer_load_dwordx4 a[28:31], v3, s[8:11], 0 offen offset:3072 sc1
    ds_read_b64_tr_b16 a[126:127], v231 offset:13312
    s_waitcnt vmcnt(8)
    buffer_store_dword v19, v18, s[16:19], s55 offen offset:896 sc1
    s_andn2_b32 s43, s41, s42
    s_cbranch_scc0 L_dry_188
L_wet_188:
    s_ff1_i32_b32 s57, s43
    s_bitset1_b32 s42, s57
    s_add_u32 s57, s57, s54
    s_and_b32 s57, s57, 7
    s_lshl_b32 s57, s57, 13
    s_add_u32 s8, s62, s57
    s_addc_u32 s9, s63, 0
    buffer_load_dwordx4 a[32:35], v3, s[8:11], 0 offen offset:0 sc1
    v_lshl_add_u32 v228, s57, 1, v240
    v_xor_b32 v229, 32, v228
    v_xor_b32 v230, 64, v228
    v_xor_b32 v231, 96, v228
    ds_read_b64_tr_b16 a[128:129], v228 offset:0
    ds_read_b64_tr_b16 a[130:131], v228 offset:1024
    ds_read_b64_tr_b16 a[144:145], v228 offset:4096
    ds_read_b64_tr_b16 a[146:147], v228 offset:5120
    ds_read_b64_tr_b16 a[132:133], v229 offset:0
    buffer_load_dwordx4 a[36:39], v3, s[8:11], 0 offen offset:1024 sc1
    ds_read_b64_tr_b16 a[134:135], v229 offset:1024
    ds_read_b64_tr_b16 a[148:149], v229 offset:4096
    ds_read_b64_tr_b16 a[150:151], v229 offset:5120
    ds_read_b64_tr_b16 a[136:137], v230 offset:0
    ds_read_b64_tr_b16 a[138:139], v230 offset:1024
    buffer_load_dwordx4 a[40:43], v3, s[8:11], 0 offen offset:2048 sc1
    ds_read_b64_tr_b16 a[152:153], v230 offset:4096
    ds_read_b64_tr_b16 a[154:155], v230 offset:5120
    ds_read_b64_tr_b16 a[140:141], v231 offset:0
    ds_read_b64_tr_b16 a[142:143], v231 offset:1024
    ds_read_b64_tr_b16 a[156:157], v231 offset:4096
    buffer_load_dwordx4 a[44:47], v3, s[8:11], 0 offen offset:3072 sc1
    ds_read_b64_tr_b16 a[158:159], v231 offset:5120
    s_add_u32 s8, s8, 4096
    s_addc_u32 s9, s9, 0
    buffer_load_dwordx4 a[48:51], v3, s[8:11], 0 offen offset:0 sc1
    ds_read_b64_tr_b16 a[224:225], v228 offset:8192
    ds_read_b64_tr_b16 a[226:227], v228 offset:9216
    ds_read_b64_tr_b16 a[240:241], v228 offset:12288
    ds_read_b64_tr_b16 a[242:243], v228 offset:13312
    ds_read_b64_tr_b16 a[228:229], v229 offset:8192
    buffer_load_dwordx4 a[52:55], v3, s[8:11], 0 offen offset:1024 sc1
    ds_read_b64_tr_b16 a[230:231], v229 offset:9216
    ds_read_b64_tr_b16 a[244:245], v229 offset:12288
    ds_read_b64_tr_b16 a[246:247], v229 offset:13312
    ds_read_b64_tr_b16 a[232:233], v230 offset:8192
    ds_read_b64_tr_b16 a[234:235], v230 offset:9216
    buffer_load_dwordx4 a[56:59], v3, s[8:11], 0 offen offset:2048 sc1
    ds_read_b64_tr_b16 a[248:249], v230 offset:12288
    ds_read_b64_tr_b16 a[250:251], v230 offset:13312
    ds_read_b64_tr_b16 a[236:237], v231 offset:8192
    ds_read_b64_tr_b16 a[238:239], v231 offset:9216
    ds_read_b64_tr_b16 a[252:253], v231 offset:12288
    buffer_load_dwordx4 a[60:63], v3, s[8:11], 0 offen offset:3072 sc1
    ds_read_b64_tr_b16 a[254:255], v231 offset:13312
    s_sub_u32 s47, 0, s81
    v_lshrrev_b32 v253, 4, v1
    v_lshlrev_b32 v250, 2, v253
    v_sub_f32 v9, 1.0, v9
    v_add_u32 v248, 0, v252
    v_xor_b32 v248, s47, v248
    v_add_u32 v248, s81, v248
    v_cvt_pk_bf16_f32 v9, v9, 0
    v_and_b32 v251, 1, v248
    v_lshlrev_b32 v251, 4, v251
    v_lshlrev_b32 v9, v251, v9
    v_bfe_u32 v248, v248, 1, 4
    v_sub_u32 v248, v248, v250
    v_cmp_eq_u32 s[88:89], 0, v248
    v_cmp_eq_u32 s[90:91], 1, v248
    v_cmp_eq_u32 s[92:93], 2, v248
    v_cmp_eq_u32 s[94:95], 3, v248
    v_cndmask_b32 v148, 0, v9, s[88:89]
    v_cndmask_b32 v149, 0, v9, s[90:91]
    v_cndmask_b32 v150, 0, v9, s[92:93]
    v_cndmask_b32 v151, 0, v9, s[94:95]
    v_sub_f32 v10, 1.0, v10
    v_add_u32 v248, 16, v252
    v_xor_b32 v248, s47, v248
    v_add_u32 v248, s81, v248
    v_cvt_pk_bf16_f32 v10, v10, 0
    v_and_b32 v251, 1, v248
    v_lshlrev_b32 v251, 4, v251
    v_lshlrev_b32 v10, v251, v10
    v_bfe_u32 v248, v248, 1, 4
    v_sub_u32 v248, v248, v250
    v_cmp_eq_u32 s[88:89], 0, v248
    v_cmp_eq_u32 s[90:91], 1, v248
    v_cmp_eq_u32 s[92:93], 2, v248
    v_cmp_eq_u32 s[94:95], 3, v248
    v_cndmask_b32 v152, 0, v10, s[88:89]
    v_cndmask_b32 v153, 0, v10, s[90:91]
    v_cndmask_b32 v154, 0, v10, s[92:93]
    v_cndmask_b32 v155, 0, v10, s[94:95]
    v_min_u32 v248, 1, v253
    v_add_u32 v248, -1, v248
    s_and_b32 s47, s47, 0xffff
    v_and_b32 v248, s47, v248
    v_mov_b32 v14, v12
    v_accvgpr_read_b32 v156, a208
    v_accvgpr_read_b32 v157, a212
    v_permlane32_swap_b32 v12, v14
    v_mov_b32 v13, v12
    v_mov_b32 v15, v14
    v_accvgpr_read_b32 v158, a216
    v_accvgpr_read_b32 v159, a220
    v_permlane16_swap_b32 v12, v13
    v_permlane16_swap_b32 v14, v15
    v_bfi_b32 v156, v248, v12, v156
    v_bfi_b32 v157, v248, v13, v157
    v_bfi_b32 v158, v248, v14, v158
    v_bfi_b32 v159, v248, v15, v159
    v_accvgpr_write_b32 a208, v156
    v_accvgpr_write_b32 a212, v157
    v_accvgpr_write_b32 a216, v158
    v_accvgpr_write_b32 a220, v159
    v_mfma_f32_16x16x32_bf16 v[164:167], a[208:211], v[148:151], 0
    v_mfma_f32_16x16x32_bf16 v[168:171], a[208:211], v[152:155], 0
    v_mfma_f32_16x16x32_bf16 v[172:175], a[212:215], v[148:151], 0
    v_mfma_f32_16x16x32_bf16 v[176:179], a[212:215], v[152:155], 0
    v_mfma_f32_16x16x32_bf16 v[180:183], a[216:219], v[148:151], 0
    v_mfma_f32_16x16x32_bf16 v[184:187], a[216:219], v[152:155], 0
    v_mfma_f32_16x16x32_bf16 v[188:191], a[220:223], v[148:151], 0
    v_mfma_f32_16x16x32_bf16 v[192:195], a[220:223], v[152:155], 0
    s_waitcnt vmcnt(13)
    s_waitcnt lgkmcnt(0)
    v_mfma_f32_16x16x32_bf16 v[164:167], a[64:67], a[0:3], v[164:167]
    s_andn2_b32 s43, s41, s42
    s_cbranch_scc0 L_dry_191
L_wet_191:
    v_mfma_f32_16x16x32_bf16 v[164:167], a[80:83], a[8:11], v[164:167]
    s_ff1_i32_b32 s58, s43
    s_bitset1_b32 s42, s58
    v_mfma_f32_16x16x32_bf16 v[168:171], a[80:83], a[12:15], v[168:171]
    s_add_u32 s58, s58, s54
    v_mfma_f32_16x16x32_bf16 v[168:171], a[64:67], a[4:7], v[168:171]
    s_and_b32 s58, s58, 7
    v_mfma_f32_16x16x32_bf16 v[176:179], a[68:71], a[4:7], v[176:179]
    s_lshl_b32 s58, s58, 13
    v_mfma_f32_16x16x32_bf16 v[176:179], a[84:87], a[12:15], v[176:179]
    s_add_u32 s8, s62, s58
    s_addc_u32 s9, s63, 0
    v_mfma_f32_16x16x32_bf16 v[172:175], a[84:87], a[8:11], v[172:175]
    buffer_load_dwordx4 a[176:179], v3, s[8:11], 0 offen offset:0 sc1
    v_lshl_add_u32 v228, s58, 1, v240
    v_xor_b32 v229, 32, v228
    v_xor_b32 v230, 64, v228
    v_xor_b32 v231, 96, v228
    v_mfma_f32_16x16x32_bf16 v[172:175], a[68:71], a[0:3], v[172:175]
    ds_read_b64_tr_b16 v[196:197], v228 offset:0
    v_mfma_f32_16x16x32_bf16 v[180:183], a[72:75], a[0:3], v[180:183]
    ds_read_b64_tr_b16 v[198:199], v228 offset:1024
    v_mfma_f32_16x16x32_bf16 v[180:183], a[88:91], a[8:11], v[180:183]
    buffer_load_dwordx4 a[180:183], v3, s[8:11], 0 offen offset:1024 sc1
    v_mfma_f32_16x16x32_bf16 v[184:187], a[88:91], a[12:15], v[184:187]
    ds_read_b64_tr_b16 v[212:213], v228 offset:4096
    ds_read_b64_tr_b16 v[214:215], v228 offset:5120
    v_mfma_f32_16x16x32_bf16 v[184:187], a[72:75], a[4:7], v[184:187]
    ds_read_b64_tr_b16 v[200:201], v229 offset:0
    v_mfma_f32_16x16x32_bf16 v[192:195], a[76:79], a[4:7], v[192:195]
    buffer_load_dwordx4 a[184:187], v3, s[8:11], 0 offen offset:2048 sc1
    v_mfma_f32_16x16x32_bf16 v[192:195], a[92:95], a[12:15], v[192:195]
    ds_read_b64_tr_b16 v[202:203], v229 offset:1024
    buffer_load_dwordx2 v[68:69], v7, s[16:19], s83 offen offset:896 sc1
    v_mfma_f32_16x16x32_bf16 v[188:191], a[92:95], a[8:11], v[188:191]
    ds_read_b64_tr_b16 v[216:217], v229 offset:4096
    s_waitcnt vmcnt(13)
    v_mfma_f32_16x16x32_bf16 v[188:191], a[76:79], a[0:3], v[188:191]
    buffer_load_dwordx4 a[188:191], v3, s[8:11], 0 offen offset:3072 sc1
    v_mfma_f32_16x16x32_bf16 v[164:167], a[96:99], a[16:19], v[164:167]
    ds_read_b64_tr_b16 v[218:219], v229 offset:5120
    v_mfma_f32_16x16x32_bf16 v[164:167], a[112:115], a[24:27], v[164:167]
    ds_read_b64_tr_b16 v[204:205], v230 offset:0
    v_mfma_f32_16x16x32_bf16 v[168:171], a[112:115], a[28:31], v[168:171]
    ds_read_b64_tr_b16 v[206:207], v230 offset:1024
    v_mfma_f32_16x16x32_bf16 v[168:171], a[96:99], a[20:23], v[168:171]
    ds_read_b64_tr_b16 v[220:221], v230 offset:4096
    v_mfma_f32_16x16x32_bf16 v[176:179], a[100:103], a[20:23], v[176:179]
    ds_read_b64_tr_b16 v[222:223], v230 offset:5120
    v_mfma_f32_16x16x32_bf16 v[176:179], a[116:119], a[28:31], v[176:179]
    ds_read_b64_tr_b16 v[208:209], v231 offset:0
    s_add_u32 s8, s8, 4096
    s_addc_u32 s9, s9, 0
    v_mfma_f32_16x16x32_bf16 v[172:175], a[116:119], a[24:27], v[172:175]
    buffer_load_dwordx4 a[192:195], v3, s[8:11], 0 offen offset:0 sc1
    v_mfma_f32_16x16x32_bf16 v[172:175], a[100:103], a[16:19], v[172:175]
    ds_read_b64_tr_b16 v[210:211], v231 offset:1024
    v_mfma_f32_16x16x32_bf16 v[180:183], a[104:107], a[16:19], v[180:183]
    ds_read_b64_tr_b16 v[224:225], v231 offset:4096
    v_mfma_f32_16x16x32_bf16 v[180:183], a[120:123], a[24:27], v[180:183]
    buffer_load_dwordx4 a[196:199], v3, s[8:11], 0 offen offset:1024 sc1
    v_mfma_f32_16x16x32_bf16 v[184:187], a[120:123], a[28:31], v[184:187]
    ds_read_b64_tr_b16 v[226:227], v231 offset:5120
    ds_read_b64_tr_b16 v[100:101], v228 offset:8192
    v_mfma_f32_16x16x32_bf16 v[184:187], a[104:107], a[20:23], v[184:187]
    ds_read_b64_tr_b16 v[102:103], v228 offset:9216
    v_mfma_f32_16x16x32_bf16 v[192:195], a[108:111], a[20:23], v[192:195]
    buffer_load_dwordx4 a[200:203], v3, s[8:11], 0 offen offset:2048 sc1
    v_mfma_f32_16x16x32_bf16 v[192:195], a[124:127], a[28:31], v[192:195]
    ds_read_b64_tr_b16 v[116:117], v228 offset:12288
    v_mfma_f32_16x16x32_bf16 v[188:191], a[124:127], a[24:27], v[188:191]
    ds_read_b64_tr_b16 v[118:119], v228 offset:13312
    s_waitcnt vmcnt(12)
    v_mfma_f32_16x16x32_bf16 v[188:191], a[108:111], a[16:19], v[188:191]
    buffer_load_dwordx4 a[204:207], v3, s[8:11], 0 offen offset:3072 sc1
    v_mfma_f32_16x16x32_bf16 v[164:167], a[128:131], a[32:35], v[164:167]
    ds_read_b64_tr_b16 v[104:105], v229 offset:8192
    s_andn2_b32 s43, s41, s42
    s_cbranch_scc0 L_dry_194
L_wet_194:
    v_mfma_f32_16x16x32_bf16 v[164:167], a[144:147], a[40:43], v[164:167]
    ds_read_b64_tr_b16 v[106:107], v229 offset:9216
    s_ff1_i32_b32 s59, s43
    s_bitset1_b32 s42, s59
    v_mfma_f32_16x16x32_bf16 v[168:171], a[144:147], a[44:47], v[168:171]
    ds_read_b64_tr_b16 v[120:121], v229 offset:12288
    s_add_u32 s59, s59, s54
    v_mfma_f32_16x16x32_bf16 v[168:171], a[128:131], a[36:39], v[168:171]
    ds_read_b64_tr_b16 v[122:123], v229 offset:13312
    s_and_b32 s59, s59, 7
    v_mfma_f32_16x16x32_bf16 v[176:179], a[132:135], a[36:39], v[176:179]
    ds_read_b64_tr_b16 v[108:109], v230 offset:8192
    s_lshl_b32 s59, s59, 13
    v_mfma_f32_16x16x32_bf16 v[176:179], a[148:151], a[44:47], v[176:179]
    ds_read_b64_tr_b16 v[110:111], v230 offset:9216
    s_add_u32 s8, s62, s59
    s_addc_u32 s9, s63, 0
    v_mfma_f32_16x16x32_bf16 v[172:175], a[148:151], a[40:43], v[172:175]
    buffer_load_dwordx4 a[0:3], v3, s[8:11], 0 offen offset:0 sc1
    v_mfma_f32_16x16x32_bf16 v[172:175], a[132:135], a[32:35], v[172:175]
    ds_read_b64_tr_b16 v[124:125], v230 offset:12288
    v_mfma_f32_16x16x32_bf16 v[180:183], a[136:139], a[32:35], v[180:183]
    ds_read_b64_tr_b16 v[126:127], v230 offset:13312
    v_mfma_f32_16x16x32_bf16 v[180:183], a[152:155], a[40:43], v[180:183]
    buffer_load_dwordx4 a[4:7], v3, s[8:11], 0 offen offset:1024 sc1
    v_mfma_f32_16x16x32_bf16 v[184:187], a[152:155], a[44:47], v[184:187]
    ds_read_b64_tr_b16 v[112:113], v231 offset:8192
    ds_read_b64_tr_b16 v[114:115], v231 offset:9216
    v_mfma_f32_16x16x32_bf16 v[184:187], a[136:139], a[36:39], v[184:187]
    ds_read_b64_tr_b16 v[128:129], v231 offset:12288
    v_mfma_f32_16x16x32_bf16 v[192:195], a[140:143], a[36:39], v[192:195]
    buffer_load_dwordx4 a[8:11], v3, s[8:11], 0 offen offset:2048 sc1
    v_mfma_f32_16x16x32_bf16 v[192:195], a[156:159], a[44:47], v[192:195]
    ds_read_b64_tr_b16 v[130:131], v231 offset:13312
    v_lshl_add_u32 v228, s59, 1, v240
    v_xor_b32 v229, 32, v228
    v_xor_b32 v230, 64, v228
    v_xor_b32 v231, 96, v228
    v_mfma_f32_16x16x32_bf16 v[188:191], a[156:159], a[40:43], v[188:191]
    ds_read_b64_tr_b16 a[64:65], v228 offset:0
    s_waitcnt vmcnt(12)
    v_mfma_f32_16x16x32_bf16 v[188:191], a[140:143], a[32:35], v[188:191]
    buffer_load_dwordx4 a[12:15], v3, s[8:11], 0 offen offset:3072 sc1
    v_mfma_f32_16x16x32_bf16 v[164:167], a[224:227], a[48:51], v[164:167]
    ds_read_b64_tr_b16 a[66:67], v228 offset:1024
    v_mfma_f32_16x16x32_bf16 v[164:167], a[240:243], a[56:59], v[164:167]
    ds_read_b64_tr_b16 a[80:81], v228 offset:4096
    v_mfma_f32_16x16x32_bf16 v[168:171], a[240:243], a[60:63], v[168:171]
    ds_read_b64_tr_b16 a[82:83], v228 offset:5120
    v_mfma_f32_16x16x32_bf16 v[168:171], a[224:227], a[52:55], v[168:171]
    ds_read_b64_tr_b16 a[68:69], v229 offset:0
    v_mfma_f32_16x16x32_bf16 v[176:179], a[228:231], a[52:55], v[176:179]
    ds_read_b64_tr_b16 a[70:71], v229 offset:1024
    v_mfma_f32_16x16x32_bf16 v[176:179], a[244:247], a[60:63], v[176:179]
    ds_read_b64_tr_b16 a[84:85], v229 offset:4096
    s_add_u32 s8, s8, 4096
    s_addc_u32 s9, s9, 0
    v_mfma_f32_16x16x32_bf16 v[172:175], a[244:247], a[56:59], v[172:175]
    buffer_load_dwordx4 a[16:19], v3, s[8:11], 0 offen offset:0 sc1
    v_mfma_f32_16x16x32_bf16 v[172:175], a[228:231], a[48:51], v[172:175]
    ds_read_b64_tr_b16 a[86:87], v229 offset:5120
    v_mfma_f32_16x16x32_bf16 v[180:183], a[232:235], a[48:51], v[180:183]
    ds_read_b64_tr_b16 a[72:73], v230 offset:0
    v_mfma_f32_16x16x32_bf16 v[180:183], a[248:251], a[56:59], v[180:183]
    buffer_load_dwordx4 a[20:23], v3, s[8:11], 0 offen offset:1024 sc1
    v_mfma_f32_16x16x32_bf16 v[184:187], a[248:251], a[60:63], v[184:187]
    ds_read_b64_tr_b16 a[74:75], v230 offset:1024
    ds_read_b64_tr_b16 a[88:89], v230 offset:4096
    v_mfma_f32_16x16x32_bf16 v[184:187], a[232:235], a[52:55], v[184:187]
    ds_read_b64_tr_b16 a[90:91], v230 offset:5120
    v_mfma_f32_16x16x32_bf16 v[192:195], a[236:239], a[52:55], v[192:195]
    buffer_load_dwordx4 a[24:27], v3, s[8:11], 0 offen offset:2048 sc1
    v_mfma_f32_16x16x32_bf16 v[192:195], a[252:255], a[60:63], v[192:195]
    ds_read_b64_tr_b16 a[76:77], v231 offset:0
    v_mfma_f32_16x16x32_bf16 v[188:191], a[252:255], a[56:59], v[188:191]
    ds_read_b64_tr_b16 a[78:79], v231 offset:1024
    s_waitcnt vmcnt(11)
    v_mfma_f32_16x16x32_bf16 v[188:191], a[236:239], a[48:51], v[188:191]
    buffer_load_dwordx4 a[28:31], v3, s[8:11], 0 offen offset:3072 sc1
    v_and_b32 v68, v68, v69
    v_cmp_eq_u32 vcc, 1, v68
    s_waitcnt lgkmcnt(2)
    v_mfma_f32_16x16x32_bf16 v[164:167], v[196:199], a[176:179], v[164:167]
    ds_read_b64_tr_b16 a[92:93], v231 offset:4096
    s_or_b32 s44, s44, vcc_lo
    s_bfe_u32 s43, s44, 0x80008
    s_and_b32 s41, s44, s43
    v_cndmask_b32 v7, v7, v233, vcc
    s_andn2_b32 s43, s41, s42
    s_cbranch_scc0 L_dry_197
L_wet_197:
    v_mfma_f32_16x16x32_bf16 v[164:167], v[212:215], a[184:187], v[164:167]
    ds_read_b64_tr_b16 a[94:95], v231 offset:5120
    s_ff1_i32_b32 s56, s43
    s_bitset1_b32 s42, s56
    v_mfma_f32_16x16x32_bf16 v[168:171], v[212:215], a[188:191], v[168:171]
    ds_read_b64_tr_b16 a[96:97], v228 offset:8192
    s_add_u32 s56, s56, s54
    v_mfma_f32_16x16x32_bf16 v[168:171], v[196:199], a[180:183], v[168:171]
    ds_read_b64_tr_b16 a[98:99], v228 offset:9216
    s_and_b32 s56, s56, 7
    v_mfma_f32_16x16x32_bf16 v[176:179], v[200:203], a[180:183], v[176:179]
    ds_read_b64_tr_b16 a[112:113], v228 offset:12288
    s_lshl_b32 s56, s56, 13
    v_mfma_f32_16x16x32_bf16 v[176:179], v[216:219], a[188:191], v[176:179]
    ds_read_b64_tr_b16 a[114:115], v228 offset:13312
    s_add_u32 s8, s62, s56
    s_addc_u32 s9, s63, 0
    v_mfma_f32_16x16x32_bf16 v[172:175], v[216:219], a[184:187], v[172:175]
    buffer_load_dwordx4 a[32:35], v3, s[8:11], 0 offen offset:0 sc1
    v_mfma_f32_16x16x32_bf16 v[172:175], v[200:203], a[176:179], v[172:175]
    ds_read_b64_tr_b16 a[100:101], v229 offset:8192
    v_mfma_f32_16x16x32_bf16 v[180:183], v[204:207], a[176:179], v[180:183]
    ds_read_b64_tr_b16 a[102:103], v229 offset:9216
    v_mfma_f32_16x16x32_bf16 v[180:183], v[220:223], a[184:187], v[180:183]
    buffer_load_dwordx4 a[36:39], v3, s[8:11], 0 offen offset:1024 sc1
    v_mfma_f32_16x16x32_bf16 v[184:187], v[220:223], a[188:191], v[184:187]
    ds_read_b64_tr_b16 a[116:117], v229 offset:12288
    ds_read_b64_tr_b16 a[118:119], v229 offset:13312
    v_mfma_f32_16x16x32_bf16 v[184:187], v[204:207], a[180:183], v[184:187]
    ds_read_b64_tr_b16 a[104:105], v230 offset:8192
    v_mfma_f32_16x16x32_bf16 v[192:195], v[208:211], a[180:183], v[192:195]
    buffer_load_dwordx4 a[40:43], v3, s[8:11], 0 offen offset:2048 sc1
    v_mfma_f32_16x16x32_bf16 v[192:195], v[224:227], a[188:191], v[192:195]
L_pad_8:
    s_cmp_eq_u32 s3, 1
    s_cbranch_scc1 L_walkret
    ds_read_b64_tr_b16 a[106:107], v230 offset:9216
    buffer_load_dwordx2 v[76:77], v7, s[16:19], s83 offen offset:896 sc1
    v_mfma_f32_16x16x32_bf16 v[188:191], v[224:227], a[184:187], v[188:191]
    ds_read_b64_tr_b16 a[120:121], v230 offset:12288
    s_waitcnt vmcnt(12)
    v_mfma_f32_16x16x32_bf16 v[188:191], v[208:211], a[176:179], v[188:191]
    buffer_load_dwordx4 a[44:47], v3, s[8:11], 0 offen offset:3072 sc1
    v_mfma_f32_16x16x32_bf16 v[164:167], v[100:103], a[192:195], v[164:167]
    ds_read_b64_tr_b16 a[122:123], v230 offset:13312
    v_mfma_f32_16x16x32_bf16 v[164:167], v[116:119], a[200:203], v[164:167]
    ds_read_b64_tr_b16 a[108:109], v231 offset:8192
    v_mfma_f32_16x16x32_bf16 v[168:171], v[116:119], a[204:207], v[168:171]
    ds_read_b64_tr_b16 a[110:111], v231 offset:9216
    v_mfma_f32_16x16x32_bf16 v[168:171], v[100:103], a[196:199], v[168:171]
    ds_read_b64_tr_b16 a[124:125], v231 offset:12288
    v_mfma_f32_16x16x32_bf16 v[176:179], v[104:107], a[196:199], v[176:179]
    ds_read_b64_tr_b16 a[126:127], v231 offset:13312
    v_lshl_add_u32 v228, s56, 1, v240
    v_xor_b32 v229, 32, v228
    v_xor_b32 v230, 64, v228
    v_xor_b32 v231, 96, v228
    v_mfma_f32_16x16x32_bf16 v[176:179], v[120:123], a[204:207], v[176:179]
    ds_read_b64_tr_b16 a[128:129], v228 offset:0
    s_add_u32 s8, s8, 4096
    s_addc_u32 s9, s9, 0
    v_mfma_f32_16x16x32_bf16 v[172:175], v[120:123], a[200:203], v[172:175]
    buffer_load_dwordx4 a[48:51], v3, s[8:11], 0 offen offset:0 sc1
    v_mfma_f32_16x16x32_bf16 v[172:175], v[104:107], a[192:195], v[172:175]
    ds_read_b64_tr_b16 a[130:131], v228 offset:1024
    v_mfma_f32_16x16x32_bf16 v[180:183], v[108:111], a[192:195], v[180:183]
    ds_read_b64_tr_b16 a[144:145], v228 offset:4096
    v_mfma_f32_16x16x32_bf16 v[180:183], v[124:127], a[200:203], v[180:183]
    buffer_load_dwordx4 a[52:55], v3, s[8:11], 0 offen offset:1024 sc1
    v_mfma_f32_16x16x32_bf16 v[184:187], v[124:127], a[204:207], v[184:187]
    ds_read_b64_tr_b16 a[146:147], v228 offset:5120
    ds_read_b64_tr_b16 a[132:133], v229 offset:0
    v_mfma_f32_16x16x32_bf16 v[184:187], v[108:111], a[196:199], v[184:187]
    ds_read_b64_tr_b16 a[134:135], v229 offset:1024
    v_mfma_f32_16x16x32_bf16 v[192:195], v[112:115], a[196:199], v[192:195]
    buffer_load_dwordx4 a[56:59], v3, s[8:11], 0 offen offset:2048 sc1
    v_mfma_f32_16x16x32_bf16 v[192:195], v[128:131], a[204:207], v[192:195]
    ds_read_b64_tr_b16 a[148:149], v229 offset:4096
    v_mfma_f32_16x16x32_bf16 v[188:191], v[128:131], a[200:203], v[188:191]
    ds_read_b64_tr_b16 a[150:151], v229 offset:5120
    s_waitcnt vmcnt(12)
    v_mfma_f32_16x16x32_bf16 v[188:191], v[112:115], a[192:195], v[188:191]
    buffer_load_dwordx4 a[60:63], v3, s[8:11], 0 offen offset:3072 sc1
    v_mfma_f32_16x16x32_bf16 v[164:167], a[64:67], a[0:3], v[164:167]
    ds_read_b64_tr_b16 a[136:137], v230 offset:0
    s_andn2_b32 s43, s41, s42
    s_cbranch_scc0 L_dry_200
L_wet_200:
    v_mfma_f32_16x16x32_bf16 v[164:167], a[80:83], a[8:11], v[164:167]
    ds_read_b64_tr_b16 a[138:139], v230 offset:1024
    s_ff1_i32_b32 s57, s43
    s_bitset1_b32 s42, s57
    v_mfma_f32_16x16x32_bf16 v[168:171], a[80:83], a[12:15], v[168:171]
    ds_read_b64_tr_b16 a[152:153], v230 offset:4096
    s_add_u32 s57, s57, s54
    v_mfma_f32_16x16x32_bf16 v[168:171], a[64:67], a[4:7], v[168:171]
    ds_read_b64_tr_b16 a[154:155], v230 offset:5120
    s_and_b32 s57, s57, 7
    v_mfma_f32_16x16x32_bf16 v[176:179], a[68:71], a[4:7], v[176:179]
    ds_read_b64_tr_b16 a[140:141], v231 offset:0
    s_lshl_b32 s57, s57, 13
    v_mfma_f32_16x16x32_bf16 v[176:179], a[84:87], a[12:15], v[176:179]
    ds_read_b64_tr_b16 a[142:143], v231 offset:1024
    s_add_u32 s8, s62, s57
    s_addc_u32 s9, s63, 0
    v_mfma_f32_16x16x32_bf16 v[172:175], a[84:87], a[8:11], v[172:175]
    buffer_load_dwordx4 a[176:179], v3, s[8:11], 0 offen offset:0 sc1
    v_mfma_f32_16x16x32_bf16 v[172:175], a[68:71], a[0:3], v[172:175]
    ds_read_b64_tr_b16 a[156:157], v231 offset:4096
    v_mfma_f32_16x16x32_bf16 v[180:183], a[72:75], a[0:3], v[180:183]
    ds_read_b64_tr_b16 a[158:159], v231 offset:5120
    v_mfma_f32_16x16x32_bf16 v[180:183], a[88:91], a[8:11], v[180:183]
    buffer_load_dwordx4 a[180:183], v3, s[8:11], 0 offen offset:1024 sc1
    v_mfma_f32_16x16x32_bf16 v[184:187], a[88:91], a[12:15], v[184:187]
    ds_read_b64_tr_b16 a[224:225], v228 offset:8192
    ds_read_b64_tr_b16 a[226:227], v228 offset:9216
    v_mfma_f32_16x16x32_bf16 v[184:187], a[72:75], a[4:7], v[184:187]
    ds_read_b64_tr_b16 a[240:241], v228 offset:12288
    s_waitcnt lgkmcnt(3)
    v_mfma_f32_16x16x32_bf16 v[192:195], a[76:79], a[4:7], v[192:195]
    buffer_load_dwordx4 a[184:187], v3, s[8:11], 0 offen offset:2048 sc1
    v_mfma_f32_16x16x32_bf16 v[192:195], a[92:95], a[12:15], v[192:195]
    ds_read_b64_tr_b16 a[242:243], v228 offset:13312
    v_mfma_f32_16x16x32_bf16 v[188:191], a[92:95], a[8:11], v[188:191]
    ds_read_b64_tr_b16 a[228:229], v229 offset:8192
    s_waitcnt vmcnt(12)
    v_mfma_f32_16x16x32_bf16 v[188:191], a[76:79], a[0:3], v[188:191]
    buffer_load_dwordx4 a[188:191], v3, s[8:11], 0 offen offset:3072 sc1
    v_mfma_f32_16x16x32_bf16 v[164:167], a[96:99], a[16:19], v[164:167]
    ds_read_b64_tr_b16 a[230:231], v229 offset:9216
    v_mfma_f32_16x16x32_bf16 v[164:167], a[112:115], a[24:27], v[164:167]
    ds_read_b64_tr_b16 a[244:245], v229 offset:12288
    v_mfma_f32_16x16x32_bf16 v[168:171], a[112:115], a[28:31], v[168:171]
    ds_read_b64_tr_b16 a[246:247], v229 offset:13312
    v_mfma_f32_16x16x32_bf16 v[168:171], a[96:99], a[20:23], v[168:171]
    ds_read_b64_tr_b16 a[232:233], v230 offset:8192
    v_mfma_f32_16x16x32_bf16 v[176:179], a[100:103], a[20:23], v[176:179]
    ds_read_b64_tr_b16 a[234:235], v230 offset:9216
    v_mfma_f32_16x16x32_bf16 v[176:179], a[116:119], a[28:31], v[176:179]
    ds_read_b64_tr_b16 a[248:249], v230 offset:12288
    s_add_u32 s8, s8, 4096
    s_addc_u32 s9, s9, 0
    v_mfma_f32_16x16x32_bf16 v[172:175], a[116:119], a[24:27], v[172:175]
    buffer_load_dwordx4 a[192:195], v3, s[8:11], 0 offen offset:0 sc1
    v_mfma_f32_16x16x32_bf16 v[172:175], a[100:103], a[16:19], v[172:175]
    ds_read_b64_tr_b16 a[250:251], v230 offset:13312
    v_mfma_f32_16x16x32_bf16 v[180:183], a[104:107], a[16:19], v[180:183]
    ds_read_b64_tr_b16 a[236:237], v231 offset:8192
    v_mfma_f32_16x16x32_bf16 v[180:183], a[120:123], a[24:27], v[180:183]
    buffer_load_dwordx4 a[196:199], v3, s[8:11], 0 offen offset:1024 sc1
    v_mfma_f32_16x16x32_bf16 v[184:187], a[120:123], a[28:31], v[184:187]
    ds_read_b64_tr_b16 a[238:239], v231 offset:9216
    ds_read_b64_tr_b16 a[252:253], v231 offset:12288
    v_mfma_f32_16x16x32_bf16 v[184:187], a[104:107], a[20:23], v[184:187]
    ds_read_b64_tr_b16 a[254:255], v231 offset:13312
    v_mfma_f32_16x16x32_bf16 v[192:195], a[108:111], a[20:23], v[192:195]
    buffer_load_dwordx4 a[200:203], v3, s[8:11], 0 offen offset:2048 sc1
    v_lshl_add_u32 v228, s57, 1, v240
    v_xor_b32 v229, 32, v228
    v_xor_b32 v230, 64, v228
    v_xor_b32 v231, 96, v228
    v_mfma_f32_16x16x32_bf16 v[192:195], a[124:127], a[28:31], v[192:195]
    ds_read_b64_tr_b16 v[196:197], v228 offset:0
    v_mfma_f32_16x16x32_bf16 v[188:191], a[124:127], a[24:27], v[188:191]
    ds_read_b64_tr_b16 v[198:199], v228 offset:1024
    s_waitcnt vmcnt(11)
    v_mfma_f32_16x16x32_bf16 v[188:191], a[108:111], a[16:19], v[188:191]
    buffer_load_dwordx4 a[204:207], v3, s[8:11], 0 offen offset:3072 sc1
    v_and_b32 v76, v76, v77
    v_cmp_eq_u32 vcc, 1, v76
    v_mfma_f32_16x16x32_bf16 v[164:167], a[128:131], a[32:35], v[164:167]
    ds_read_b64_tr_b16 v[212:213], v228 offset:4096
    s_or_b32 s44, s44, vcc_lo
    s_bfe_u32 s43, s44, 0x80008
    s_and_b32 s41, s44, s43
    v_cndmask_b32 v7, v7, v233, vcc
    s_andn2_b32 s43, s41, s42
    s_cbranch_scc0 L_dry_203
L_wet_203:
    v_mfma_f32_16x16x32_bf16 v[164:167], a[144:147], a[40:43], v[164:167]
    ds_read_b64_tr_b16 v[214:215], v228 offset:5120
    s_ff1_i32_b32 s58, s43
    s_bitset1_b32 s42, s58
    v_mfma_f32_16x16x32_bf16 v[168:171], a[144:147], a[44:47], v[168:171]
    ds_read_b64_tr_b16 v[200:201], v229 offset:0
    s_add_u32 s58, s58, s54
    v_mfma_f32_16x16x32_bf16 v[168:171], a[128:131], a[36:39], v[168:171]
    ds_read_b64_tr_b16 v[202:203], v229 offset:1024
    s_and_b32 s58, s58, 7
    v_mfma_f32_16x16x32_bf16 v[176:179], a[132:135], a[36:39], v[176:179]
    ds_read_b64_tr_b16 v[216:217], v229 offset:4096
    s_lshl_b32 s58, s58, 13
    v_mfma_f32_16x16x32_bf16 v[176:179], a[148:151], a[44:47], v[176:179]
    ds_read_b64_tr_b16 v[218:219], v229 offset:5120
    s_add_u32 s8, s62, s58
    s_addc_u32 s9, s63, 0
    v_mfma_f32_16x16x32_bf16 v[172:175], a[148:151], a[40:43], v[172:175]
    buffer_load_dwordx4 a[0:3], v3, s[8:11], 0 offen offset:0 sc1
    v_mfma_f32_16x16x32_bf16 v[172:175], a[132:135], a[32:35], v[172:175]
    ds_read_b64_tr_b16 v[204:205], v230 offset:0
    v_mfma_f32_16x16x32_bf16 v[180:183], a[136:139], a[32:35], v[180:183]
    ds_read_b64_tr_b16 v[206:207], v230 offset:1024
    v_mfma_f32_16x16x32_bf16 v[180:183], a[152:155], a[40:43], v[180:183]
    buffer_load_dwordx4 a[4:7], v3, s[8:11], 0 offen offset:1024 sc1
    v_mfma_f32_16x16x32_bf16 v[184:187], a[152:155], a[44:47], v[184:187]
    ds_read_b64_tr_b16 v[220:221], v230 offset:4096
    ds_read_b64_tr_b16 v[222:223], v230 offset:5120
    v_mfma_f32_16x16x32_bf16 v[184:187], a[136:139], a[36:39], v[184:187]
    ds_read_b64_tr_b16 v[208:209], v231 offset:0
    v_mfma_f32_16x16x32_bf16 v[192:195], a[140:143], a[36:39], v[192:195]
    buffer_load_dwordx4 a[8:11], v3, s[8:11], 0 offen offset:2048 sc1
    v_mfma_f32_16x16x32_bf16 v[192:195], a[156:159], a[44:47], v[192:195]
    ds_read_b64_tr_b16 v[210:211], v231 offset:1024
    v_mfma_f32_16x16x32_bf16 v[188:191], a[156:159], a[40:43], v[188:191]
    ds_read_b64_tr_b16 v[224:225], v231 offset:4096
    s_waitcnt vmcnt(11)
    v_mfma_f32_16x16x32_bf16 v[188:191], a[140:143], a[32:35], v[188:191]
    buffer_load_dwordx4 a[12:15], v3, s[8:11], 0 offen offset:3072 sc1
    s_waitcnt lgkmcnt(2)
    v_mfma_f32_16x16x32_bf16 v[164:167], a[224:227], a[48:51], v[164:167]
    ds_read_b64_tr_b16 v[226:227], v231 offset:5120
    v_mfma_f32_16x16x32_bf16 v[164:167], a[240:243], a[56:59], v[164:167]
    ds_read_b64_tr_b16 v[100:101], v228 offset:8192
    v_mfma_f32_16x16x32_bf16 v[168:171], a[240:243], a[60:63], v[168:171]
    ds_read_b64_tr_b16 v[102:103], v228 offset:9216
    v_mfma_f32_16x16x32_bf16 v[168:171], a[224:227], a[52:55], v[168:171]
    ds_read_b64_tr_b16 v[116:117], v228 offset:12288
    v_mfma_f32_16x16x32_bf16 v[176:179], a[228:231], a[52:55], v[176:179]
    ds_read_b64_tr_b16 v[118:119], v228 offset:13312
    v_mfma_f32_16x16x32_bf16 v[176:179], a[244:247], a[60:63], v[176:179]
    ds_read_b64_tr_b16 v[104:105], v229 offset:8192
    s_add_u32 s8, s8, 4096
    s_addc_u32 s9, s9, 0
    v_mfma_f32_16x16x32_bf16 v[172:175], a[244:247], a[56:59], v[172:175]
    buffer_load_dwordx4 a[16:19], v3, s[8:11], 0 offen offset:0 sc1
    v_mfma_f32_16x16x32_bf16 v[172:175], a[228:231], a[48:51], v[172:175]
    ds_read_b64_tr_b16 v[106:107], v229 offset:9216
    v_mfma_f32_16x16x32_bf16 v[180:183], a[232:235], a[48:51], v[180:183]
    ds_read_b64_tr_b16 v[120:121], v229 offset:12288
    v_mfma_f32_16x16x32_bf16 v[180:183], a[248:251], a[56:59], v[180:183]
    buffer_load_dwordx4 a[20:23], v3, s[8:11], 0 offen offset:1024 sc1
    v_mfma_f32_16x16x32_bf16 v[184:187], a[248:251], a[60:63], v[184:187]
    ds_read_b64_tr_b16 v[122:123], v229 offset:13312
    ds_read_b64_tr_b16 v[108:109], v230 offset:8192
    v_mfma_f32_16x16x32_bf16 v[184:187], a[232:235], a[52:55], v[184:187]
    ds_read_b64_tr_b16 v[110:111], v230 offset:9216
    v_mfma_f32_16x16x32_bf16 v[192:195], a[236:239], a[52:55], v[192:195]
    buffer_load_dwordx4 a[24:27], v3, s[8:11], 0 offen offset:2048 sc1
    v_mfma_f32_16x16x32_bf16 v[192:195], a[252:255], a[60:63], v[192:195]
    ds_read_b64_tr_b16 v[124:125], v230 offset:12288
    v_mfma_f32_16x16x32_bf16 v[188:191], a[252:255], a[56:59], v[188:191]
    ds_read_b64_tr_b16 v[126:127], v230 offset:13312
    s_waitcnt vmcnt(11)
    v_mfma_f32_16x16x32_bf16 v[188:191], a[236:239], a[48:51], v[188:191]
    buffer_load_dwordx4 a[28:31], v3, s[8:11], 0 offen offset:3072 sc1
    v_mfma_f32_16x16x32_bf16 v[164:167], v[196:199], a[176:179], v[164:167]
    ds_read_b64_tr_b16 v[112:113], v231 offset:8192
    s_andn2_b32 s43, s41, s42
    s_cbranch_scc0 L_dry_206
L_wet_206:
    v_mfma_f32_16x16x32_bf16 v[164:167], v[212:215], a[184:187], v[164:167]
    ds_read_b64_tr_b16 v[114:115], v231 offset:9216
    s_ff1_i32_b32 s59, s43
    s_bitset1_b32 s42, s59
    v_mfma_f32_16x16x32_bf16 v[168:171], v[212:215], a[188:191], v[168:171]
    ds_read_b64_tr_b16 v[128:129], v231 offset:12288
    s_add_u32 s59, s59, s54
    v_mfma_f32_16x16x32_bf16 v[168:171], v[196:199], a[180:183], v[168:171]
    ds_read_b64_tr_b16 v[130:131], v231 offset:13312
    v_lshl_add_u32 v228, s58, 1, v240
    v_xor_b32 v229, 32, v228
    v_xor_b32 v230, 64, v228
    v_xor_b32 v231, 96, v228
    s_and_b32 s59, s59, 7
    v_mfma_f32_16x16x32_bf16 v[176:179], v[200:203], a[180:183], v[176:179]
    ds_read_b64_tr_b16 a[64:65], v228 offset:0
    s_lshl_b32 s59, s59, 13
    v_mfma_f32_16x16x32_bf16 v[176:179], v[216:219], a[188:191], v[176:179]
    ds_read_b64_tr_b16 a[66:67], v228 offset:1024
    s_add_u32 s8, s62, s59
    s_addc_u32 s9, s63, 0
    v_mfma_f32_16x16x32_bf16 v[172:175], v[216:219], a[184:187], v[172:175]
    buffer_load_dwordx4 a[32:35], v3, s[8:11], 0 offen offset:0 sc1
    v_mfma_f32_16x16x32_bf16 v[172:175], v[200:203], a[176:179], v[172:175]
    ds_read_b64_tr_b16 a[80:81], v228 offset:4096
    v_mfma_f32_16x16x32_bf16 v[180:183], v[204:207], a[176:179], v[180:183]
    ds_read_b64_tr_b16 a[82:83], v228 offset:5120
    v_mfma_f32_16x16x32_bf16 v[180:183], v[220:223], a[184:187], v[180:183]
    buffer_load_dwordx4 a[36:39], v3, s[8:11], 0 offen offset:1024 sc1
    v_mfma_f32_16x16x32_bf16 v[184:187], v[220:223], a[188:191], v[184:187]
    ds_read_b64_tr_b16 a[68:69], v229 offset:0
    ds_read_b64_tr_b16 a[70:71], v229 offset:1024
    v_mfma_f32_16x16x32_bf16 v[184:187], v[204:207], a[180:183], v[184:187]
    ds_read_b64_tr_b16 a[84:85], v229 offset:4096
    s_waitcnt lgkmcnt(3)
    v_mfma_f32_16x16x32_bf16 v[192:195], v[208:211], a[180:183], v[192:195]
    buffer_load_dwordx4 a[40:43], v3, s[8:11], 0 offen offset:2048 sc1
    v_mfma_f32_16x16x32_bf16 v[192:195], v[224:227], a[188:191], v[192:195]
    ds_read_b64_tr_b16 a[86:87], v229 offset:5120
    v_mfma_f32_16x16x32_bf16 v[188:191], v[224:227], a[184:187], v[188:191]
    ds_read_b64_tr_b16 a[72:73], v230 offset:0
    s_waitcnt vmcnt(11)
    v_mfma_f32_16x16x32_bf16 v[188:191], v[208:211], a[176:179], v[188:191]
    buffer_load_dwordx4 a[44:47], v3, s[8:11], 0 offen offset:3072 sc1
    v_mfma_f32_16x16x32_bf16 v[164:167], v[100:103], a[192:195], v[164:167]
    ds_read_b64_tr_b16 a[74:75], v230 offset:1024
    v_mfma_f32_16x16x32_bf16 v[164:167], v[116:119], a[200:203], v[164:167]
    ds_read_b64_tr_b16 a[88:89], v230 offset:4096
    v_mfma_f32_16x16x32_bf16 v[168:171], v[116:119], a[204:207], v[168:171]
    ds_read_b64_tr_b16 a[90:91], v230 offset:5120
    v_mfma_f32_16x16x32_bf16 v[168:171], v[100:103], a[196:199], v[168:171]
    ds_read_b64_tr_b16 a[76:77], v231 offset:0
    v_mfma_f32_16x16x32_bf16 v[176:179], v[104:107], a[196:199], v[176:179]
    ds_read_b64_tr_b16 a[78:79], v231 offset:1024
    v_mfma_f32_16x16x32_bf16 v[176:179], v[120:123], a[204:207], v[176:179]
    ds_read_b64_tr_b16 a[92:93], v231 offset:4096
    s_add_u32 s8, s8, 4096
    s_addc_u32 s9, s9, 0
    v_mfma_f32_16x16x32_bf16 v[172:175], v[120:123], a[200:203], v[172:175]
    buffer_load_dwordx4 a[48:51], v3, s[8:11], 0 offen offset:0 sc1
    v_mfma_f32_16x16x32_bf16 v[172:175], v[104:107], a[192:195], v[172:175]
    ds_read_b64_tr_b16 a[94:95], v231 offset:5120
    v_mfma_f32_16x16x32_bf16 v[180:183], v[108:111], a[192:195], v[180:183]
    ds_read_b64_tr_b16 a[96:97], v228 offset:8192
    v_mfma_f32_16x16x32_bf16 v[180:183], v[124:127], a[200:203], v[180:183]
    buffer_load_dwordx4 a[52:55], v3, s[8:11], 0 offen offset:1024 sc1
    v_mfma_f32_16x16x32_bf16 v[184:187], v[124:127], a[204:207], v[184:187]
    ds_read_b64_tr_b16 a[98:99], v228 offset:9216
    ds_read_b64_tr_b16 a[112:113], v228 offset:12288
    v_mfma_f32_16x16x32_bf16 v[184:187], v[108:111], a[196:199], v[184:187]
    ds_read_b64_tr_b16 a[114:115], v228 offset:13312
    v_mfma_f32_16x16x32_bf16 v[192:195], v[112:115], a[196:199], v[192:195]
    buffer_load_dwordx4 a[56:59], v3, s[8:11], 0 offen offset:2048 sc1
    v_mfma_f32_16x16x32_bf16 v[192:195], v[128:131], a[204:207], v[192:195]
    ds_read_b64_tr_b16 a[100:101], v229 offset:8192
    v_mfma_f32_16x16x32_bf16 v[188:191], v[128:131], a[200:203], v[188:191]
    ds_read_b64_tr_b16 a[102:103], v229 offset:9216
    s_waitcnt vmcnt(11)
    v_mfma_f32_16x16x32_bf16 v[188:191], v[112:115], a[192:195], v[188:191]
    buffer_load_dwordx4 a[60:63], v3, s[8:11], 0 offen offset:3072 sc1
    v_mfma_f32_16x16x32_bf16 v[164:167], a[64:67], a[0:3], v[164:167]
    ds_read_b64_tr_b16 a[116:117], v229 offset:12288
    s_sub_u32 s50, s101, 8388608
    v_mfma_f32_16x16x32_bf16 v[164:167], a[80:83], a[8:11], v[164:167]
    ds_read_b64_tr_b16 a[118:119], v229 offset:13312
    s_add_u32 s50, s50, s100
    v_mfma_f32_16x16x32_bf16 v[168:171], a[80:83], a[12:15], v[168:171]
    ds_read_b64_tr_b16 a[104:105], v230 offset:8192
    v_sub_u32 v26, v249, v3
    v_mfma_f32_16x16x32_bf16 v[168:171], a[64:67], a[4:7], v[168:171]
    ds_read_b64_tr_b16 a[106:107], v230 offset:9216
    s_waitcnt lgkmcnt(4)
    v_mfma_f32_16x16x32_bf16 v[176:179], a[68:71], a[4:7], v[176:179]
    ds_read_b64_tr_b16 a[120:121], v230 offset:12288
    v_lshl_add_u32 v20, v252, 7, v26
    v_mfma_f32_16x16x32_bf16 v[176:179], a[84:87], a[12:15], v[176:179]
    ds_read_b64_tr_b16 a[122:123], v230 offset:13312
    v_and_b32 v21, 1, v253
    v_mfma_f32_16x16x32_bf16 v[172:175], a[84:87], a[8:11], v[172:175]
    ds_read_b64_tr_b16 a[108:109], v231 offset:8192
    v_lshl_add_u32 v20, v21, 3, v20
    v_mfma_f32_16x16x32_bf16 v[172:175], a[68:71], a[0:3], v[172:175]
    ds_read_b64_tr_b16 a[110:111], v231 offset:9216
    v_lshrrev_b32 v21, 5, v1
    v_mfma_f32_16x16x32_bf16 v[180:183], a[72:75], a[0:3], v[180:183]
    ds_read_b64_tr_b16 a[124:125], v231 offset:12288
    v_and_b32 v22, 7, v1
    v_mfma_f32_16x16x32_bf16 v[180:183], a[88:91], a[8:11], v[180:183]
    ds_read_b64_tr_b16 a[126:127], v231 offset:13312
    v_lshl_add_u32 v228, s59, 1, v240
    v_xor_b32 v229, 32, v228
    v_xor_b32 v230, 64, v228
    v_xor_b32 v231, 96, v228
    v_mfma_f32_16x16x32_bf16 v[184:187], a[88:91], a[12:15], v[184:187]
    ds_read_b64_tr_b16 a[128:129], v228 offset:0
    v_xor_b32 v21, v21, v22
    v_mfma_f32_16x16x32_bf16 v[184:187], a[72:75], a[4:7], v[184:187]
    ds_read_b64_tr_b16 a[130:131], v228 offset:1024
    v_lshl_add_u32 v20, v21, 4, v20
    v_mfma_f32_16x16x32_bf16 v[192:195], a[76:79], a[4:7], v[192:195]
    ds_read_b64_tr_b16 a[144:145], v228 offset:4096
    v_lshrrev_b32 v25, 3, v1
    v_mfma_f32_16x16x32_bf16 v[192:195], a[92:95], a[12:15], v[192:195]
    ds_read_b64_tr_b16 a[146:147], v228 offset:5120
    v_xor_b32 v21, v25, v1
    v_mfma_f32_16x16x32_bf16 v[188:191], a[92:95], a[8:11], v[188:191]
    ds_read_b64_tr_b16 a[132:133], v229 offset:0
    s_waitcnt vmcnt(8)
    v_mfma_f32_16x16x32_bf16 v[188:191], a[76:79], a[0:3], v[188:191]
    ds_read_b64_tr_b16 a[134:135], v229 offset:1024
    v_lshl_add_u32 v24, v21, 4, v26
    v_mfma_f32_16x16x32_bf16 v[164:167], a[96:99], a[16:19], v[164:167]
    ds_read_b64_tr_b16 a[148:149], v229 offset:4096
    v_lshlrev_b32 v22, 4, v22
    v_mfma_f32_16x16x32_bf16 v[164:167], a[112:115], a[24:27], v[164:167]
    ds_read_b64_tr_b16 a[150:151], v229 offset:5120
    v_lshl_add_u32 v25, v25, 11, v22
    v_mfma_f32_16x16x32_bf16 v[168:171], a[112:115], a[28:31], v[168:171]
    ds_read_b64_tr_b16 a[136:137], v230 offset:0
    v_xor_b32 v21, 32, v20
    v_mfma_f32_16x16x32_bf16 v[168:171], a[96:99], a[20:23], v[168:171]
    ds_read_b64_tr_b16 a[138:139], v230 offset:1024
    v_xor_b32 v22, 64, v20
    v_mfma_f32_16x16x32_bf16 v[176:179], a[100:103], a[20:23], v[176:179]
    ds_read_b64_tr_b16 a[152:153], v230 offset:4096
    s_waitcnt lgkmcnt(4)
    v_mfma_f32_16x16x32_bf16 v[176:179], a[116:119], a[28:31], v[176:179]
    ds_read_b64_tr_b16 a[154:155], v230 offset:5120
    v_xor_b32 v23, 96, v20
    v_mfma_f32_16x16x32_bf16 v[172:175], a[116:119], a[24:27], v[172:175]
    ds_read_b64_tr_b16 a[140:141], v231 offset:0
    v_mfma_f32_16x16x32_bf16 v[172:175], a[100:103], a[16:19], v[172:175]
    ds_read_b64_tr_b16 a[142:143], v231 offset:1024
    v_mfma_f32_16x16x32_bf16 v[180:183], a[104:107], a[16:19], v[180:183]
    ds_read_b64_tr_b16 a[156:157], v231 offset:4096
    v_mfma_f32_16x16x32_bf16 v[180:183], a[120:123], a[24:27], v[180:183]
    ds_read_b64_tr_b16 a[158:159], v231 offset:5120
    v_mfma_f32_16x16x32_bf16 v[184:187], a[120:123], a[28:31], v[184:187]
    ds_read_b64_tr_b16 a[224:225], v228 offset:8192
    v_mfma_f32_16x16x32_bf16 v[184:187], a[104:107], a[20:23], v[184:187]
    ds_read_b64_tr_b16 a[226:227], v228 offset:9216
    v_mfma_f32_16x16x32_bf16 v[192:195], a[108:111], a[20:23], v[192:195]
    ds_read_b64_tr_b16 a[240:241], v228 offset:12288
    v_mfma_f32_16x16x32_bf16 v[192:195], a[124:127], a[28:31], v[192:195]
    ds_read_b64_tr_b16 a[242:243], v228 offset:13312
    v_mfma_f32_16x16x32_bf16 v[188:191], a[124:127], a[24:27], v[188:191]
    ds_read_b64_tr_b16 a[228:229], v229 offset:8192
    s_waitcnt vmcnt(4)
    v_mfma_f32_16x16x32_bf16 v[188:191], a[108:111], a[16:19], v[188:191]
    ds_read_b64_tr_b16 a[230:231], v229 offset:9216
    v_mfma_f32_16x16x32_bf16 v[164:167], a[128:131], a[32:35], v[164:167]
    ds_read_b64_tr_b16 a[244:245], v229 offset:12288
    v_mfma_f32_16x16x32_bf16 v[164:167], a[144:147], a[40:43], v[164:167]
    ds_read_b64_tr_b16 a[246:247], v229 offset:13312
    s_waitcnt lgkmcnt(3)
    v_mfma_f32_16x16x32_bf16 v[172:175], a[148:151], a[40:43], v[172:175]
    ds_read_b64_tr_b16 a[232:233], v230 offset:8192
    v_mfma_f32_16x16x32_bf16 v[172:175], a[132:135], a[32:35], v[172:175]
    ds_read_b64_tr_b16 a[234:235], v230 offset:9216
    v_mfma_f32_16x16x32_bf16 v[180:183], a[136:139], a[32:35], v[180:183]
    ds_read_b64_tr_b16 a[248:249], v230 offset:12288
    v_mfma_f32_16x16x32_bf16 v[180:183], a[152:155], a[40:43], v[180:183]
    ds_read_b64_tr_b16 a[250:251], v230 offset:13312
    v_mfma_f32_16x16x32_bf16 v[188:191], a[156:159], a[40:43], v[188:191]
    ds_read_b64_tr_b16 a[236:237], v231 offset:8192
    v_mfma_f32_16x16x32_bf16 v[188:191], a[140:143], a[32:35], v[188:191]
    s_waitcnt vmcnt(0)
    ds_read_b64_tr_b16 a[238:239], v231 offset:9216
    v_mfma_f32_16x16x32_bf16 v[164:167], a[224:227], a[48:51], v[164:167]
    ds_read_b64_tr_b16 a[252:253], v231 offset:12288
    v_mfma_f32_16x16x32_bf16 v[164:167], a[240:243], a[56:59], v[164:167]
    ds_read_b64_tr_b16 a[254:255], v231 offset:13312
    s_waitcnt lgkmcnt(3)
    v_mfma_f32_16x16x32_bf16 v[172:175], a[244:247], a[56:59], v[172:175]
    v_mfma_f32_16x16x32_bf16 v[172:175], a[228:231], a[48:51], v[172:175]
    v_mfma_f32_16x16x32_bf16 v[180:183], a[232:235], a[48:51], v[180:183]
    v_mfma_f32_16x16x32_bf16 v[180:183], a[248:251], a[56:59], v[180:183]
    s_waitcnt lgkmcnt(0)
    v_mfma_f32_16x16x32_bf16 v[188:191], a[252:255], a[56:59], v[188:191]
    v_mfma_f32_16x16x32_bf16 v[188:191], a[236:239], a[48:51], v[188:191]
    v_mfma_f32_16x16x32_bf16 v[168:171], a[128:131], a[36:39], v[168:171]
    v_mfma_f32_16x16x32_bf16 v[168:171], a[144:147], a[44:47], v[168:171]
    v_cvt_pk_bf16_f32 v28, v164, v165
    v_cvt_pk_bf16_f32 v29, v166, v167
    v_mfma_f32_16x16x32_bf16 v[168:171], a[224:227], a[52:55], v[168:171]
    ds_write_b64 v20, v[28:29] offset:0
    v_mfma_f32_16x16x32_bf16 v[168:171], a[240:243], a[60:63], v[168:171]
    v_cvt_pk_bf16_f32 v32, v172, v173
    v_cvt_pk_bf16_f32 v33, v174, v175
    v_mfma_f32_16x16x32_bf16 v[176:179], a[132:135], a[36:39], v[176:179]
    ds_write_b64 v21, v[32:33] offset:0
    v_mfma_f32_16x16x32_bf16 v[176:179], a[148:151], a[44:47], v[176:179]
    v_cvt_pk_bf16_f32 v36, v180, v181
    v_cvt_pk_bf16_f32 v37, v182, v183
    v_mfma_f32_16x16x32_bf16 v[176:179], a[228:231], a[52:55], v[176:179]
    ds_write_b64 v22, v[36:37] offset:0
    v_mfma_f32_16x16x32_bf16 v[176:179], a[244:247], a[60:63], v[176:179]
    v_cvt_pk_bf16_f32 v40, v188, v189
    v_cvt_pk_bf16_f32 v41, v190, v191
    v_mfma_f32_16x16x32_bf16 v[184:187], a[136:139], a[36:39], v[184:187]
    ds_write_b64 v23, v[40:41] offset:0
    v_mfma_f32_16x16x32_bf16 v[184:187], a[152:155], a[44:47], v[184:187]
    ds_read_b128 v[44:47], v24 offset:0
    v_mfma_f32_16x16x32_bf16 v[184:187], a[232:235], a[52:55], v[184:187]
    ds_read_b128 v[48:51], v24 offset:1024
    v_cvt_pk_bf16_f32 v30, v168, v169
    v_mfma_f32_16x16x32_bf16 v[184:187], a[248:251], a[60:63], v[184:187]
    v_cvt_pk_bf16_f32 v31, v170, v171
    v_mfma_f32_16x16x32_bf16 v[192:195], a[140:143], a[36:39], v[192:195]
    ds_write_b64 v20, v[30:31] offset:2048
    v_mfma_f32_16x16x32_bf16 v[192:195], a[156:159], a[44:47], v[192:195]
    v_cvt_pk_bf16_f32 v34, v176, v177
    v_cvt_pk_bf16_f32 v35, v178, v179
    v_mfma_f32_16x16x32_bf16 v[192:195], a[236:239], a[52:55], v[192:195]
    ds_write_b64 v21, v[34:35] offset:2048
    v_mfma_f32_16x16x32_bf16 v[192:195], a[252:255], a[60:63], v[192:195]
    s_waitcnt lgkmcnt(2)
    buffer_store_dwordx4 v[44:47], v25, s[24:27], s50 offen sc1
    s_add_u32 s50, s50, 16384
    v_cvt_pk_bf16_f32 v38, v184, v185
    v_cvt_pk_bf16_f32 v39, v186, v187
    ds_write_b64 v22, v[38:39] offset:2048
    buffer_store_dwordx4 v[48:51], v25, s[24:27], s50 offen sc1
    s_add_u32 s50, s50, 16384
    v_cvt_pk_bf16_f32 v42, v192, v193
    v_cvt_pk_bf16_f32 v43, v194, v195
    ds_write_b64 v23, v[42:43] offset:2048
    ds_read_b128 v[52:55], v24 offset:2048
    ds_read_b128 v[56:59], v24 offset:3072
    s_waitcnt lgkmcnt(1)
    buffer_store_dwordx4 v[52:55], v25, s[24:27], s50 offen sc1
    s_add_u32 s50, s50, 16384
    s_waitcnt lgkmcnt(0)
    buffer_store_dwordx4 v[56:59], v25, s[24:27], s50 offen sc1
L_end:
    s_endpgm
.p2align 12
L_pad_9:
    s_branch L_walkret
L_p3spin:
    s_mov_b32 s72, 1048576
L_p3spin1:
    buffer_load_dwordx2 v[246:247], v7, s[16:19], s83 offen offset:896 sc1
    s_waitcnt vmcnt(0)
    v_and_b32 v246, v246, v247
    v_cmp_eq_u32 vcc, 1, v246
    s_nop 0
    s_or_b32 s44, s44, vcc_lo
    s_bfe_u32 s43, s44, 0x80008
    s_and_b32 s41, s44, s43
    v_cndmask_b32 v7, v7, v233, vcc
    s_sub_u32 s72, s72, 1
    s_cselect_b32 s44, -1, s44
    s_andn2_b32 s43, s41, s42
    s_cbranch_scc0 L_p3spin1
    s_setpc_b64 s[78:79]
L_late:
    buffer_load_dwordx2 v[244:245], v7, s[16:19], s83 offen offset:896 sc1
    s_waitcnt vmcnt(1)
    buffer_store_dword v19, v18, s[16:19], s55 offen offset:896 sc1
    v_bfrev_b32 v18, 1
    s_waitcnt vmcnt(1)
    v_and_b32 v244, v244, v245
    v_cmp_eq_u32 vcc, 1, v244
    s_nop 0
    s_or_b32 s44, s44, vcc_lo
    s_bfe_u32 s43, s44, 0x80008
    s_and_b32 s41, s44, s43
    v_cndmask_b32 v7, v7, v233, vcc
    s_branch L_p3
L_dry_185:
    s_call_b64 s[78:79], L_p3spin
    s_branch L_wet_185
L_dry_188:
    s_call_b64 s[78:79], L_p3spin
    s_branch L_wet_188
L_dry_191:
    s_call_b64 s[78:79], L_p3spin
    s_branch L_wet_191
L_dry_194:
    s_call_b64 s[78:79], L_p3spin
    s_branch L_wet_194
L_dry_197:
    s_call_b64 s[78:79], L_p3spin
    s_branch L_wet_197
L_dry_200:
    s_call_b64 s[78:79], L_p3spin
    s_branch L_wet_200
L_dry_203:
    s_call_b64 s[78:79], L_p3spin
    s_branch L_wet_203
L_dry_206:
    s_call_b64 s[78:79], L_p3spin
    s_branch L_wet_206
L_fb0_slow:
    s_mov_b32 s76, 1048576
L_fb0_spin:
    buffer_load_dword v244, v8, s[16:19], s82 offen offset:128 sc1
    s_waitcnt vmcnt(0)
    v_cmp_eq_u32 vcc, 1, v244
    s_nop 0
    s_andn2_b32 s47, 6, vcc_lo
    s_cmp_eq_u32 s47, 0
    s_cbranch_scc1 L_fb0_ok
    s_sleep 1
    s_sub_u32 s76, s76, 1
    s_cmp_lg_u32 s76, 0
    s_cbranch_scc1 L_fb0_spin
    s_branch L_fb0_ok
L_fb_slow:
    s_mov_b32 s76, 1048576
L_fb_spin:
    buffer_load_dword v244, v8, s[16:19], s82 offen offset:128 sc1
    s_waitcnt vmcnt(0)
    v_cmp_eq_u32 vcc, 1, v244
    s_nop 0
    s_cmp_eq_u64 vcc, exec
    s_cbranch_scc1 L_fb_ok
    s_sleep 1
    s_sub_u32 s76, s76, 1
    s_cmp_lg_u32 s76, 0
    s_cbranch_scc1 L_fb_spin
    s_branch L_fb_ok
L_nyq:
    s_waitcnt lgkmcnt(0)
    v_mfma_f32_32x32x16_bf16 v[20:35], a[192:195], a[0:3], 0
    v_mfma_f32_32x32x16_bf16 v[20:35], a[196:199], a[4:7], v[20:35]
    v_mfma_f32_32x32x16_bf16 v[20:35], a[200:203], a[8:11], v[20:35]
    v_mfma_f32_32x32x16_bf16 v[20:35], a[204:207], a[12:15], v[20:35]
    v_mfma_f32_32x32x16_bf16 v[36:51], a[192:195], a[32:35], 0
    v_mfma_f32_32x32x16_bf16 v[36:51], a[196:199], a[36:39], v[36:51]
    v_mfma_f32_32x32x16_bf16 v[36:51], a[200:203], a[40:43], v[36:51]
    v_mfma_f32_32x32x16_bf16 v[36:51], a[204:207], a[44:47], v[36:51]
    v_accvgpr_write_b32 a192, 0
    v_accvgpr_write_b32 a193, 0
    v_accvgpr_write_b32 a194, 0
    v_accvgpr_write_b32 a195, 0
    v_accvgpr_write_b32 a196, 0
    v_accvgpr_write_b32 a197, 0
    v_accvgpr_write_b32 a198, 0
    v_accvgpr_write_b32 a199, 0
    v_accvgpr_write_b32 a200, 0
    v_accvgpr_write_b32 a201, 0
    v_accvgpr_write_b32 a202, 0
    v_accvgpr_write_b32 a203, 0
    v_accvgpr_write_b32 a204, 0
    v_accvgpr_write_b32 a205, 0
    v_accvgpr_write_b32 a206, 0
    v_accvgpr_write_b32 a207, 0
    s_add_u32 s50, s75, 2097152
    v_pk_mul_f32 v[182:183], v[20:21], v[212:213]
    v_pk_mul_f32 v[180:181], v[36:37], v[212:213]
    v_pk_fma_f32 v[182:183], v[36:37], v[196:197], v[182:183] neg_lo:[0,0,1] neg_hi:[0,0,1]
    v_pk_fma_f32 v[180:181], v[20:21], v[196:197], v[180:181]
    v_cvt_pk_bf16_f32 v172, v182, v183
    v_cvt_pk_bf16_f32 v164, v180, v181
    v_pk_mul_f32 v[186:187], v[22:23], v[214:215]
    v_pk_mul_f32 v[184:185], v[38:39], v[214:215]
    v_pk_fma_f32 v[186:187], v[38:39], v[198:199], v[186:187] neg_lo:[0,0,1] neg_hi:[0,0,1]
    v_pk_fma_f32 v[184:185], v[22:23], v[198:199], v[184:185]
    v_cvt_pk_bf16_f32 v173, v186, v187
    v_cvt_pk_bf16_f32 v165, v184, v185
    v_pk_mul_f32 v[182:183], v[24:25], v[216:217]
    v_pk_mul_f32 v[180:181], v[40:41], v[216:217]
    v_pk_fma_f32 v[182:183], v[40:41], v[200:201], v[182:183] neg_lo:[0,0,1] neg_hi:[0,0,1]
    v_pk_fma_f32 v[180:181], v[24:25], v[200:201], v[180:181]
    v_cvt_pk_bf16_f32 v174, v182, v183
    v_cvt_pk_bf16_f32 v166, v180, v181
    v_pk_mul_f32 v[186:187], v[26:27], v[218:219]
    v_pk_mul_f32 v[184:185], v[42:43], v[218:219]
    v_pk_fma_f32 v[186:187], v[42:43], v[202:203], v[186:187] neg_lo:[0,0,1] neg_hi:[0,0,1]
    v_pk_fma_f32 v[184:185], v[26:27], v[202:203], v[184:185]
    v_cvt_pk_bf16_f32 v175, v186, v187
    v_cvt_pk_bf16_f32 v167, v184, v185
    v_pk_mul_f32 v[182:183], v[28:29], v[220:221]
    v_pk_mul_f32 v[180:181], v[44:45], v[220:221]
    v_pk_fma_f32 v[182:183], v[44:45], v[204:205], v[182:183] neg_lo:[0,0,1] neg_hi:[0,0,1]
    v_pk_fma_f32 v[180:181], v[28:29], v[204:205], v[180:181]
    v_cvt_pk_bf16_f32 v176, v182, v183
    v_cvt_pk_bf16_f32 v168, v180, v181
    v_pk_mul_f32 v[186:187], v[30:31], v[222:223]
    v_pk_mul_f32 v[184:185], v[46:47], v[222:223]
    v_pk_fma_f32 v[186:187], v[46:47], v[206:207], v[186:187] neg_lo:[0,0,1] neg_hi:[0,0,1]
    v_pk_fma_f32 v[184:185], v[30:31], v[206:207], v[184:185]
    v_cvt_pk_bf16_f32 v177, v186, v187
    v_cvt_pk_bf16_f32 v169, v184, v185
    v_pk_mul_f32 v[182:183], v[32:33], v[224:225]
    v_pk_mul_f32 v[180:181], v[48:49], v[224:225]
    v_pk_fma_f32 v[182:183], v[48:49], v[208:209], v[182:183] neg_lo:[0,0,1] neg_hi:[0,0,1]
    v_pk_fma_f32 v[180:181], v[32:33], v[208:209], v[180:181]
    v_cvt_pk_bf16_f32 v178, v182, v183
    v_cvt_pk_bf16_f32 v170, v180, v181
    v_pk_mul_f32 v[186:187], v[34:35], v[226:227]
    v_pk_mul_f32 v[184:185], v[50:51], v[226:227]
    v_pk_fma_f32 v[186:187], v[50:51], v[210:211], v[186:187] neg_lo:[0,0,1] neg_hi:[0,0,1]
    v_pk_fma_f32 v[184:185], v[34:35], v[210:211], v[184:185]
    v_cvt_pk_bf16_f32 v179, v186, v187
    v_cvt_pk_bf16_f32 v171, v184, v185
    v_mfma_f32_32x32x16_bf16 v[180:195], v[164:167], a[48:51], 0
    v_mfma_f32_32x32x16_bf16 v[180:195], v[172:175], a[56:59], v[180:195]
    v_mfma_f32_32x32x16_bf16 v[180:195], v[168:171], a[52:55], v[180:195]
    v_mfma_f32_32x32x16_bf16 v[180:195], v[176:179], a[60:63], v[180:195]
    s_waitcnt vmcnt(0)
    buffer_store_dword v19, v2, s[16:19], s53 offen offset:128 sc1
    s_nop 9
    v_cvt_pk_bf16_f32 v20, v180, v181
    v_cvt_pk_bf16_f32 v21, v182, v183
    ds_write_b64 v78, v[20:21]
    v_cvt_pk_bf16_f32 v22, v184, v185
    v_cvt_pk_bf16_f32 v23, v186, v187
    ds_write_b64 v79, v[22:23]
    v_cvt_pk_bf16_f32 v24, v188, v189
    v_cvt_pk_bf16_f32 v25, v190, v191
    ds_write_b64 v80, v[24:25]
    v_cvt_pk_bf16_f32 v26, v192, v193
    v_cvt_pk_bf16_f32 v27, v194, v195
    ds_write_b64 v81, v[26:27]
    ds_read_b128 a[208:211], v77 offset:0
    ds_read_b128 a[212:215], v77 offset:1024
    s_waitcnt lgkmcnt(0)
    buffer_store_dwordx4 a[208:211], v3, s[16:19], s50 offen offset:0 sc1
    buffer_store_dwordx4 a[212:215], v3, s[16:19], s50 offen offset:1024 sc1
    s_nop 1
    s_branch L_nyq_done
L_sa_slow:
    s_mov_b32 s76, 1048576
L_sa_spin:
    buffer_load_dword v244, v233, s[32:35], 0 offen sc1
    s_waitcnt vmcnt(0)
    v_cmp_le_u32 vcc, 4, v244
    s_nop 0
    s_cmp_eq_u64 vcc, exec
    s_cbranch_scc1 L_sa_ok
    s_sleep 1
    s_sub_u32 s76, s76, 1
    s_cmp_lg_u32 s76, 0
    s_cbranch_scc1 L_sa_spin
    s_branch L_sa_ok
L_fc_slow:
    s_mov_b32 s76, 1048576
L_fc_spin:
    buffer_load_dwordx4 v[244:247], v4, s[16:19], s98 offen offset:384 sc1
    s_waitcnt vmcnt(0)
    v_and_b32 v244, v244, v245
    v_and_b32 v246, v246, v247
    v_and_b32 v244, v244, v246
    v_cmp_eq_u32 vcc, 1, v244
    s_nop 0
    s_cmp_eq_u64 vcc, exec
    s_cbranch_scc1 L_fc_ok
    s_sleep 1
    s_sub_u32 s76, s76, 1
    s_cmp_lg_u32 s76, 0
    s_cbranch_scc1 L_fc_spin
    s_branch L_fc_ok
L_codeend:
L_fallback:
    s_waitcnt vmcnt(0) lgkmcnt(0)
    s_barrier
    s_mov_b32 s71, 1
    s_mov_b32 s46, 0
    v_mov_b32 v233, 0xff800000
    v_mov_b32 v234, 0xff800000
    v_mov_b32 v235, 0xff800000
    v_mov_b32 v236, 0xff800000
L_fbloop:
    s_lshr_b32 s47, s46, 1
    s_lshl_b32 s47, s47, 14
    s_and_b32 s48, s46, 1
    s_lshl_b32 s48, s48, 12
    s_add_u32 s47, s47, s48
    s_add_u32 s47, s47, s66
    buffer_load_dwordx4 v[20:23], v3, s[16:19], s47 offen sc1
    buffer_load_dwordx4 v[24:27], v3, s[16:19], s47 offen offset:1024 sc1
    s_waitcnt vmcnt(0)
    v_mfma_f32_32x32x16_bf16 v[100:115], v[20:23], a[64:67], 0
    v_mfma_f32_32x32x16_bf16 v[100:115], v[24:27], a[68:71], v[100:115]
    v_mfma_f32_32x32x16_bf16 v[116:131], v[20:23], a[72:75], 0
    v_mfma_f32_32x32x16_bf16 v[116:131], v[24:27], a[76:79], v[116:131]
    v_mfma_f32_32x32x16_bf16 v[132:147], v[20:23], a[80:83], 0
    v_mfma_f32_32x32x16_bf16 v[132:147], v[24:27], a[84:87], v[132:147]
    v_mfma_f32_32x32x16_bf16 v[148:163], v[20:23], a[88:91], 0
    v_mfma_f32_32x32x16_bf16 v[148:163], v[24:27], a[92:95], v[148:163]
    s_nop 5
    v_max3_f32 v233, v100, v101, v233
    v_max3_f32 v233, v102, v103, v233
    v_max3_f32 v233, v104, v105, v233
    v_max3_f32 v233, v106, v107, v233
    v_max3_f32 v233, v108, v109, v233
    v_max3_f32 v233, v110, v111, v233
    v_max3_f32 v233, v112, v113, v233
    v_max3_f32 v233, v114, v115, v233
    v_max3_f32 v234, v116, v117, v234
    v_max3_f32 v234, v118, v119, v234
    v_max3_f32 v234, v120, v121, v234
    v_max3_f32 v234, v122, v123, v234
    v_max3_f32 v234, v124, v125, v234
    v_max3_f32 v234, v126, v127, v234
    v_max3_f32 v234, v128, v129, v234
    v_max3_f32 v234, v130, v131, v234
    v_max3_f32 v235, v132, v133, v235
    v_max3_f32 v235, v134, v135, v235
    v_max3_f32 v235, v136, v137, v235
    v_max3_f32 v235, v138, v139, v235
    v_max3_f32 v235, v140, v141, v235
    v_max3_f32 v235, v142, v143, v235
    v_max3_f32 v235, v144, v145, v235
    v_max3_f32 v235, v146, v147, v235
    v_max3_f32 v236, v148, v149, v236
    v_max3_f32 v236, v150, v151, v236
    v_max3_f32 v236, v152, v153, v236
    v_max3_f32 v236, v154, v155, v236
    v_max3_f32 v236, v156, v157, v236
    v_max3_f32 v236, v158, v159, v236
    v_max3_f32 v236, v160, v161, v236
    v_max3_f32 v236, v162, v163, v236
    s_add_u32 s46, s46, 1
    s_cmp_lt_u32 s46, 32
    s_cbranch_scc1 L_fbloop
    v_mov_b32 v248, v233
    v_mov_b32 v249, v234
    v_mov_b32 v250, v235
    v_mov_b32 v251, v236
    v_permlane32_swap_b32 v233, v248
    v_permlane32_swap_b32 v234, v249
    v_permlane32_swap_b32 v235, v250
    v_permlane32_swap_b32 v236, v251
    v_max_f32 v233, v233, v248
    v_max_f32 v234, v234, v249
    v_max_f32 v235, v235, v250
    v_max_f32 v236, v236, v251
    s_lshl_b32 s47, s36, 13
    s_add_u32 s47, s47, 131072
    v_add_u32 v248, s47, v3
    v_xor_b32 v249, 16384, v248
    s_lshl_b32 s68, s38, 14
    s_add_u32 s67, s66, s68
    buffer_load_dwordx4 a[96:99], v3, s[16:19], s67 offen offset:0 sc1
    buffer_load_dwordx4 a[100:103], v3, s[16:19], s67 offen offset:1024 sc1
    buffer_load_dwordx4 a[104:107], v3, s[16:19], s67 offen offset:2048 sc1
    buffer_load_dwordx4 a[108:111], v3, s[16:19], s67 offen offset:3072 sc1
    buffer_load_dwordx4 a[112:115], v3, s[16:19], s84 offen offset:0 sc1
    buffer_load_dwordx4 a[116:119], v3, s[16:19], s84 offen offset:1024 sc1
    buffer_load_dwordx4 a[120:123], v3, s[16:19], s84 offen offset:2048 sc1
    buffer_load_dwordx4 a[124:127], v3, s[16:19], s84 offen offset:3072 sc1
    v_mov_b32 v20, v233
    v_mov_b32 v21, v234
    v_mov_b32 v22, v235
    v_mov_b32 v23, v236
    ds_write_b128 v248, v[20:23]
    s_waitcnt lgkmcnt(0)
    s_barrier
    ds_read_b128 v[24:27], v249
    s_waitcnt vmcnt(0) lgkmcnt(0)
    s_barrier
    v_max_f32 v233, v233, v26
    v_max_f32 v234, v234, v27
    v_max_f32 v235, v235, v24
    v_max_f32 v236, v236, v25
    v_sub_f32 v164, 0, v233
    v_sub_f32 v165, 0, v233
    v_sub_f32 v166, 0, v233
    v_sub_f32 v167, 0, v233
    v_sub_f32 v168, 0, v233
    v_sub_f32 v169, 0, v233
    v_sub_f32 v170, 0, v233
    v_sub_f32 v171, 0, v233
    v_sub_f32 v172, 0, v233
    v_sub_f32 v173, 0, v233
    v_sub_f32 v174, 0, v233
    v_sub_f32 v175, 0, v233
    v_sub_f32 v176, 0, v233
    v_sub_f32 v177, 0, v233
    v_sub_f32 v178, 0, v233
    v_sub_f32 v179, 0, v233
    v_sub_f32 v180, 0, v234
    v_sub_f32 v181, 0, v234
    v_sub_f32 v182, 0, v234
    v_sub_f32 v183, 0, v234
    v_sub_f32 v184, 0, v234
    v_sub_f32 v185, 0, v234
    v_sub_f32 v186, 0, v234
    v_sub_f32 v187, 0, v234
    v_sub_f32 v188, 0, v234
    v_sub_f32 v189, 0, v234
    v_sub_f32 v190, 0, v234
    v_sub_f32 v191, 0, v234
    v_sub_f32 v192, 0, v234
    v_sub_f32 v193, 0, v234
    v_sub_f32 v194, 0, v234
    v_sub_f32 v195, 0, v234
    v_sub_f32 v196, 0, v235
    v_sub_f32 v197, 0, v235
    v_sub_f32 v198, 0, v235
    v_sub_f32 v199, 0, v235
    v_sub_f32 v200, 0, v235
    v_sub_f32 v201, 0, v235
    v_sub_f32 v202, 0, v235
    v_sub_f32 v203, 0, v235
    v_sub_f32 v204, 0, v235
    v_sub_f32 v205, 0, v235
    v_sub_f32 v206, 0, v235
    v_sub_f32 v207, 0, v235
    v_sub_f32 v208, 0, v235
    v_sub_f32 v209, 0, v235
    v_sub_f32 v210, 0, v235
    v_sub_f32 v211, 0, v235
    v_sub_f32 v212, 0, v236
    v_sub_f32 v213, 0, v236
    v_sub_f32 v214, 0, v236
    v_sub_f32 v215, 0, v236
    v_sub_f32 v216, 0, v236
    v_sub_f32 v217, 0, v236
    v_sub_f32 v218, 0, v236
    v_sub_f32 v219, 0, v236
    v_sub_f32 v220, 0, v236
    v_sub_f32 v221, 0, v236
    v_sub_f32 v222, 0, v236
    v_sub_f32 v223, 0, v236
    v_sub_f32 v224, 0, v236
    v_sub_f32 v225, 0, v236
    v_sub_f32 v226, 0, v236
    v_sub_f32 v227, 0, v236
    v_mfma_f32_32x32x16_bf16 v[100:115], a[96:99], a[64:67], v[164:179]
    v_mfma_f32_32x32x16_bf16 v[100:115], a[100:103], a[68:71], v[100:115]
    v_mov_b32 v20, 0
    v_mov_b32 v21, 0
    v_mov_b32 v22, 0
    v_mov_b32 v23, 0
    v_mov_b32 v24, 0
    v_mov_b32 v25, 0
    v_mov_b32 v26, 0
    v_mov_b32 v27, 0
    v_mov_b32 v28, 0
    v_mov_b32 v29, 0
    v_mov_b32 v30, 0
    v_mov_b32 v31, 0
    v_mov_b32 v32, 0
    v_mov_b32 v33, 0
    v_mov_b32 v34, 0
    v_mov_b32 v35, 0
    v_mov_b32 v36, 0
    v_mov_b32 v37, 0
    v_mov_b32 v38, 0
    v_mov_b32 v39, 0
    v_mov_b32 v40, 0
    v_mov_b32 v41, 0
    v_mov_b32 v42, 0
    v_mov_b32 v43, 0
    v_mov_b32 v44, 0
    v_mov_b32 v45, 0
    v_mov_b32 v46, 0
    v_mov_b32 v47, 0
    v_mov_b32 v48, 0
    v_mov_b32 v49, 0
    v_mov_b32 v50, 0
    v_mov_b32 v51, 0
    v_mov_b32 v52, 0
    v_mov_b32 v53, 0
    v_mov_b32 v54, 0
    v_mov_b32 v55, 0
    v_mov_b32 v56, 0
    v_mov_b32 v57, 0
    v_mov_b32 v58, 0
    v_mov_b32 v59, 0
    v_mov_b32 v60, 0
    v_mov_b32 v61, 0
    v_mov_b32 v62, 0
    v_mov_b32 v63, 0
    v_mov_b32 v64, 0
    v_mov_b32 v65, 0
    v_mov_b32 v66, 0
    v_mov_b32 v67, 0
    v_mov_b32 v68, 0
    v_mov_b32 v69, 0
    v_mov_b32 v70, 0
    v_mov_b32 v71, 0
    v_mov_b32 v72, 0
    v_mov_b32 v73, 0
    v_mov_b32 v74, 0
    v_mov_b32 v75, 0
    v_mov_b32 v76, 0
    v_mov_b32 v77, 0
    v_mov_b32 v78, 0
    v_mov_b32 v79, 0
    v_mov_b32 v80, 0
    v_mov_b32 v81, 0
    v_mov_b32 v82, 0
    v_mov_b32 v83, 0
    v_mov_b32 v84, 0
    v_mov_b32 v85, 0
    v_mov_b32 v86, 0
    v_mov_b32 v87, 0
    v_mov_b32 v88, 0
    v_mov_b32 v89, 0
    v_mov_b32 v90, 0
    v_mov_b32 v91, 0
    v_mov_b32 v92, 0
    v_mov_b32 v93, 0
    v_mov_b32 v94, 0
    v_mov_b32 v95, 0
    v_mov_b32 v96, 0
    v_mov_b32 v97, 0
    v_mov_b32 v98, 0
    v_mov_b32 v99, 0
    v_bfrev_b32 v16, 1
    s_branch L_att
.section .rodata,"a"
.p2align 6
.amdhsa_kernel gated_mix__mha_block__spectral_fnet__prompt_kernel
  .amdhsa_next_free_vgpr 512
  .amdhsa_next_free_sgpr 102
  .amdhsa_accum_offset 256
  .amdhsa_group_segment_fixed_size 0
  .amdhsa_kernarg_size 96
  .amdhsa_user_sgpr_count 2
  .amdhsa_user_sgpr_kernarg_segment_ptr 1
  .amdhsa_system_sgpr_workgroup_id_x 1
  .amdhsa_float_denorm_mode_32 3
.end_amdhsa_kernel
```
